```python
import torch

def _softmax(x, axis=-1):
    return torch.softmax(x, dim=axis)
def _gelu(x):
    return torch.nn.functional.gelu(x, approximate="tanh")
def _silu(x):
    return torch.nn.functional.silu(x)
def _sigmoid(x):
    return torch.sigmoid(x)
def _layernorm(x, axis=-1, eps=1e-5):
    m = x.mean(dim=axis, keepdim=True)
    v = x.var(dim=axis, keepdim=True, unbiased=False)
    return (x - m) / torch.sqrt(v + eps)
def _scatter_add(tgt, idx, src, axis=0):
    return tgt.clone().index_add_(axis, idx, src)
def _segment_sum(src, seg, n):
    out = torch.zeros((n,) + src.shape[1:], dtype=src.dtype)
    return out.index_add_(0, seg, src)
def _pad(x, pw):
    flat = tuple(v for pair in reversed(pw) for v in pair)
    return torch.nn.functional.pad(x, flat)

kernel_name = 'sequential_preLN__mha_block__geglu_ffn__prompt'

def setup_inputs():

    _w = (lambda a: (lambda t: t.to(torch.bfloat16) if t.is_floating_point() else t)(torch.as_tensor(a)))
    def _A_setup():
        B, S, D, H = 1, 2048, 576, 32
        return {
            "x": _w((lambda *s: torch.randn(*s, dtype=torch.bfloat16) * 0.05)(B, S, D)),
            "wqkv": _w((lambda *s: torch.randn(*s, dtype=torch.bfloat16) * 0.05)(D, 3 * D)),
            "wo": _w((lambda *s: torch.randn(*s, dtype=torch.bfloat16) * 0.05)(D, D)),
        }
    _A_in = _A_setup()

    def _B_setup():
        B, S, D, F = 1, 2048, 576, 4608
        return {
            "x": _w((lambda *s: torch.randn(*s, dtype=torch.bfloat16) * 0.05)(B, S, D)),
            "w_gate": _w((lambda *s: torch.randn(*s, dtype=torch.bfloat16) * 0.05)(D, F)),
            "w_up": _w((lambda *s: torch.randn(*s, dtype=torch.bfloat16) * 0.05)(D, F)),
            "w_down": _w((lambda *s: torch.randn(*s, dtype=torch.bfloat16) * 0.05)(F, D)),
        }
    _B_in = _B_setup()

    return {
        "A_x": _A_in["x"],
        "A_wqkv": _A_in["wqkv"],
        "A_wo": _A_in["wo"],
        "B_x": _B_in["x"],
        "B_w_gate": _B_in["w_gate"],
        "B_w_up": _B_in["w_up"],
        "B_w_down": _B_in["w_down"],
    }

def reference(A_x, A_wqkv, A_wo, B_x, B_w_gate, B_w_up, B_w_down):
    def _A_ref(x, wqkv, wo):
        B, S, D = x.shape
        H = 32
        Dh = D // H
        qkv = (lambda x, *d: x.permute(*d))((x @ wqkv).reshape(B, S, 3, H, Dh), 2, 0, 3, 1, 4)
        q, k, v = qkv[0], qkv[1], qkv[2]
        scores = torch.einsum("bhqd,bhkd->bhqk", q, k) * (Dh ** -0.5)
        p = _softmax(scores, axis=-1)
        o = torch.einsum("bhqk,bhkd->bhqd", p, v)
        return (lambda x, *d: x.permute(*d))(o, 0, 2, 1, 3).reshape(B, S, D) @ wo

    def _B_ref(x, w_gate, w_up, w_down):
        return (_gelu(x @ w_gate) * (x @ w_up)) @ w_down

    x = A_x
    h = x + _A_ref(_layernorm(x, axis=-1), A_wqkv, A_wo)
    h2 = h + _B_ref(_layernorm(h, axis=-1), B_w_gate, B_w_up, B_w_down)
    return h2
```

```asm
; @launch kernel=qkv_kernel grid=(256,1,1) block=(512,1,1) lds=152064
; @launch kernel=attn_kernel grid=(256,1,1) block=(512,1,1) lds=163840
; @launch kernel=attn_out_kernel grid=(256,1,1) block=(256,1,1) lds=83968
; @launch kernel=ffn_kernel grid=(256,1,1) block=(512,1,1) lds=147456
.amdgcn_target "amdgcn-amd-amdhsa--gfx950"
.text
.globl qkv_kernel
.p2align 8
.type qkv_kernel,@function
qkv_kernel:
    s_cmp_ge_u32 s2, 0x100
    s_cbranch_scc1 L_qkv_end
    s_cmp_ge_u32 s2, 0xc0
    s_cbranch_scc1 L_qkv_pack
    s_load_dwordx4 s[4:7], s[0:1], 0
    s_load_dwordx2 s[8:9], s[0:1], 0x48
    s_and_b32 s10, s2, 7
    s_lshr_b32 s11, s2, 3
    s_lshr_b32 s12, s10, 1
    s_lshl_b32 s12, s12, 2
    s_and_b32 s17, s11, 3
    s_add_u32 s12, s12, s17
    s_and_b32 s13, s10, 1
    s_mul_i32 s13, s13, 6
    s_lshr_b32 s17, s11, 2
    s_add_u32 s13, s13, s17
    v_lshrrev_b32 v3, 6, v0
    v_and_b32 v1, 63, v0
    v_readfirstlane_b32 s14, v3
    v_and_b32 v2, 31, v1
    s_nop 0
    s_and_b32 s15, s14, 3
    s_lshr_b32 s16, s14, 2
    s_lshl_b32 s18, s12, 2
    s_add_u32 s18, s18, s15
    s_cmp_ge_u32 s14, 4
    s_cbranch_scc1 L_qkv_c1
    v_lshrrev_b32 v3, 3, v1
    v_add_u32 v3, 0, v3
    v_bfe_u32 v4, v3, 1, 3
    v_and_b32 v5, 7, v1
    v_xor_b32 v4, v4, v5
    v_mul_u32_u24 v3, 0x480, v3
    v_lshl_add_u32 v6, v4, 4, v3
    v_lshrrev_b32 v3, 3, v1
    v_add_u32 v3, 8, v3
    v_bfe_u32 v4, v3, 1, 3
    v_and_b32 v5, 7, v1
    v_xor_b32 v4, v4, v5
    v_mul_u32_u24 v3, 0x480, v3
    v_lshl_add_u32 v7, v4, 4, v3
    v_lshrrev_b32 v3, 3, v1
    v_add_u32 v3, 16, v3
    v_bfe_u32 v4, v3, 1, 3
    v_and_b32 v5, 7, v1
    v_xor_b32 v4, v4, v5
    v_mul_u32_u24 v3, 0x480, v3
    v_lshl_add_u32 v8, v4, 4, v3
    v_lshrrev_b32 v3, 3, v1
    v_add_u32 v3, 24, v3
    v_bfe_u32 v4, v3, 1, 3
    v_and_b32 v5, 7, v1
    v_xor_b32 v4, v4, v5
    v_mul_u32_u24 v3, 0x480, v3
    v_lshl_add_u32 v9, v4, 4, v3
    s_mul_i32 s28, s18, 0x9000
    s_lshl_b32 s29, s15, 12
    s_add_u32 s29, s29, 0x14000
    s_waitcnt lgkmcnt(0)
    s_mov_b32 s20, s4
    s_and_b32 s21, s5, 0xffff
    s_mov_b32 s22, 0x240000
    s_mov_b32 s23, 0x20000
    s_add_u32 m0, s29, 0
    s_add_u32 s17, s28, 0
    buffer_load_dwordx4 v6, s[20:23], s17 offen lds
    s_add_u32 m0, s29, 0x400
    s_add_u32 s17, s28, 0
    buffer_load_dwordx4 v7, s[20:23], s17 offen lds
    s_add_u32 m0, s29, 0x800
    s_add_u32 s17, s28, 0
    buffer_load_dwordx4 v8, s[20:23], s17 offen lds
    s_add_u32 m0, s29, 0xc00
    s_add_u32 s17, s28, 0
    buffer_load_dwordx4 v9, s[20:23], s17 offen lds
    s_barrier
    s_add_u32 m0, s29, 0x4000
    s_add_u32 s17, s28, 0x80
    buffer_load_dwordx4 v6, s[20:23], s17 offen lds
    s_add_u32 m0, s29, 0x4400
    s_add_u32 s17, s28, 0x80
    buffer_load_dwordx4 v7, s[20:23], s17 offen lds
    s_add_u32 m0, s29, 0x4800
    s_add_u32 s17, s28, 0x80
    buffer_load_dwordx4 v8, s[20:23], s17 offen lds
    s_add_u32 m0, s29, 0x4c00
    s_add_u32 s17, s28, 0x80
    buffer_load_dwordx4 v9, s[20:23], s17 offen lds
    s_mov_b32 s24, s8
    s_and_b32 s25, s9, 0xffff
    s_mov_b32 s26, 0x740000
    s_mov_b32 s27, 0x20000
    v_mov_b32 v196, 0x3f803f80
    v_mov_b32 v197, 0x3f803f80
    v_mov_b32 v198, 0x3f803f80
    v_mov_b32 v199, 0x3f803f80
    v_lshrrev_b32 v3, 1, v0
    v_mul_u32_u24 v3, 0x140, v3
    v_and_b32 v4, 1, v0
    v_lshl_add_u32 v3, v4, 4, v3
    ds_write_b128 v3, v[196:199] offset:288
    v_bfe_u32 v4, v2, 1, 3
    v_lshrrev_b32 v3, 5, v1
    v_xor_b32 v4, v4, v3
    v_lshlrev_b32 v5, 7, v2
    s_lshl_b32 s17, s15, 12
    s_add_u32 s17, s17, 0x14000
    v_add_u32 v5, s17, v5
    s_add_u32 s17, s15, 0
    s_and_b32 s17, s17, 3
    s_lshl_b32 s17, s17, 1
    v_xor_b32 v186, s17, v4
    v_lshl_add_u32 v186, v186, 4, v5
    s_add_u32 s17, s15, 1
    s_and_b32 s17, s17, 3
    s_lshl_b32 s17, s17, 1
    v_xor_b32 v187, s17, v4
    v_lshl_add_u32 v187, v187, 4, v5
    s_add_u32 s17, s15, 2
    s_and_b32 s17, s17, 3
    s_lshl_b32 s17, s17, 1
    v_xor_b32 v188, s17, v4
    v_lshl_add_u32 v188, v188, 4, v5
    s_add_u32 s17, s15, 3
    s_and_b32 s17, s17, 3
    s_lshl_b32 s17, s17, 1
    v_xor_b32 v189, s17, v4
    v_lshl_add_u32 v189, v189, 4, v5
    v_lshlrev_b32 v3, 3, v3
    v_bfe_u32 v4, v1, 2, 2
    v_add_u32 v3, v3, v4
    v_mul_u32_u24 v3, 0x140, v3
    v_bfe_u32 v4, v1, 4, 1
    v_lshl_add_u32 v3, v4, 5, v3
    v_and_b32 v4, 3, v1
    v_lshl_add_u32 v3, v4, 3, v3
    s_add_u32 s17, s15, 0
    s_and_b32 s17, s17, 3
    s_mul_i32 s17, s17, 0x1400
    v_add_u32 v190, s17, v3
    s_add_u32 s17, s15, 1
    s_and_b32 s17, s17, 3
    s_mul_i32 s17, s17, 0x1400
    v_add_u32 v191, s17, v3
    s_add_u32 s17, s15, 2
    s_and_b32 s17, s17, 3
    s_mul_i32 s17, s17, 0x1400
    v_add_u32 v192, s17, v3
    s_add_u32 s17, s15, 3
    s_and_b32 s17, s17, 3
    s_mul_i32 s17, s17, 0x1400
    v_add_u32 v193, s17, v3
    v_and_b32 v3, 15, v1
    v_bfe_u32 v4, v1, 4, 1
    v_cmp_eq_u32 vcc, v3, v4
    s_nop 1
    v_cndmask_b32 v176, 0, v196, vcc
    v_mov_b32 v177, v176
    v_mov_b32 v178, v176
    v_mov_b32 v179, v176
    v_mov_b32 v180, 0
    v_mov_b32 v181, 0
    v_lshlrev_b32 v214, 4, v1
    v_mov_b32 v205, v214
    v_mov_b32 v206, v214
    v_mov_b32 v207, v214
    v_mov_b32 v208, v214
    v_mov_b32 v209, v214
    v_mov_b32 v200, v214
    v_mov_b32 v201, v214
    v_mov_b32 v202, v214
    v_mov_b32 v203, v214
    v_mov_b32 v204, v214
    s_mul_i32 s40, s15, 0x5000
    s_lshr_b32 s41, s13, 2
    s_and_b32 s42, s13, 3
    s_lshl_b32 s42, s42, 3
    s_cmp_eq_u32 s41, 0
    s_cselect_b32 s43, 0x3eae1a93, 1.0
    v_lshrrev_b32 v4, 5, v1
    v_mul_u32_u24 v213, 0x128, v2
    v_lshl_add_u32 v213, v4, 3, v213
    v_add_u32 v213, s40, v213
    s_cmp_eq_u32 s41, 2
    s_cbranch_scc1 L_q_v_1
    v_and_b32 v210, 19, v2
    v_bfe_u32 v4, v2, 2, 1
    v_lshl_or_b32 v210, v4, 3, v210
    v_bfe_u32 v4, v2, 3, 1
    v_lshl_or_b32 v210, v4, 2, v210
    s_cmp_eq_u32 s41, 0
    s_cselect_b64 vcc, -1, 0
    v_cndmask_b32 v210, v210, v2, vcc
    v_mul_u32_u24 v210, 0x128, v210
    s_mul_i32 s17, s16, 0x90
    s_add_u32 s17, s17, s40
    v_add_u32 v210, s17, v210
    v_lshrrev_b32 v4, 5, v1
    v_lshl_add_u32 v210, v4, 4, v210
    s_cmp_eq_u32 s41, 0
    s_cbranch_scc0 L_q_k_2
    s_lshl_b32 s44, s16, 2
    s_add_u32 s44, s44, s42
    s_lshl_b32 s44, s44, 16
    s_lshl_b32 s17, s18, 10
    s_add_u32 s44, s44, s17
    s_add_u32 s44, s44, 0
    s_mov_b32 s45, 0x10000
    s_lshl_b32 s46, s42, 13
    s_lshl_b32 s17, s18, 7
    s_add_u32 s46, s46, s17
    s_add_u32 s46, s46, 0x200000
    v_lshrrev_b32 v4, 3, v1
    v_and_b32 v212, 7, v1
    v_lshlrev_b32 v211, 4, v212
    v_lshl_add_u32 v211, v4, 13, v211
    v_mul_u32_u24 v212, 0x4a0, v212
    v_mad_u32_u24 v212, v4, 36, v212
    v_add_u32 v212, s40, v212
    s_branch L_q_j_3
L_q_k_2:
    s_lshl_b32 s44, s16, 2
    s_add_u32 s44, s44, s42
    s_mul_i32 s44, s44, 0x28000
    s_mul_i32 s46, s18, 0xa00
    s_add_u32 s44, s44, s46
    s_add_u32 s44, s44, 0x240000
    s_mov_b32 s45, 0x28000
    s_add_u32 s46, s44, 0x400
    v_and_b32 v212, 9, v1
    v_bfe_u32 v4, v1, 1, 1
    v_lshl_or_b32 v212, v4, 2, v212
    v_bfe_u32 v4, v1, 2, 1
    v_lshl_or_b32 v212, v4, 1, v212
    v_mul_u32_u24 v212, 0x250, v212
    v_lshrrev_b32 v4, 4, v1
    v_mad_u32_u24 v212, v4, 36, v212
    v_add_u32 v212, s17, v212
    v_mul_u32_u24 v211, 0x28000, v4
    v_and_b32 v4, 15, v1
    v_lshl_add_u32 v211, v4, 4, v211
    s_branch L_q_j_3
L_q_v_1:
    v_lshrrev_b32 v4, 4, v1
    v_lshlrev_b32 v210, 3, v4
    v_bfe_u32 v5, v1, 2, 2
    v_add_u32 v210, v210, v5
    v_mul_u32_u24 v210, 0x128, v210
    v_and_b32 v5, 3, v1
    v_lshl_add_u32 v210, v5, 3, v210
    s_mul_i32 s17, s16, 0xa0
    s_add_u32 s17, s17, s40
    v_add_u32 v210, s17, v210
    s_lshl_b32 s44, s16, 2
    s_add_u32 s44, s44, s42
    s_mul_i32 s44, s44, 0x28000
    s_mul_i32 s17, s18, 0xa00
    s_add_u32 s44, s44, s17
    s_add_u32 s44, s44, 0x240500
    v_mul_u32_u24 v211, 0x140, v4
    s_add_u32 s46, s40, 0x2600
    v_add_u32 v211, s46, v211
    v_and_b32 v212, 15, v1
    s_mul_i32 s17, s16, 0x50
    v_add_u32 v212, s17, v212
    s_mov_b32 s45, 0x500
    v_add_u32 v116, 0, v212
    v_mul_u32_u24 v117, 0xe38f, v116
    v_lshrrev_b32 v117, 20, v117
    v_mul_u32_u24 v118, 18, v117
    v_sub_u32 v118, v116, v118
    v_mad_u32_u24 v117, v117, s45, v211
    v_lshl_add_u32 v200, v118, 4, v117
    v_add_u32 v116, 16, v212
    v_mul_u32_u24 v117, 0xe38f, v116
    v_lshrrev_b32 v117, 20, v117
    v_mul_u32_u24 v118, 18, v117
    v_sub_u32 v118, v116, v118
    v_mad_u32_u24 v117, v117, s45, v211
    v_lshl_add_u32 v201, v118, 4, v117
    v_add_u32 v116, 32, v212
    v_mul_u32_u24 v117, 0xe38f, v116
    v_lshrrev_b32 v117, 20, v117
    v_mul_u32_u24 v118, 18, v117
    v_sub_u32 v118, v116, v118
    v_mad_u32_u24 v117, v117, s45, v211
    v_lshl_add_u32 v202, v118, 4, v117
    v_add_u32 v116, 48, v212
    v_mul_u32_u24 v117, 0xe38f, v116
    v_lshrrev_b32 v117, 20, v117
    v_mul_u32_u24 v118, 18, v117
    v_sub_u32 v118, v116, v118
    v_mad_u32_u24 v117, v117, s45, v211
    v_lshl_add_u32 v203, v118, 4, v117
    v_add_u32 v116, 64, v212
    v_mul_u32_u24 v117, 0xe38f, v116
    v_lshrrev_b32 v117, 20, v117
    v_mul_u32_u24 v118, 18, v117
    v_sub_u32 v118, v116, v118
    v_mad_u32_u24 v117, v117, s45, v211
    v_lshl_add_u32 v204, v118, 4, v117
    s_cmp_eq_u32 s16, 0
    s_cbranch_scc1 L_q_o_4
    v_lshrrev_b32 v4, 1, v1
    v_mul_u32_u24 v4, 0x140, v4
    v_and_b32 v5, 1, v1
    v_lshl_add_u32 v4, v5, 4, v4
    v_add_u32 v4, 0x120, v4
    v_add_u32 v204, s46, v4
L_q_o_4:
    v_add_u32 v116, 0, v1
    v_mul_u32_u24 v117, 0x3334, v116
    v_lshrrev_b32 v117, 20, v117
    v_mul_u32_u24 v118, 0x50, v117
    v_sub_u32 v118, v116, v118
    v_mul_u32_u24 v117, 0x28000, v117
    v_lshl_add_u32 v205, v118, 4, v117
    v_add_u32 v116, 64, v1
    v_mul_u32_u24 v117, 0x3334, v116
    v_lshrrev_b32 v117, 20, v117
    v_mul_u32_u24 v118, 0x50, v117
    v_sub_u32 v118, v116, v118
    v_mul_u32_u24 v117, 0x28000, v117
    v_lshl_add_u32 v206, v118, 4, v117
    v_add_u32 v116, 0x80, v1
    v_mul_u32_u24 v117, 0x3334, v116
    v_lshrrev_b32 v117, 20, v117
    v_mul_u32_u24 v118, 0x50, v117
    v_sub_u32 v118, v116, v118
    v_mul_u32_u24 v117, 0x28000, v117
    v_lshl_add_u32 v207, v118, 4, v117
    v_add_u32 v116, 0xc0, v1
    v_mul_u32_u24 v117, 0x3334, v116
    v_lshrrev_b32 v117, 20, v117
    v_mul_u32_u24 v118, 0x50, v117
    v_sub_u32 v118, v116, v118
    v_mul_u32_u24 v117, 0x28000, v117
    v_lshl_add_u32 v208, v118, 4, v117
    v_add_u32 v116, 0x100, v1
    v_mul_u32_u24 v117, 0x3334, v116
    v_lshrrev_b32 v117, 20, v117
    v_mul_u32_u24 v118, 0x50, v117
    v_sub_u32 v118, v116, v118
    v_mul_u32_u24 v117, 0x28000, v117
    v_lshl_add_u32 v209, v118, 4, v117
    s_mul_i32 s17, s16, 0x1400
    s_add_u32 s17, s17, s46
    v_add_u32 v212, s17, v214
L_q_j_3:
    s_waitcnt vmcnt(4) lgkmcnt(0)
    s_barrier
    ds_read_b128 v[60:63], v186
    ds_read_b64_tr_b16 v[128:129], v190
    ds_read_b64_tr_b16 v[130:131], v190 offset:1280
    ds_read_b64_tr_b16 v[132:133], v190 offset:64
    ds_read_b64_tr_b16 v[134:135], v190 offset:1344
    ds_read_b64_tr_b16 v[136:137], v190 offset:256
    ds_read_b64_tr_b16 v[138:139], v190 offset:1536
    ds_read_b128 v[64:67], v187
    ds_read_b64_tr_b16 v[140:141], v191
    ds_read_b64_tr_b16 v[142:143], v191 offset:1280
    ds_read_b64_tr_b16 v[144:145], v191 offset:64
    ds_read_b64_tr_b16 v[146:147], v191 offset:1344
    ds_read_b64_tr_b16 v[148:149], v191 offset:256
    ds_read_b64_tr_b16 v[150:151], v191 offset:1536
    s_waitcnt lgkmcnt(11)
    v_mfma_f32_32x32x16_bf16 v[12:27], v[128:131], v[60:63], 0
    ds_read_b128 v[68:71], v188
    ds_read_b64_tr_b16 v[152:153], v192
    ds_read_b64_tr_b16 v[154:155], v192 offset:1280
    v_lshlrev_b32 v182, 16, v60
    v_and_b32 v183, 0xffff0000, v60
    v_fmac_f32 v180, v182, v182
    s_add_u32 m0, s29, 0x8000
    s_add_u32 s17, s28, 0x100
    buffer_load_dwordx4 v6, s[20:23], s17 offen lds
    v_mfma_f32_16x16x32_bf16 v[164:167], v[176:179], v[128:131], 0
    s_waitcnt lgkmcnt(12)
    v_mfma_f32_32x32x16_bf16 v[28:43], v[132:135], v[60:63], 0
    ds_read_b64_tr_b16 v[156:157], v192 offset:64
    ds_read_b64_tr_b16 v[158:159], v192 offset:1344
    v_fmac_f32 v181, v183, v183
    v_lshlrev_b32 v184, 16, v61
    v_and_b32 v185, 0xffff0000, v61
    s_waitcnt lgkmcnt(12)
    v_mfma_f32_32x32x16_bf16 v[44:59], v[136:139], v[60:63], 0
    ds_read_b64_tr_b16 v[160:161], v192 offset:256
    ds_read_b64_tr_b16 v[162:163], v192 offset:1536
    v_fmac_f32 v180, v184, v184
    v_fmac_f32 v181, v185, v185
    s_add_u32 m0, s29, 0x8400
    s_add_u32 s17, s28, 0x100
    buffer_load_dwordx4 v7, s[20:23], s17 offen lds
    s_waitcnt lgkmcnt(11)
    v_mfma_f32_32x32x16_bf16 v[12:27], v[140:143], v[64:67], v[12:27]
    ds_read_b128 v[60:63], v189
    ds_read_b64_tr_b16 v[128:129], v193
    ds_read_b64_tr_b16 v[130:131], v193 offset:1280
    v_lshlrev_b32 v182, 16, v64
    v_and_b32 v183, 0xffff0000, v64
    v_fmac_f32 v180, v182, v182
    s_add_u32 m0, s29, 0x8800
    s_add_u32 s17, s28, 0x100
    buffer_load_dwordx4 v8, s[20:23], s17 offen lds
    s_waitcnt lgkmcnt(12)
    v_mfma_f32_32x32x16_bf16 v[28:43], v[144:147], v[64:67], v[28:43]
    ds_read_b64_tr_b16 v[132:133], v193 offset:64
    ds_read_b64_tr_b16 v[134:135], v193 offset:1344
    v_fmac_f32 v181, v183, v183
    v_lshlrev_b32 v184, 16, v65
    v_and_b32 v185, 0xffff0000, v65
    v_mfma_f32_16x16x32_bf16 v[168:171], v[176:179], v[144:147], 0
    s_waitcnt lgkmcnt(12)
    v_mfma_f32_32x32x16_bf16 v[44:59], v[148:151], v[64:67], v[44:59]
    ds_read_b64_tr_b16 v[136:137], v193 offset:256
    ds_read_b64_tr_b16 v[138:139], v193 offset:1536
    v_fmac_f32 v180, v184, v184
    v_fmac_f32 v181, v185, v185
    s_add_u32 m0, s29, 0x8c00
    s_add_u32 s17, s28, 0x100
    buffer_load_dwordx4 v9, s[20:23], s17 offen lds
    s_waitcnt vmcnt(4)
    s_barrier
    s_waitcnt lgkmcnt(11)
    v_mfma_f32_32x32x16_bf16 v[12:27], v[152:155], v[68:71], v[12:27]
    ds_read_b128 v[64:67], v186 offset:16384
    ds_read_b64_tr_b16 v[140:141], v190 offset:20480
    ds_read_b64_tr_b16 v[142:143], v190 offset:21760
    v_lshlrev_b32 v182, 16, v68
    v_and_b32 v183, 0xffff0000, v68
    v_fmac_f32 v180, v182, v182
    s_add_u32 m0, s29, 0xc000
    s_add_u32 s17, s28, 0x180
    buffer_load_dwordx4 v6, s[20:23], s17 offen lds
    s_waitcnt lgkmcnt(12)
    v_mfma_f32_32x32x16_bf16 v[28:43], v[156:159], v[68:71], v[28:43]
    ds_read_b64_tr_b16 v[144:145], v190 offset:20544
    ds_read_b64_tr_b16 v[146:147], v190 offset:21824
    v_fmac_f32 v181, v183, v183
    v_lshlrev_b32 v184, 16, v69
    v_and_b32 v185, 0xffff0000, v69
    s_waitcnt lgkmcnt(12)
    v_mfma_f32_32x32x16_bf16 v[44:59], v[160:163], v[68:71], v[44:59]
    ds_read_b64_tr_b16 v[148:149], v190 offset:20736
    ds_read_b64_tr_b16 v[150:151], v190 offset:22016
    v_fmac_f32 v180, v184, v184
    v_fmac_f32 v181, v185, v185
    s_add_u32 m0, s29, 0xc400
    s_add_u32 s17, s28, 0x180
    buffer_load_dwordx4 v7, s[20:23], s17 offen lds
    v_mfma_f32_16x16x32_bf16 v[172:175], v[176:179], v[160:163], 0
    s_waitcnt lgkmcnt(11)
    v_mfma_f32_32x32x16_bf16 v[12:27], v[128:131], v[60:63], v[12:27]
    ds_read_b128 v[68:71], v187 offset:16384
    ds_read_b64_tr_b16 v[152:153], v191 offset:20480
    ds_read_b64_tr_b16 v[154:155], v191 offset:21760
    v_lshlrev_b32 v182, 16, v60
    v_and_b32 v183, 0xffff0000, v60
    v_fmac_f32 v180, v182, v182
    s_add_u32 m0, s29, 0xc800
    s_add_u32 s17, s28, 0x180
    buffer_load_dwordx4 v8, s[20:23], s17 offen lds
    s_waitcnt lgkmcnt(12)
    v_mfma_f32_32x32x16_bf16 v[28:43], v[132:135], v[60:63], v[28:43]
    ds_read_b64_tr_b16 v[156:157], v191 offset:20544
    ds_read_b64_tr_b16 v[158:159], v191 offset:21824
    v_fmac_f32 v181, v183, v183
    v_lshlrev_b32 v184, 16, v61
    v_and_b32 v185, 0xffff0000, v61
    s_waitcnt lgkmcnt(12)
    v_mfma_f32_32x32x16_bf16 v[44:59], v[136:139], v[60:63], v[44:59]
    ds_read_b64_tr_b16 v[160:161], v191 offset:20736
    ds_read_b64_tr_b16 v[162:163], v191 offset:22016
    v_fmac_f32 v180, v184, v184
    v_fmac_f32 v181, v185, v185
    s_add_u32 m0, s29, 0xcc00
    s_add_u32 s17, s28, 0x180
    buffer_load_dwordx4 v9, s[20:23], s17 offen lds
    s_waitcnt lgkmcnt(11)
    v_mfma_f32_32x32x16_bf16 v[12:27], v[140:143], v[64:67], v[12:27]
    ds_read_b128 v[60:63], v188 offset:16384
    ds_read_b64_tr_b16 v[128:129], v192 offset:20480
    ds_read_b64_tr_b16 v[130:131], v192 offset:21760
    v_lshlrev_b32 v182, 16, v64
    v_and_b32 v183, 0xffff0000, v64
    v_fmac_f32 v180, v182, v182
    v_mfma_f32_16x16x32_bf16 v[164:167], v[176:179], v[140:143], v[164:167]
    s_waitcnt lgkmcnt(12)
    v_mfma_f32_32x32x16_bf16 v[28:43], v[144:147], v[64:67], v[28:43]
    ds_read_b64_tr_b16 v[132:133], v192 offset:20544
    ds_read_b64_tr_b16 v[134:135], v192 offset:21824
    v_fmac_f32 v181, v183, v183
    v_lshlrev_b32 v184, 16, v65
    v_and_b32 v185, 0xffff0000, v65
    s_waitcnt lgkmcnt(12)
    v_mfma_f32_32x32x16_bf16 v[44:59], v[148:151], v[64:67], v[44:59]
    ds_read_b64_tr_b16 v[136:137], v192 offset:20736
    ds_read_b64_tr_b16 v[138:139], v192 offset:22016
    v_fmac_f32 v180, v184, v184
    v_fmac_f32 v181, v185, v185
    s_waitcnt lgkmcnt(11)
    v_mfma_f32_32x32x16_bf16 v[12:27], v[152:155], v[68:71], v[12:27]
    ds_read_b128 v[64:67], v189 offset:16384
    ds_read_b64_tr_b16 v[140:141], v193 offset:20480
    ds_read_b64_tr_b16 v[142:143], v193 offset:21760
    v_lshlrev_b32 v182, 16, v68
    v_and_b32 v183, 0xffff0000, v68
    v_fmac_f32 v180, v182, v182
    s_waitcnt lgkmcnt(12)
    v_mfma_f32_32x32x16_bf16 v[28:43], v[156:159], v[68:71], v[28:43]
    ds_read_b64_tr_b16 v[144:145], v193 offset:20544
    ds_read_b64_tr_b16 v[146:147], v193 offset:21824
    v_fmac_f32 v181, v183, v183
    v_lshlrev_b32 v184, 16, v69
    v_and_b32 v185, 0xffff0000, v69
    v_mfma_f32_16x16x32_bf16 v[168:171], v[176:179], v[156:159], v[168:171]
    s_waitcnt lgkmcnt(12)
    v_mfma_f32_32x32x16_bf16 v[44:59], v[160:163], v[68:71], v[44:59]
    ds_read_b64_tr_b16 v[148:149], v193 offset:20736
    ds_read_b64_tr_b16 v[150:151], v193 offset:22016
    v_fmac_f32 v180, v184, v184
    v_fmac_f32 v181, v185, v185
    s_waitcnt vmcnt(4)
    s_barrier
    s_waitcnt lgkmcnt(11)
    v_mfma_f32_32x32x16_bf16 v[12:27], v[128:131], v[60:63], v[12:27]
    ds_read_b128 v[68:71], v186 offset:32768
    ds_read_b64_tr_b16 v[152:153], v190 offset:40960
    ds_read_b64_tr_b16 v[154:155], v190 offset:42240
    v_lshlrev_b32 v182, 16, v60
    v_and_b32 v183, 0xffff0000, v60
    v_fmac_f32 v180, v182, v182
    s_add_u32 m0, s29, 0
    s_add_u32 s17, s28, 0x200
    buffer_load_dwordx4 v6, s[20:23], s17 offen lds
    s_waitcnt lgkmcnt(12)
    v_mfma_f32_32x32x16_bf16 v[28:43], v[132:135], v[60:63], v[28:43]
    ds_read_b64_tr_b16 v[156:157], v190 offset:41024
    ds_read_b64_tr_b16 v[158:159], v190 offset:42304
    v_fmac_f32 v181, v183, v183
    v_lshlrev_b32 v184, 16, v61
    v_and_b32 v185, 0xffff0000, v61
    s_waitcnt lgkmcnt(12)
    v_mfma_f32_32x32x16_bf16 v[44:59], v[136:139], v[60:63], v[44:59]
    ds_read_b64_tr_b16 v[160:161], v190 offset:41216
    ds_read_b64_tr_b16 v[162:163], v190 offset:42496
    v_fmac_f32 v180, v184, v184
    v_fmac_f32 v181, v185, v185
    s_add_u32 m0, s29, 0x400
    s_add_u32 s17, s28, 0x200
    buffer_load_dwordx4 v7, s[20:23], s17 offen lds
    v_mfma_f32_16x16x32_bf16 v[172:175], v[176:179], v[136:139], v[172:175]
    s_waitcnt lgkmcnt(11)
    v_mfma_f32_32x32x16_bf16 v[12:27], v[140:143], v[64:67], v[12:27]
    ds_read_b128 v[60:63], v187 offset:32768
    ds_read_b64_tr_b16 v[128:129], v191 offset:40960
    ds_read_b64_tr_b16 v[130:131], v191 offset:42240
    v_lshlrev_b32 v182, 16, v64
    v_and_b32 v183, 0xffff0000, v64
    v_fmac_f32 v180, v182, v182
    s_add_u32 m0, s29, 0x800
    s_add_u32 s17, s28, 0x200
    buffer_load_dwordx4 v8, s[20:23], s17 offen lds
    s_waitcnt lgkmcnt(12)
    v_mfma_f32_32x32x16_bf16 v[28:43], v[144:147], v[64:67], v[28:43]
    ds_read_b64_tr_b16 v[132:133], v191 offset:41024
    ds_read_b64_tr_b16 v[134:135], v191 offset:42304
    v_fmac_f32 v181, v183, v183
    v_lshlrev_b32 v184, 16, v65
    v_and_b32 v185, 0xffff0000, v65
    s_waitcnt lgkmcnt(12)
    v_mfma_f32_32x32x16_bf16 v[44:59], v[148:151], v[64:67], v[44:59]
    ds_read_b64_tr_b16 v[136:137], v191 offset:41216
    ds_read_b64_tr_b16 v[138:139], v191 offset:42496
    v_fmac_f32 v180, v184, v184
    v_fmac_f32 v181, v185, v185
    s_add_u32 m0, s29, 0xc00
    s_add_u32 s17, s28, 0x200
    buffer_load_dwordx4 v9, s[20:23], s17 offen lds
    s_waitcnt lgkmcnt(11)
    v_mfma_f32_32x32x16_bf16 v[12:27], v[152:155], v[68:71], v[12:27]
    ds_read_b128 v[64:67], v188 offset:32768
    ds_read_b64_tr_b16 v[140:141], v192 offset:40960
    ds_read_b64_tr_b16 v[142:143], v192 offset:42240
    v_lshlrev_b32 v182, 16, v68
    v_and_b32 v183, 0xffff0000, v68
    v_fmac_f32 v180, v182, v182
    v_mfma_f32_16x16x32_bf16 v[164:167], v[176:179], v[152:155], v[164:167]
    s_waitcnt lgkmcnt(12)
    v_mfma_f32_32x32x16_bf16 v[28:43], v[156:159], v[68:71], v[28:43]
    ds_read_b64_tr_b16 v[144:145], v192 offset:41024
    ds_read_b64_tr_b16 v[146:147], v192 offset:42304
    v_fmac_f32 v181, v183, v183
    v_lshlrev_b32 v184, 16, v69
    v_and_b32 v185, 0xffff0000, v69
    s_waitcnt lgkmcnt(12)
    v_mfma_f32_32x32x16_bf16 v[44:59], v[160:163], v[68:71], v[44:59]
    ds_read_b64_tr_b16 v[148:149], v192 offset:41216
    ds_read_b64_tr_b16 v[150:151], v192 offset:42496
    v_fmac_f32 v180, v184, v184
    v_fmac_f32 v181, v185, v185
    s_waitcnt lgkmcnt(11)
    v_mfma_f32_32x32x16_bf16 v[12:27], v[128:131], v[60:63], v[12:27]
    ds_read_b128 v[68:71], v189 offset:32768
    ds_read_b64_tr_b16 v[152:153], v193 offset:40960
    ds_read_b64_tr_b16 v[154:155], v193 offset:42240
    v_lshlrev_b32 v182, 16, v60
    v_and_b32 v183, 0xffff0000, v60
    v_fmac_f32 v180, v182, v182
    s_waitcnt lgkmcnt(12)
    v_mfma_f32_32x32x16_bf16 v[28:43], v[132:135], v[60:63], v[28:43]
    ds_read_b64_tr_b16 v[156:157], v193 offset:41024
    ds_read_b64_tr_b16 v[158:159], v193 offset:42304
    v_fmac_f32 v181, v183, v183
    v_lshlrev_b32 v184, 16, v61
    v_and_b32 v185, 0xffff0000, v61
    v_mfma_f32_16x16x32_bf16 v[168:171], v[176:179], v[132:135], v[168:171]
    s_waitcnt lgkmcnt(12)
    v_mfma_f32_32x32x16_bf16 v[44:59], v[136:139], v[60:63], v[44:59]
    ds_read_b64_tr_b16 v[160:161], v193 offset:41216
    ds_read_b64_tr_b16 v[162:163], v193 offset:42496
    v_fmac_f32 v180, v184, v184
    v_fmac_f32 v181, v185, v185
    s_waitcnt vmcnt(4)
    s_barrier
    s_waitcnt lgkmcnt(11)
    v_mfma_f32_32x32x16_bf16 v[12:27], v[140:143], v[64:67], v[12:27]
    ds_read_b128 v[60:63], v186 offset:49152
    ds_read_b64_tr_b16 v[128:129], v190 offset:61440
    ds_read_b64_tr_b16 v[130:131], v190 offset:62720
    v_lshlrev_b32 v182, 16, v64
    v_and_b32 v183, 0xffff0000, v64
    v_fmac_f32 v180, v182, v182
    s_add_u32 m0, s29, 0x4000
    s_add_u32 s17, s28, 0x280
    buffer_load_dwordx4 v6, s[20:23], s17 offen lds
    s_waitcnt lgkmcnt(12)
    v_mfma_f32_32x32x16_bf16 v[28:43], v[144:147], v[64:67], v[28:43]
    ds_read_b64_tr_b16 v[132:133], v190 offset:61504
    ds_read_b64_tr_b16 v[134:135], v190 offset:62784
    v_fmac_f32 v181, v183, v183
    v_lshlrev_b32 v184, 16, v65
    v_and_b32 v185, 0xffff0000, v65
    s_waitcnt lgkmcnt(12)
    v_mfma_f32_32x32x16_bf16 v[44:59], v[148:151], v[64:67], v[44:59]
    ds_read_b64_tr_b16 v[136:137], v190 offset:61696
    ds_read_b64_tr_b16 v[138:139], v190 offset:62976
    v_fmac_f32 v180, v184, v184
    v_fmac_f32 v181, v185, v185
    s_add_u32 m0, s29, 0x4400
    s_add_u32 s17, s28, 0x280
    buffer_load_dwordx4 v7, s[20:23], s17 offen lds
    v_mfma_f32_16x16x32_bf16 v[172:175], v[176:179], v[148:151], v[172:175]
    s_waitcnt lgkmcnt(11)
    v_mfma_f32_32x32x16_bf16 v[12:27], v[152:155], v[68:71], v[12:27]
    ds_read_b128 v[64:67], v187 offset:49152
    ds_read_b64_tr_b16 v[140:141], v191 offset:61440
    ds_read_b64_tr_b16 v[142:143], v191 offset:62720
    v_lshlrev_b32 v182, 16, v68
    v_and_b32 v183, 0xffff0000, v68
    v_fmac_f32 v180, v182, v182
    s_add_u32 m0, s29, 0x4800
    s_add_u32 s17, s28, 0x280
    buffer_load_dwordx4 v8, s[20:23], s17 offen lds
    s_waitcnt lgkmcnt(12)
    v_mfma_f32_32x32x16_bf16 v[28:43], v[156:159], v[68:71], v[28:43]
    ds_read_b64_tr_b16 v[144:145], v191 offset:61504
    ds_read_b64_tr_b16 v[146:147], v191 offset:62784
    v_fmac_f32 v181, v183, v183
    v_lshlrev_b32 v184, 16, v69
    v_and_b32 v185, 0xffff0000, v69
    s_waitcnt lgkmcnt(12)
    v_mfma_f32_32x32x16_bf16 v[44:59], v[160:163], v[68:71], v[44:59]
    ds_read_b64_tr_b16 v[148:149], v191 offset:61696
    ds_read_b64_tr_b16 v[150:151], v191 offset:62976
    v_fmac_f32 v180, v184, v184
    v_fmac_f32 v181, v185, v185
    s_add_u32 m0, s29, 0x4c00
    s_add_u32 s17, s28, 0x280
    buffer_load_dwordx4 v9, s[20:23], s17 offen lds
    s_waitcnt lgkmcnt(11)
    v_mfma_f32_32x32x16_bf16 v[12:27], v[128:131], v[60:63], v[12:27]
    ds_read_b128 v[68:71], v188 offset:49152
    ds_read_b64_tr_b16 v[152:153], v192 offset:61440
    ds_read_b64_tr_b16 v[154:155], v192 offset:62720
    v_lshlrev_b32 v182, 16, v60
    v_and_b32 v183, 0xffff0000, v60
    v_fmac_f32 v180, v182, v182
    v_mfma_f32_16x16x32_bf16 v[164:167], v[176:179], v[128:131], v[164:167]
    s_waitcnt lgkmcnt(12)
    v_mfma_f32_32x32x16_bf16 v[28:43], v[132:135], v[60:63], v[28:43]
    ds_read_b64_tr_b16 v[156:157], v192 offset:61504
    ds_read_b64_tr_b16 v[158:159], v192 offset:62784
    v_fmac_f32 v181, v183, v183
    v_lshlrev_b32 v184, 16, v61
    v_and_b32 v185, 0xffff0000, v61
    s_waitcnt lgkmcnt(12)
    v_mfma_f32_32x32x16_bf16 v[44:59], v[136:139], v[60:63], v[44:59]
    ds_read_b64_tr_b16 v[160:161], v192 offset:61696
    ds_read_b64_tr_b16 v[162:163], v192 offset:62976
    v_fmac_f32 v180, v184, v184
    v_fmac_f32 v181, v185, v185
    s_waitcnt lgkmcnt(11)
    v_mfma_f32_32x32x16_bf16 v[12:27], v[140:143], v[64:67], v[12:27]
    ds_read_b128 v[60:63], v189 offset:49152
    ds_read_b64_tr_b16 v[128:129], v193 offset:61440
    ds_read_b64_tr_b16 v[130:131], v193 offset:62720
    v_lshlrev_b32 v182, 16, v64
    v_and_b32 v183, 0xffff0000, v64
    v_fmac_f32 v180, v182, v182
    s_waitcnt lgkmcnt(12)
    v_mfma_f32_32x32x16_bf16 v[28:43], v[144:147], v[64:67], v[28:43]
    ds_read_b64_tr_b16 v[132:133], v193 offset:61504
    ds_read_b64_tr_b16 v[134:135], v193 offset:62784
    v_fmac_f32 v181, v183, v183
    v_lshlrev_b32 v184, 16, v65
    v_and_b32 v185, 0xffff0000, v65
    v_mfma_f32_16x16x32_bf16 v[168:171], v[176:179], v[144:147], v[168:171]
    s_waitcnt lgkmcnt(12)
    v_mfma_f32_32x32x16_bf16 v[44:59], v[148:151], v[64:67], v[44:59]
    ds_read_b64_tr_b16 v[136:137], v193 offset:61696
    ds_read_b64_tr_b16 v[138:139], v193 offset:62976
    v_fmac_f32 v180, v184, v184
    v_fmac_f32 v181, v185, v185
    s_waitcnt vmcnt(4)
    s_barrier
    s_waitcnt lgkmcnt(11)
    v_mfma_f32_32x32x16_bf16 v[12:27], v[152:155], v[68:71], v[12:27]
    ds_read_b128 v[64:67], v186
    ds_read_b64_tr_b16 v[140:141], v190
    ds_read_b64_tr_b16 v[142:143], v190 offset:1280
    v_lshlrev_b32 v182, 16, v68
    v_and_b32 v183, 0xffff0000, v68
    v_fmac_f32 v180, v182, v182
    s_add_u32 m0, s29, 0x8000
    s_add_u32 s17, s28, 0x300
    buffer_load_dwordx4 v6, s[20:23], s17 offen lds
    s_waitcnt lgkmcnt(12)
    v_mfma_f32_32x32x16_bf16 v[28:43], v[156:159], v[68:71], v[28:43]
    ds_read_b64_tr_b16 v[144:145], v190 offset:64
    ds_read_b64_tr_b16 v[146:147], v190 offset:1344
    v_fmac_f32 v181, v183, v183
    v_lshlrev_b32 v184, 16, v69
    v_and_b32 v185, 0xffff0000, v69
    s_waitcnt lgkmcnt(12)
    v_mfma_f32_32x32x16_bf16 v[44:59], v[160:163], v[68:71], v[44:59]
    ds_read_b64_tr_b16 v[148:149], v190 offset:256
    ds_read_b64_tr_b16 v[150:151], v190 offset:1536
    v_fmac_f32 v180, v184, v184
    v_fmac_f32 v181, v185, v185
    s_add_u32 m0, s29, 0x8400
    s_add_u32 s17, s28, 0x300
    buffer_load_dwordx4 v7, s[20:23], s17 offen lds
    v_mfma_f32_16x16x32_bf16 v[172:175], v[176:179], v[160:163], v[172:175]
    s_waitcnt lgkmcnt(11)
    v_mfma_f32_32x32x16_bf16 v[12:27], v[128:131], v[60:63], v[12:27]
    ds_read_b128 v[68:71], v187
    ds_read_b64_tr_b16 v[152:153], v191
    ds_read_b64_tr_b16 v[154:155], v191 offset:1280
    v_lshlrev_b32 v182, 16, v60
    v_and_b32 v183, 0xffff0000, v60
    v_fmac_f32 v180, v182, v182
    s_add_u32 m0, s29, 0x8800
    s_add_u32 s17, s28, 0x300
    buffer_load_dwordx4 v8, s[20:23], s17 offen lds
    s_waitcnt lgkmcnt(12)
    v_mfma_f32_32x32x16_bf16 v[28:43], v[132:135], v[60:63], v[28:43]
    ds_read_b64_tr_b16 v[156:157], v191 offset:64
    ds_read_b64_tr_b16 v[158:159], v191 offset:1344
    v_fmac_f32 v181, v183, v183
    v_lshlrev_b32 v184, 16, v61
    v_and_b32 v185, 0xffff0000, v61
    s_waitcnt lgkmcnt(12)
    v_mfma_f32_32x32x16_bf16 v[44:59], v[136:139], v[60:63], v[44:59]
    ds_read_b64_tr_b16 v[160:161], v191 offset:256
    ds_read_b64_tr_b16 v[162:163], v191 offset:1536
    v_fmac_f32 v180, v184, v184
    v_fmac_f32 v181, v185, v185
    s_add_u32 m0, s29, 0x8c00
    s_add_u32 s17, s28, 0x300
    buffer_load_dwordx4 v9, s[20:23], s17 offen lds
    s_waitcnt lgkmcnt(11)
    v_mfma_f32_32x32x16_bf16 v[12:27], v[140:143], v[64:67], v[12:27]
    ds_read_b128 v[60:63], v188
    ds_read_b64_tr_b16 v[128:129], v192
    ds_read_b64_tr_b16 v[130:131], v192 offset:1280
    v_lshlrev_b32 v182, 16, v64
    v_and_b32 v183, 0xffff0000, v64
    v_fmac_f32 v180, v182, v182
    v_mfma_f32_16x16x32_bf16 v[164:167], v[176:179], v[140:143], v[164:167]
    s_waitcnt lgkmcnt(12)
    v_mfma_f32_32x32x16_bf16 v[28:43], v[144:147], v[64:67], v[28:43]
    ds_read_b64_tr_b16 v[132:133], v192 offset:64
    ds_read_b64_tr_b16 v[134:135], v192 offset:1344
    v_fmac_f32 v181, v183, v183
    v_lshlrev_b32 v184, 16, v65
    v_and_b32 v185, 0xffff0000, v65
    s_waitcnt lgkmcnt(12)
    v_mfma_f32_32x32x16_bf16 v[44:59], v[148:151], v[64:67], v[44:59]
    ds_read_b64_tr_b16 v[136:137], v192 offset:256
    ds_read_b64_tr_b16 v[138:139], v192 offset:1536
    v_fmac_f32 v180, v184, v184
    v_fmac_f32 v181, v185, v185
    s_waitcnt lgkmcnt(11)
    v_mfma_f32_32x32x16_bf16 v[12:27], v[152:155], v[68:71], v[12:27]
    ds_read_b128 v[64:67], v189
    ds_read_b64_tr_b16 v[140:141], v193
    ds_read_b64_tr_b16 v[142:143], v193 offset:1280
    v_lshlrev_b32 v182, 16, v68
    v_and_b32 v183, 0xffff0000, v68
    v_fmac_f32 v180, v182, v182
    s_waitcnt lgkmcnt(12)
    v_mfma_f32_32x32x16_bf16 v[28:43], v[156:159], v[68:71], v[28:43]
    ds_read_b64_tr_b16 v[144:145], v193 offset:64
    ds_read_b64_tr_b16 v[146:147], v193 offset:1344
    v_fmac_f32 v181, v183, v183
    v_lshlrev_b32 v184, 16, v69
    v_and_b32 v185, 0xffff0000, v69
    v_mfma_f32_16x16x32_bf16 v[168:171], v[176:179], v[156:159], v[168:171]
    s_waitcnt lgkmcnt(12)
    v_mfma_f32_32x32x16_bf16 v[44:59], v[160:163], v[68:71], v[44:59]
    ds_read_b64_tr_b16 v[148:149], v193 offset:256
    ds_read_b64_tr_b16 v[150:151], v193 offset:1536
    v_fmac_f32 v180, v184, v184
    v_fmac_f32 v181, v185, v185
    s_waitcnt vmcnt(4)
    s_barrier
    s_waitcnt lgkmcnt(11)
    v_mfma_f32_32x32x16_bf16 v[12:27], v[128:131], v[60:63], v[12:27]
    ds_read_b128 v[68:71], v186 offset:16384
    ds_read_b64_tr_b16 v[152:153], v190 offset:20480
    ds_read_b64_tr_b16 v[154:155], v190 offset:21760
    v_lshlrev_b32 v182, 16, v60
    v_and_b32 v183, 0xffff0000, v60
    v_fmac_f32 v180, v182, v182
    s_add_u32 m0, s29, 0xc000
    s_add_u32 s17, s28, 0x380
    buffer_load_dwordx4 v6, s[20:23], s17 offen lds
    s_waitcnt lgkmcnt(12)
    v_mfma_f32_32x32x16_bf16 v[28:43], v[132:135], v[60:63], v[28:43]
    ds_read_b64_tr_b16 v[156:157], v190 offset:20544
    ds_read_b64_tr_b16 v[158:159], v190 offset:21824
    v_fmac_f32 v181, v183, v183
    v_lshlrev_b32 v184, 16, v61
    v_and_b32 v185, 0xffff0000, v61
    s_waitcnt lgkmcnt(12)
    v_mfma_f32_32x32x16_bf16 v[44:59], v[136:139], v[60:63], v[44:59]
    ds_read_b64_tr_b16 v[160:161], v190 offset:20736
    ds_read_b64_tr_b16 v[162:163], v190 offset:22016
    v_fmac_f32 v180, v184, v184
    v_fmac_f32 v181, v185, v185
    s_add_u32 m0, s29, 0xc400
    s_add_u32 s17, s28, 0x380
    buffer_load_dwordx4 v7, s[20:23], s17 offen lds
    v_mfma_f32_16x16x32_bf16 v[172:175], v[176:179], v[136:139], v[172:175]
    s_waitcnt lgkmcnt(11)
    v_mfma_f32_32x32x16_bf16 v[12:27], v[140:143], v[64:67], v[12:27]
    ds_read_b128 v[60:63], v187 offset:16384
    ds_read_b64_tr_b16 v[128:129], v191 offset:20480
    ds_read_b64_tr_b16 v[130:131], v191 offset:21760
    v_lshlrev_b32 v182, 16, v64
    v_and_b32 v183, 0xffff0000, v64
    v_fmac_f32 v180, v182, v182
    s_add_u32 m0, s29, 0xc800
    s_add_u32 s17, s28, 0x380
    buffer_load_dwordx4 v8, s[20:23], s17 offen lds
    s_waitcnt lgkmcnt(12)
    v_mfma_f32_32x32x16_bf16 v[28:43], v[144:147], v[64:67], v[28:43]
    ds_read_b64_tr_b16 v[132:133], v191 offset:20544
    ds_read_b64_tr_b16 v[134:135], v191 offset:21824
    v_fmac_f32 v181, v183, v183
    v_lshlrev_b32 v184, 16, v65
    v_and_b32 v185, 0xffff0000, v65
    s_waitcnt lgkmcnt(12)
    v_mfma_f32_32x32x16_bf16 v[44:59], v[148:151], v[64:67], v[44:59]
    ds_read_b64_tr_b16 v[136:137], v191 offset:20736
    ds_read_b64_tr_b16 v[138:139], v191 offset:22016
    v_fmac_f32 v180, v184, v184
    v_fmac_f32 v181, v185, v185
    s_add_u32 m0, s29, 0xcc00
    s_add_u32 s17, s28, 0x380
    buffer_load_dwordx4 v9, s[20:23], s17 offen lds
    s_waitcnt lgkmcnt(11)
    v_mfma_f32_32x32x16_bf16 v[12:27], v[152:155], v[68:71], v[12:27]
    ds_read_b128 v[64:67], v188 offset:16384
    ds_read_b64_tr_b16 v[140:141], v192 offset:20480
    ds_read_b64_tr_b16 v[142:143], v192 offset:21760
    v_lshlrev_b32 v182, 16, v68
    v_and_b32 v183, 0xffff0000, v68
    v_fmac_f32 v180, v182, v182
    v_mfma_f32_16x16x32_bf16 v[164:167], v[176:179], v[152:155], v[164:167]
    s_waitcnt lgkmcnt(12)
    v_mfma_f32_32x32x16_bf16 v[28:43], v[156:159], v[68:71], v[28:43]
    ds_read_b64_tr_b16 v[144:145], v192 offset:20544
    ds_read_b64_tr_b16 v[146:147], v192 offset:21824
    v_fmac_f32 v181, v183, v183
    v_lshlrev_b32 v184, 16, v69
    v_and_b32 v185, 0xffff0000, v69
    s_waitcnt lgkmcnt(12)
    v_mfma_f32_32x32x16_bf16 v[44:59], v[160:163], v[68:71], v[44:59]
    ds_read_b64_tr_b16 v[148:149], v192 offset:20736
    ds_read_b64_tr_b16 v[150:151], v192 offset:22016
    v_fmac_f32 v180, v184, v184
    v_fmac_f32 v181, v185, v185
    s_waitcnt lgkmcnt(11)
    v_mfma_f32_32x32x16_bf16 v[12:27], v[128:131], v[60:63], v[12:27]
    ds_read_b128 v[68:71], v189 offset:16384
    ds_read_b64_tr_b16 v[152:153], v193 offset:20480
    ds_read_b64_tr_b16 v[154:155], v193 offset:21760
    v_lshlrev_b32 v182, 16, v60
    v_and_b32 v183, 0xffff0000, v60
    v_fmac_f32 v180, v182, v182
    s_waitcnt lgkmcnt(12)
    v_mfma_f32_32x32x16_bf16 v[28:43], v[132:135], v[60:63], v[28:43]
    ds_read_b64_tr_b16 v[156:157], v193 offset:20544
    ds_read_b64_tr_b16 v[158:159], v193 offset:21824
    v_fmac_f32 v181, v183, v183
    v_lshlrev_b32 v184, 16, v61
    v_and_b32 v185, 0xffff0000, v61
    v_mfma_f32_16x16x32_bf16 v[168:171], v[176:179], v[132:135], v[168:171]
    s_waitcnt lgkmcnt(12)
    v_mfma_f32_32x32x16_bf16 v[44:59], v[136:139], v[60:63], v[44:59]
    ds_read_b64_tr_b16 v[160:161], v193 offset:20736
    ds_read_b64_tr_b16 v[162:163], v193 offset:22016
    v_fmac_f32 v180, v184, v184
    v_fmac_f32 v181, v185, v185
    s_waitcnt vmcnt(4)
    s_barrier
    s_waitcnt lgkmcnt(11)
    v_mfma_f32_32x32x16_bf16 v[12:27], v[140:143], v[64:67], v[12:27]
    ds_read_b128 v[60:63], v186 offset:32768
    ds_read_b64_tr_b16 v[128:129], v190 offset:40960
    ds_read_b64_tr_b16 v[130:131], v190 offset:42240
    v_lshlrev_b32 v182, 16, v64
    v_and_b32 v183, 0xffff0000, v64
    v_fmac_f32 v180, v182, v182
    s_add_u32 m0, s29, 0
    s_add_u32 s17, s28, 0x400
    buffer_load_dwordx4 v6, s[20:23], s17 offen lds
    s_waitcnt lgkmcnt(12)
    v_mfma_f32_32x32x16_bf16 v[28:43], v[144:147], v[64:67], v[28:43]
    ds_read_b64_tr_b16 v[132:133], v190 offset:41024
    ds_read_b64_tr_b16 v[134:135], v190 offset:42304
    v_fmac_f32 v181, v183, v183
    v_lshlrev_b32 v184, 16, v65
    v_and_b32 v185, 0xffff0000, v65
    s_waitcnt lgkmcnt(12)
    v_mfma_f32_32x32x16_bf16 v[44:59], v[148:151], v[64:67], v[44:59]
    ds_read_b64_tr_b16 v[136:137], v190 offset:41216
    ds_read_b64_tr_b16 v[138:139], v190 offset:42496
    v_fmac_f32 v180, v184, v184
    v_fmac_f32 v181, v185, v185
    s_add_u32 m0, s29, 0x400
    s_add_u32 s17, s28, 0x400
    buffer_load_dwordx4 v7, s[20:23], s17 offen lds
    v_mfma_f32_16x16x32_bf16 v[172:175], v[176:179], v[148:151], v[172:175]
    s_waitcnt lgkmcnt(11)
    v_mfma_f32_32x32x16_bf16 v[12:27], v[152:155], v[68:71], v[12:27]
    ds_read_b128 v[64:67], v187 offset:32768
    ds_read_b64_tr_b16 v[140:141], v191 offset:40960
    ds_read_b64_tr_b16 v[142:143], v191 offset:42240
    v_lshlrev_b32 v182, 16, v68
    v_and_b32 v183, 0xffff0000, v68
    v_fmac_f32 v180, v182, v182
    s_add_u32 m0, s29, 0x800
    s_add_u32 s17, s28, 0x400
    buffer_load_dwordx4 v8, s[20:23], s17 offen lds
    s_waitcnt lgkmcnt(12)
    v_mfma_f32_32x32x16_bf16 v[28:43], v[156:159], v[68:71], v[28:43]
    ds_read_b64_tr_b16 v[144:145], v191 offset:41024
    ds_read_b64_tr_b16 v[146:147], v191 offset:42304
    v_fmac_f32 v181, v183, v183
    v_lshlrev_b32 v184, 16, v69
    v_and_b32 v185, 0xffff0000, v69
    s_waitcnt lgkmcnt(12)
    v_mfma_f32_32x32x16_bf16 v[44:59], v[160:163], v[68:71], v[44:59]
    ds_read_b64_tr_b16 v[148:149], v191 offset:41216
    ds_read_b64_tr_b16 v[150:151], v191 offset:42496
    v_fmac_f32 v180, v184, v184
    v_fmac_f32 v181, v185, v185
    s_add_u32 m0, s29, 0xc00
    s_add_u32 s17, s28, 0x400
    buffer_load_dwordx4 v9, s[20:23], s17 offen lds
    s_waitcnt lgkmcnt(11)
    v_mfma_f32_32x32x16_bf16 v[12:27], v[128:131], v[60:63], v[12:27]
    ds_read_b128 v[68:71], v188 offset:32768
    ds_read_b64_tr_b16 v[152:153], v192 offset:40960
    ds_read_b64_tr_b16 v[154:155], v192 offset:42240
    v_lshlrev_b32 v182, 16, v60
    v_and_b32 v183, 0xffff0000, v60
    v_fmac_f32 v180, v182, v182
    v_mfma_f32_16x16x32_bf16 v[164:167], v[176:179], v[128:131], v[164:167]
    s_waitcnt lgkmcnt(12)
    v_mfma_f32_32x32x16_bf16 v[28:43], v[132:135], v[60:63], v[28:43]
    ds_read_b64_tr_b16 v[156:157], v192 offset:41024
    ds_read_b64_tr_b16 v[158:159], v192 offset:42304
    v_fmac_f32 v181, v183, v183
    v_lshlrev_b32 v184, 16, v61
    v_and_b32 v185, 0xffff0000, v61
    s_waitcnt lgkmcnt(12)
    v_mfma_f32_32x32x16_bf16 v[44:59], v[136:139], v[60:63], v[44:59]
    ds_read_b64_tr_b16 v[160:161], v192 offset:41216
    ds_read_b64_tr_b16 v[162:163], v192 offset:42496
    v_fmac_f32 v180, v184, v184
    v_fmac_f32 v181, v185, v185
    s_waitcnt lgkmcnt(11)
    v_mfma_f32_32x32x16_bf16 v[12:27], v[140:143], v[64:67], v[12:27]
    ds_read_b128 v[60:63], v189 offset:32768
    ds_read_b64_tr_b16 v[128:129], v193 offset:40960
    ds_read_b64_tr_b16 v[130:131], v193 offset:42240
    v_lshlrev_b32 v182, 16, v64
    v_and_b32 v183, 0xffff0000, v64
    v_fmac_f32 v180, v182, v182
    s_waitcnt lgkmcnt(12)
    v_mfma_f32_32x32x16_bf16 v[28:43], v[144:147], v[64:67], v[28:43]
    ds_read_b64_tr_b16 v[132:133], v193 offset:41024
    ds_read_b64_tr_b16 v[134:135], v193 offset:42304
    v_fmac_f32 v181, v183, v183
    v_lshlrev_b32 v184, 16, v65
    v_and_b32 v185, 0xffff0000, v65
    v_mfma_f32_16x16x32_bf16 v[168:171], v[176:179], v[144:147], v[168:171]
    s_waitcnt lgkmcnt(12)
    v_mfma_f32_32x32x16_bf16 v[44:59], v[148:151], v[64:67], v[44:59]
    ds_read_b64_tr_b16 v[136:137], v193 offset:41216
    ds_read_b64_tr_b16 v[138:139], v193 offset:42496
    v_fmac_f32 v180, v184, v184
    v_fmac_f32 v181, v185, v185
    s_waitcnt vmcnt(4)
    s_barrier
    s_waitcnt lgkmcnt(11)
    v_mfma_f32_32x32x16_bf16 v[12:27], v[152:155], v[68:71], v[12:27]
    ds_read_b128 v[64:67], v186 offset:49152
    ds_read_b64_tr_b16 v[140:141], v190 offset:61440
    ds_read_b64_tr_b16 v[142:143], v190 offset:62720
    v_lshlrev_b32 v182, 16, v68
    v_and_b32 v183, 0xffff0000, v68
    v_fmac_f32 v180, v182, v182
    s_waitcnt lgkmcnt(12)
    v_mfma_f32_32x32x16_bf16 v[28:43], v[156:159], v[68:71], v[28:43]
    ds_read_b64_tr_b16 v[144:145], v190 offset:61504
    ds_read_b64_tr_b16 v[146:147], v190 offset:62784
    v_fmac_f32 v181, v183, v183
    v_lshlrev_b32 v184, 16, v69
    v_and_b32 v185, 0xffff0000, v69
    s_waitcnt lgkmcnt(12)
    v_mfma_f32_32x32x16_bf16 v[44:59], v[160:163], v[68:71], v[44:59]
    ds_read_b64_tr_b16 v[148:149], v190 offset:61696
    ds_read_b64_tr_b16 v[150:151], v190 offset:62976
    v_fmac_f32 v180, v184, v184
    v_fmac_f32 v181, v185, v185
    v_mfma_f32_16x16x32_bf16 v[172:175], v[176:179], v[160:163], v[172:175]
    s_waitcnt lgkmcnt(11)
    v_mfma_f32_32x32x16_bf16 v[12:27], v[128:131], v[60:63], v[12:27]
    ds_read_b128 v[68:71], v187 offset:49152
    ds_read_b64_tr_b16 v[152:153], v191 offset:61440
    ds_read_b64_tr_b16 v[154:155], v191 offset:62720
    v_lshlrev_b32 v182, 16, v60
    v_and_b32 v183, 0xffff0000, v60
    v_fmac_f32 v180, v182, v182
    s_waitcnt lgkmcnt(12)
    v_mfma_f32_32x32x16_bf16 v[28:43], v[132:135], v[60:63], v[28:43]
    ds_read_b64_tr_b16 v[156:157], v191 offset:61504
    ds_read_b64_tr_b16 v[158:159], v191 offset:62784
    v_fmac_f32 v181, v183, v183
    v_lshlrev_b32 v184, 16, v61
    v_and_b32 v185, 0xffff0000, v61
    s_waitcnt lgkmcnt(12)
    v_mfma_f32_32x32x16_bf16 v[44:59], v[136:139], v[60:63], v[44:59]
    ds_read_b64_tr_b16 v[160:161], v191 offset:61696
    ds_read_b64_tr_b16 v[162:163], v191 offset:62976
    v_fmac_f32 v180, v184, v184
    v_fmac_f32 v181, v185, v185
    s_waitcnt lgkmcnt(11)
    v_mfma_f32_32x32x16_bf16 v[12:27], v[140:143], v[64:67], v[12:27]
    ds_read_b128 v[60:63], v188 offset:49152
    ds_read_b64_tr_b16 v[128:129], v192 offset:61440
    ds_read_b64_tr_b16 v[130:131], v192 offset:62720
    v_lshlrev_b32 v182, 16, v64
    v_and_b32 v183, 0xffff0000, v64
    v_fmac_f32 v180, v182, v182
    v_mfma_f32_16x16x32_bf16 v[164:167], v[176:179], v[140:143], v[164:167]
    s_waitcnt lgkmcnt(12)
    v_mfma_f32_32x32x16_bf16 v[28:43], v[144:147], v[64:67], v[28:43]
    ds_read_b64_tr_b16 v[132:133], v192 offset:61504
    ds_read_b64_tr_b16 v[134:135], v192 offset:62784
    v_fmac_f32 v181, v183, v183
    v_lshlrev_b32 v184, 16, v65
    v_and_b32 v185, 0xffff0000, v65
    s_waitcnt lgkmcnt(12)
    v_mfma_f32_32x32x16_bf16 v[44:59], v[148:151], v[64:67], v[44:59]
    ds_read_b64_tr_b16 v[136:137], v192 offset:61696
    ds_read_b64_tr_b16 v[138:139], v192 offset:62976
    v_fmac_f32 v180, v184, v184
    v_fmac_f32 v181, v185, v185
    s_waitcnt lgkmcnt(11)
    v_mfma_f32_32x32x16_bf16 v[12:27], v[152:155], v[68:71], v[12:27]
    ds_read_b128 v[64:67], v189 offset:49152
    ds_read_b64_tr_b16 v[140:141], v193 offset:61440
    ds_read_b64_tr_b16 v[142:143], v193 offset:62720
    v_lshlrev_b32 v182, 16, v68
    v_and_b32 v183, 0xffff0000, v68
    v_fmac_f32 v180, v182, v182
    s_waitcnt lgkmcnt(12)
    v_mfma_f32_32x32x16_bf16 v[28:43], v[156:159], v[68:71], v[28:43]
    ds_read_b64_tr_b16 v[144:145], v193 offset:61504
    ds_read_b64_tr_b16 v[146:147], v193 offset:62784
    v_fmac_f32 v181, v183, v183
    v_lshlrev_b32 v184, 16, v69
    v_and_b32 v185, 0xffff0000, v69
    v_mfma_f32_16x16x32_bf16 v[168:171], v[176:179], v[156:159], v[168:171]
    s_waitcnt lgkmcnt(12)
    v_mfma_f32_32x32x16_bf16 v[44:59], v[160:163], v[68:71], v[44:59]
    ds_read_b64_tr_b16 v[148:149], v193 offset:61696
    ds_read_b64_tr_b16 v[150:151], v193 offset:62976
    v_fmac_f32 v180, v184, v184
    v_fmac_f32 v181, v185, v185
    s_waitcnt vmcnt(0)
    s_barrier
    s_waitcnt lgkmcnt(11)
    v_mfma_f32_32x32x16_bf16 v[12:27], v[128:131], v[60:63], v[12:27]
    ds_read_b128 v[68:71], v186
    ds_read_b64_tr_b16 v[152:153], v190
    ds_read_b64_tr_b16 v[154:155], v190 offset:1280
    v_lshlrev_b32 v182, 16, v60
    v_and_b32 v183, 0xffff0000, v60
    v_fmac_f32 v180, v182, v182
    s_waitcnt lgkmcnt(12)
    v_mfma_f32_32x32x16_bf16 v[28:43], v[132:135], v[60:63], v[28:43]
    ds_read_b64_tr_b16 v[156:157], v190 offset:64
    ds_read_b64_tr_b16 v[158:159], v190 offset:1344
    v_fmac_f32 v181, v183, v183
    v_lshlrev_b32 v184, 16, v61
    v_and_b32 v185, 0xffff0000, v61
    s_waitcnt lgkmcnt(12)
    v_mfma_f32_32x32x16_bf16 v[44:59], v[136:139], v[60:63], v[44:59]
    ds_read_b64_tr_b16 v[160:161], v190 offset:256
    ds_read_b64_tr_b16 v[162:163], v190 offset:1536
    v_fmac_f32 v180, v184, v184
    v_fmac_f32 v181, v185, v185
    v_mfma_f32_16x16x32_bf16 v[172:175], v[176:179], v[136:139], v[172:175]
    s_waitcnt lgkmcnt(11)
    v_mfma_f32_32x32x16_bf16 v[12:27], v[140:143], v[64:67], v[12:27]
    ds_read_b128 v[60:63], v187
    ds_read_b64_tr_b16 v[128:129], v191
    ds_read_b64_tr_b16 v[130:131], v191 offset:1280
    v_lshlrev_b32 v182, 16, v64
    v_and_b32 v183, 0xffff0000, v64
    v_fmac_f32 v180, v182, v182
    s_waitcnt lgkmcnt(12)
    v_mfma_f32_32x32x16_bf16 v[28:43], v[144:147], v[64:67], v[28:43]
    ds_read_b64_tr_b16 v[132:133], v191 offset:64
    ds_read_b64_tr_b16 v[134:135], v191 offset:1344
    v_fmac_f32 v181, v183, v183
    v_lshlrev_b32 v184, 16, v65
    v_and_b32 v185, 0xffff0000, v65
    s_waitcnt lgkmcnt(12)
    v_mfma_f32_32x32x16_bf16 v[44:59], v[148:151], v[64:67], v[44:59]
    ds_read_b64_tr_b16 v[136:137], v191 offset:256
    ds_read_b64_tr_b16 v[138:139], v191 offset:1536
    v_fmac_f32 v180, v184, v184
    v_fmac_f32 v181, v185, v185
    s_waitcnt lgkmcnt(11)
    v_mfma_f32_32x32x16_bf16 v[12:27], v[152:155], v[68:71], v[12:27]
    ds_read_b128 v[64:67], v188
    ds_read_b64_tr_b16 v[140:141], v192
    ds_read_b64_tr_b16 v[142:143], v192 offset:1280
    v_lshlrev_b32 v182, 16, v68
    v_and_b32 v183, 0xffff0000, v68
    v_fmac_f32 v180, v182, v182
    v_mfma_f32_16x16x32_bf16 v[164:167], v[176:179], v[152:155], v[164:167]
    s_waitcnt lgkmcnt(12)
    v_mfma_f32_32x32x16_bf16 v[28:43], v[156:159], v[68:71], v[28:43]
    ds_read_b64_tr_b16 v[144:145], v192 offset:64
    ds_read_b64_tr_b16 v[146:147], v192 offset:1344
    v_fmac_f32 v181, v183, v183
    v_lshlrev_b32 v184, 16, v69
    v_and_b32 v185, 0xffff0000, v69
    s_waitcnt lgkmcnt(12)
    v_mfma_f32_32x32x16_bf16 v[44:59], v[160:163], v[68:71], v[44:59]
    ds_read_b64_tr_b16 v[148:149], v192 offset:256
    ds_read_b64_tr_b16 v[150:151], v192 offset:1536
    v_fmac_f32 v180, v184, v184
    v_fmac_f32 v181, v185, v185
    s_waitcnt lgkmcnt(11)
    v_mfma_f32_32x32x16_bf16 v[12:27], v[128:131], v[60:63], v[12:27]
    ds_read_b128 v[68:71], v189
    ds_read_b64_tr_b16 v[152:153], v193
    ds_read_b64_tr_b16 v[154:155], v193 offset:1280
    v_lshlrev_b32 v182, 16, v60
    v_and_b32 v183, 0xffff0000, v60
    v_fmac_f32 v180, v182, v182
    s_waitcnt lgkmcnt(12)
    v_mfma_f32_32x32x16_bf16 v[28:43], v[132:135], v[60:63], v[28:43]
    ds_read_b64_tr_b16 v[156:157], v193 offset:64
    ds_read_b64_tr_b16 v[158:159], v193 offset:1344
    v_fmac_f32 v181, v183, v183
    v_lshlrev_b32 v184, 16, v61
    v_and_b32 v185, 0xffff0000, v61
    v_mfma_f32_16x16x32_bf16 v[168:171], v[176:179], v[132:135], v[168:171]
    s_waitcnt lgkmcnt(12)
    v_mfma_f32_32x32x16_bf16 v[44:59], v[136:139], v[60:63], v[44:59]
    ds_read_b64_tr_b16 v[160:161], v193 offset:256
    ds_read_b64_tr_b16 v[162:163], v193 offset:1536
    v_fmac_f32 v180, v184, v184
    v_fmac_f32 v181, v185, v185
    s_waitcnt lgkmcnt(11)
    v_mfma_f32_32x32x16_bf16 v[12:27], v[140:143], v[64:67], v[12:27]
    v_lshlrev_b32 v182, 16, v64
    v_and_b32 v183, 0xffff0000, v64
    v_fmac_f32 v180, v182, v182
    s_waitcnt lgkmcnt(9)
    v_mfma_f32_32x32x16_bf16 v[28:43], v[144:147], v[64:67], v[28:43]
    v_fmac_f32 v181, v183, v183
    v_lshlrev_b32 v184, 16, v65
    v_and_b32 v185, 0xffff0000, v65
    s_waitcnt lgkmcnt(7)
    v_mfma_f32_32x32x16_bf16 v[44:59], v[148:151], v[64:67], v[44:59]
    v_fmac_f32 v180, v184, v184
    v_fmac_f32 v181, v185, v185
    v_mfma_f32_16x16x32_bf16 v[172:175], v[176:179], v[148:151], v[172:175]
    s_waitcnt lgkmcnt(4)
    v_mfma_f32_32x32x16_bf16 v[12:27], v[152:155], v[68:71], v[12:27]
    v_lshlrev_b32 v182, 16, v68
    v_and_b32 v183, 0xffff0000, v68
    v_fmac_f32 v180, v182, v182
    s_waitcnt lgkmcnt(2)
    v_mfma_f32_32x32x16_bf16 v[28:43], v[156:159], v[68:71], v[28:43]
    v_fmac_f32 v181, v183, v183
    v_lshlrev_b32 v184, 16, v69
    v_and_b32 v185, 0xffff0000, v69
    s_waitcnt lgkmcnt(0)
    v_mfma_f32_32x32x16_bf16 v[44:59], v[160:163], v[68:71], v[44:59]
    v_fmac_f32 v180, v184, v184
    v_fmac_f32 v181, v185, v185
    v_add_f32 v180, v180, v181
    v_mov_b32 v72, v180
    v_lshlrev_b32 v3, 4, v2
    s_lshl_b32 s17, s15, 9
    s_add_u32 s17, s17, 0x24a00
    v_add_u32 v3, s17, v3
    v_permlane32_swap_b32 v180, v72
    v_lshlrev_b32 v4, 4, v1
    s_lshl_b32 s17, s15, 2
    s_add_u32 s17, s17, 0x24000
    v_add_u32 v4, s17, v4
    v_add_f32 v180, v180, v72
    ds_write_b32 v3, v180
    ds_write_b32 v3, v52 offset:8
    s_mov_b64 exec, 0xffff
    ds_write_b32 v4, v164
    ds_write_b32 v4, v165 offset:256
    ds_write_b32 v4, v168 offset:512
    ds_write_b32 v4, v169 offset:768
    ds_write_b32 v4, v172 offset:2048
    ds_write_b32 v4, v173 offset:2304
    s_mov_b64 exec, -1
    v_lshlrev_b32 v4, 4, v2
    v_add_u32 v4, 0x24000, v4
    s_waitcnt lgkmcnt(0)
    s_barrier
    ds_read_b128 v[72:75], v3
    ds_read_b128 v[128:131], v4
    ds_read_b128 v[132:135], v4 offset:512
    ds_read_b128 v[136:139], v4 offset:2048
    s_waitcnt lgkmcnt(3)
    v_add_f32 v72, v72, v73
    v_mul_f32 v74, 0xbae38e39, v74
    v_mul_f32 v72, 0x3ae38e39, v72
    v_fma_f32 v72, -v74, v74, v72
    v_max_f32 v72, 0, v72
    v_add_f32 v72, 0x3727c5ac, v72
    v_rsq_f32 v73, v72
    v_cvt_pk_bf16_f32 v76, v74, v74
    v_lshlrev_b32 v76, 16, v76
    v_sub_f32 v77, v74, v76
    v_cvt_pk_bf16_f32 v88, v76, v77
    s_mov_b32 exec_lo, 0
    v_mov_b32 v88, 0
    s_mov_b32 exec_lo, -1
    v_mov_b32 v89, v88
    v_mul_f32 v73, s43, v73
    s_waitcnt lgkmcnt(2)
    v_add_f32 v128, v128, v129
    v_add_f32 v130, v130, v131
    v_add_f32 v128, v128, v130
    v_cvt_pk_bf16_f32 v140, v128, v128
    v_lshlrev_b32 v142, 16, v140
    v_sub_f32 v142, v128, v142
    v_cvt_pk_bf16_f32 v141, v142, v142
    s_nop 1
    v_mfma_f32_32x32x8_bf16 v[12:27], v[140:141], v[88:89], v[12:27]
    s_waitcnt lgkmcnt(1)
    v_add_f32 v132, v132, v133
    v_add_f32 v134, v134, v135
    v_add_f32 v132, v132, v134
    v_cvt_pk_bf16_f32 v144, v132, v132
    v_lshlrev_b32 v146, 16, v144
    v_sub_f32 v146, v132, v146
    v_cvt_pk_bf16_f32 v145, v146, v146
    s_nop 1
    v_mfma_f32_32x32x8_bf16 v[28:43], v[144:145], v[88:89], v[28:43]
    s_waitcnt lgkmcnt(0)
    v_add_f32 v136, v136, v137
    v_add_f32 v138, v138, v139
    v_add_f32 v136, v136, v138
    v_cvt_pk_bf16_f32 v148, v136, v136
    v_lshlrev_b32 v150, 16, v148
    v_sub_f32 v150, v136, v150
    v_cvt_pk_bf16_f32 v149, v150, v150
    s_nop 1
    v_mfma_f32_32x32x8_bf16 v[44:59], v[148:149], v[88:89], v[44:59]
    v_mul_f32 v12, v12, v73
    v_mul_f32 v13, v13, v73
    v_mul_f32 v14, v14, v73
    v_mul_f32 v15, v15, v73
    v_cvt_pk_bf16_f32 v80, v12, v13
    v_cvt_pk_bf16_f32 v81, v14, v15
    ds_write_b64 v213, v[80:81]
    v_mul_f32 v16, v16, v73
    v_mul_f32 v17, v17, v73
    v_mul_f32 v18, v18, v73
    v_mul_f32 v19, v19, v73
    v_cvt_pk_bf16_f32 v84, v16, v17
    v_cvt_pk_bf16_f32 v85, v18, v19
    ds_write_b64 v213, v[84:85] offset:16
    v_mul_f32 v20, v20, v73
    v_mul_f32 v21, v21, v73
    v_mul_f32 v22, v22, v73
    v_mul_f32 v23, v23, v73
    v_cvt_pk_bf16_f32 v80, v20, v21
    v_cvt_pk_bf16_f32 v81, v22, v23
    ds_write_b64 v213, v[80:81] offset:32
    v_mul_f32 v24, v24, v73
    v_mul_f32 v25, v25, v73
    v_mul_f32 v26, v26, v73
    v_mul_f32 v27, v27, v73
    v_cvt_pk_bf16_f32 v84, v24, v25
    v_cvt_pk_bf16_f32 v85, v26, v27
    ds_write_b64 v213, v[84:85] offset:48
    v_mul_f32 v28, v28, v73
    v_mul_f32 v29, v29, v73
    v_mul_f32 v30, v30, v73
    v_mul_f32 v31, v31, v73
    v_cvt_pk_bf16_f32 v80, v28, v29
    v_cvt_pk_bf16_f32 v81, v30, v31
    ds_write_b64 v213, v[80:81] offset:64
    v_mul_f32 v32, v32, v73
    v_mul_f32 v33, v33, v73
    v_mul_f32 v34, v34, v73
    v_mul_f32 v35, v35, v73
    v_cvt_pk_bf16_f32 v84, v32, v33
    v_cvt_pk_bf16_f32 v85, v34, v35
    ds_write_b64 v213, v[84:85] offset:80
    v_mul_f32 v36, v36, v73
    v_mul_f32 v37, v37, v73
    v_mul_f32 v38, v38, v73
    v_mul_f32 v39, v39, v73
    v_cvt_pk_bf16_f32 v80, v36, v37
    v_cvt_pk_bf16_f32 v81, v38, v39
    ds_write_b64 v213, v[80:81] offset:96
    v_mul_f32 v40, v40, v73
    v_mul_f32 v41, v41, v73
    v_mul_f32 v42, v42, v73
    v_mul_f32 v43, v43, v73
    v_cvt_pk_bf16_f32 v84, v40, v41
    v_cvt_pk_bf16_f32 v85, v42, v43
    ds_write_b64 v213, v[84:85] offset:112
    v_mul_f32 v44, v44, v73
    v_mul_f32 v45, v45, v73
    v_mul_f32 v46, v46, v73
    v_mul_f32 v47, v47, v73
    v_cvt_pk_bf16_f32 v80, v44, v45
    v_cvt_pk_bf16_f32 v81, v46, v47
    ds_write_b64 v213, v[80:81] offset:256
    v_mul_f32 v48, v48, v73
    v_mul_f32 v49, v49, v73
    v_mul_f32 v50, v50, v73
    v_mul_f32 v51, v51, v73
    v_cvt_pk_bf16_f32 v84, v48, v49
    v_cvt_pk_bf16_f32 v85, v50, v51
    ds_write_b64 v213, v[84:85] offset:272
    s_waitcnt lgkmcnt(0)
    s_barrier
    s_branch L_qkv_out
L_qkv_c1:
    v_add_u32 v3, 0, v1
    v_mul_u32_u24 v4, 0xcccd, v3
    v_lshrrev_b32 v4, 20, v4
    v_mul_u32_u24 v5, 20, v4
    v_sub_u32 v5, v3, v5
    v_mul_u32_u24 v4, 0xd80, v4
    v_lshl_add_u32 v6, v5, 4, v4
    s_mov_b32 s30, 0xfff3ffff
    s_mov_b32 s31, 0xf3ffff3f
    v_add_u32 v3, 64, v1
    v_mul_u32_u24 v4, 0xcccd, v3
    v_lshrrev_b32 v4, 20, v4
    v_mul_u32_u24 v5, 20, v4
    v_sub_u32 v5, v3, v5
    v_mul_u32_u24 v4, 0xd80, v4
    v_lshl_add_u32 v7, v5, 4, v4
    s_mov_b32 s32, 0xffff3fff
    s_mov_b32 s33, 0xff3ffff3
    v_add_u32 v3, 0x80, v1
    v_mul_u32_u24 v4, 0xcccd, v3
    v_lshrrev_b32 v4, 20, v4
    v_mul_u32_u24 v5, 20, v4
    v_sub_u32 v5, v3, v5
    v_mul_u32_u24 v4, 0xd80, v4
    v_lshl_add_u32 v8, v5, 4, v4
    s_mov_b32 s34, 0x3ffff3ff
    s_mov_b32 s35, 0xfff3ffff
    v_add_u32 v3, 0xc0, v1
    v_mul_u32_u24 v4, 0xcccd, v3
    v_lshrrev_b32 v4, 20, v4
    v_mul_u32_u24 v5, 20, v4
    v_sub_u32 v5, v3, v5
    v_mul_u32_u24 v4, 0xd80, v4
    v_lshl_add_u32 v9, v5, 4, v4
    s_mov_b32 s36, 0xf3ffff3f
    s_mov_b32 s37, 0xffff3fff
    v_add_u32 v3, 0x100, v1
    v_mul_u32_u24 v4, 0xcccd, v3
    v_lshrrev_b32 v4, 20, v4
    v_mul_u32_u24 v5, 20, v4
    v_sub_u32 v5, v3, v5
    v_mul_u32_u24 v4, 0xd80, v4
    v_lshl_add_u32 v10, v5, 4, v4
    s_mov_b32 s38, 0xff3ffff3
    s_mov_b32 s39, 0x3ffff3ff
    s_mul_i32 s28, s13, 0x120
    s_mul_i32 s17, s15, 0xd800
    s_add_u32 s28, s28, s17
    s_mul_i32 s29, s15, 0x1400
    s_waitcnt lgkmcnt(0)
    s_mov_b32 s20, s6
    s_and_b32 s21, s7, 0xffff
    s_mov_b32 s22, 0x1e6000
    s_mov_b32 s23, 0x20000
    s_add_u32 m0, s29, 0
    s_mov_b64 exec, s[30:31]
    s_add_u32 s17, s28, 0
    buffer_load_dwordx4 v6, s[20:23], s17 offen lds
    s_mov_b64 exec, -1
    s_add_u32 m0, s29, 0x400
    s_mov_b64 exec, s[32:33]
    s_add_u32 s17, s28, 0
    buffer_load_dwordx4 v7, s[20:23], s17 offen lds
    s_mov_b64 exec, -1
    s_add_u32 m0, s29, 0x800
    s_mov_b64 exec, s[34:35]
    s_add_u32 s17, s28, 0
    buffer_load_dwordx4 v8, s[20:23], s17 offen lds
    s_mov_b64 exec, -1
    s_add_u32 m0, s29, 0xc00
    s_mov_b64 exec, s[36:37]
    s_add_u32 s17, s28, 0
    buffer_load_dwordx4 v9, s[20:23], s17 offen lds
    s_mov_b64 exec, -1
    s_add_u32 m0, s29, 0x1000
    s_mov_b64 exec, s[38:39]
    s_add_u32 s17, s28, 0
    buffer_load_dwordx4 v10, s[20:23], s17 offen lds
    s_mov_b64 exec, -1
    s_barrier
    s_add_u32 m0, s29, 0x5000
    s_mov_b64 exec, s[30:31]
    s_add_u32 s17, s28, 0x36000
    buffer_load_dwordx4 v6, s[20:23], s17 offen lds
    s_mov_b64 exec, -1
    s_add_u32 m0, s29, 0x5400
    s_mov_b64 exec, s[32:33]
    s_add_u32 s17, s28, 0x36000
    buffer_load_dwordx4 v7, s[20:23], s17 offen lds
    s_mov_b64 exec, -1
    s_add_u32 m0, s29, 0x5800
    s_mov_b64 exec, s[34:35]
    s_add_u32 s17, s28, 0x36000
    buffer_load_dwordx4 v8, s[20:23], s17 offen lds
    s_mov_b64 exec, -1
    s_add_u32 m0, s29, 0x5c00
    s_mov_b64 exec, s[36:37]
    s_add_u32 s17, s28, 0x36000
    buffer_load_dwordx4 v9, s[20:23], s17 offen lds
    s_mov_b64 exec, -1
    s_add_u32 m0, s29, 0x6000
    s_mov_b64 exec, s[38:39]
    s_add_u32 s17, s28, 0x36000
    buffer_load_dwordx4 v10, s[20:23], s17 offen lds
    s_mov_b64 exec, -1
    s_mov_b32 s24, s8
    s_and_b32 s25, s9, 0xffff
    s_mov_b32 s26, 0x740000
    s_mov_b32 s27, 0x20000
    v_mov_b32 v196, 0x3f803f80
    v_mov_b32 v197, 0x3f803f80
    v_mov_b32 v198, 0x3f803f80
    v_mov_b32 v199, 0x3f803f80
    v_lshrrev_b32 v3, 1, v0
    v_mul_u32_u24 v3, 0x140, v3
    v_and_b32 v4, 1, v0
    v_lshl_add_u32 v3, v4, 4, v3
    ds_write_b128 v3, v[196:199] offset:288
    v_bfe_u32 v4, v2, 1, 3
    v_lshrrev_b32 v3, 5, v1
    v_xor_b32 v4, v4, v3
    v_lshlrev_b32 v5, 7, v2
    s_lshl_b32 s17, s15, 12
    s_add_u32 s17, s17, 0x14000
    v_add_u32 v5, s17, v5
    s_add_u32 s17, s15, 0
    s_and_b32 s17, s17, 3
    s_lshl_b32 s17, s17, 1
    v_xor_b32 v186, s17, v4
    v_lshl_add_u32 v186, v186, 4, v5
    s_add_u32 s17, s15, 1
    s_and_b32 s17, s17, 3
    s_lshl_b32 s17, s17, 1
    v_xor_b32 v187, s17, v4
    v_lshl_add_u32 v187, v187, 4, v5
    s_add_u32 s17, s15, 2
    s_and_b32 s17, s17, 3
    s_lshl_b32 s17, s17, 1
    v_xor_b32 v188, s17, v4
    v_lshl_add_u32 v188, v188, 4, v5
    s_add_u32 s17, s15, 3
    s_and_b32 s17, s17, 3
    s_lshl_b32 s17, s17, 1
    v_xor_b32 v189, s17, v4
    v_lshl_add_u32 v189, v189, 4, v5
    v_lshlrev_b32 v3, 3, v3
    v_bfe_u32 v4, v1, 2, 2
    v_add_u32 v3, v3, v4
    v_mul_u32_u24 v3, 0x140, v3
    v_bfe_u32 v4, v1, 4, 1
    v_lshl_add_u32 v3, v4, 5, v3
    v_and_b32 v4, 3, v1
    v_lshl_add_u32 v3, v4, 3, v3
    s_add_u32 s17, s15, 0
    s_and_b32 s17, s17, 3
    s_mul_i32 s17, s17, 0x1400
    v_add_u32 v190, s17, v3
    s_add_u32 s17, s15, 1
    s_and_b32 s17, s17, 3
    s_mul_i32 s17, s17, 0x1400
    v_add_u32 v191, s17, v3
    s_add_u32 s17, s15, 2
    s_and_b32 s17, s17, 3
    s_mul_i32 s17, s17, 0x1400
    v_add_u32 v192, s17, v3
    s_add_u32 s17, s15, 3
    s_and_b32 s17, s17, 3
    s_mul_i32 s17, s17, 0x1400
    v_add_u32 v193, s17, v3
    v_and_b32 v3, 15, v1
    v_bfe_u32 v4, v1, 4, 1
    v_cmp_eq_u32 vcc, v3, v4
    s_nop 1
    v_cndmask_b32 v176, 0, v196, vcc
    v_mov_b32 v177, v176
    v_mov_b32 v178, v176
    v_mov_b32 v179, v176
    v_mov_b32 v180, 0
    v_mov_b32 v181, 0
    v_lshlrev_b32 v214, 4, v1
    v_mov_b32 v205, v214
    v_mov_b32 v206, v214
    v_mov_b32 v207, v214
    v_mov_b32 v208, v214
    v_mov_b32 v209, v214
    v_mov_b32 v200, v214
    v_mov_b32 v201, v214
    v_mov_b32 v202, v214
    v_mov_b32 v203, v214
    v_mov_b32 v204, v214
    s_mul_i32 s40, s15, 0x5000
    s_lshr_b32 s41, s13, 2
    s_and_b32 s42, s13, 3
    s_lshl_b32 s42, s42, 3
    s_cmp_eq_u32 s41, 0
    s_cselect_b32 s43, 0x3eae1a93, 1.0
    v_lshrrev_b32 v4, 5, v1
    v_mul_u32_u24 v213, 0x128, v2
    v_lshl_add_u32 v213, v4, 3, v213
    v_add_u32 v213, s40, v213
    s_cmp_eq_u32 s41, 2
    s_cbranch_scc1 L_q_v_5
    v_and_b32 v210, 19, v2
    v_bfe_u32 v4, v2, 2, 1
    v_lshl_or_b32 v210, v4, 3, v210
    v_bfe_u32 v4, v2, 3, 1
    v_lshl_or_b32 v210, v4, 2, v210
    s_cmp_eq_u32 s41, 0
    s_cselect_b64 vcc, -1, 0
    v_cndmask_b32 v210, v210, v2, vcc
    v_mul_u32_u24 v210, 0x128, v210
    s_mul_i32 s17, s16, 0x90
    s_add_u32 s17, s17, s40
    v_add_u32 v210, s17, v210
    v_lshrrev_b32 v4, 5, v1
    v_lshl_add_u32 v210, v4, 4, v210
    s_cmp_eq_u32 s41, 0
    s_cbranch_scc0 L_q_k_6
    s_lshl_b32 s44, s16, 2
    s_add_u32 s44, s44, s42
    s_lshl_b32 s44, s44, 16
    s_lshl_b32 s17, s18, 10
    s_add_u32 s44, s44, s17
    s_add_u32 s44, s44, 0
    s_mov_b32 s45, 0x10000
    s_lshl_b32 s46, s42, 13
    s_lshl_b32 s17, s18, 7
    s_add_u32 s46, s46, s17
    s_add_u32 s46, s46, 0x200000
    v_lshrrev_b32 v4, 3, v1
    v_and_b32 v212, 7, v1
    v_lshlrev_b32 v211, 4, v212
    v_lshl_add_u32 v211, v4, 13, v211
    v_mul_u32_u24 v212, 0x4a0, v212
    v_mad_u32_u24 v212, v4, 36, v212
    v_add_u32 v212, s40, v212
    s_branch L_q_j_7
L_q_k_6:
    s_lshl_b32 s44, s16, 2
    s_add_u32 s44, s44, s42
    s_mul_i32 s44, s44, 0x28000
    s_mul_i32 s46, s18, 0xa00
    s_add_u32 s44, s44, s46
    s_add_u32 s44, s44, 0x240000
    s_mov_b32 s45, 0x28000
    s_add_u32 s46, s44, 0x400
    v_and_b32 v212, 9, v1
    v_bfe_u32 v4, v1, 1, 1
    v_lshl_or_b32 v212, v4, 2, v212
    v_bfe_u32 v4, v1, 2, 1
    v_lshl_or_b32 v212, v4, 1, v212
    v_mul_u32_u24 v212, 0x250, v212
    v_lshrrev_b32 v4, 4, v1
    v_mad_u32_u24 v212, v4, 36, v212
    v_add_u32 v212, s17, v212
    v_mul_u32_u24 v211, 0x28000, v4
    v_and_b32 v4, 15, v1
    v_lshl_add_u32 v211, v4, 4, v211
    s_branch L_q_j_7
L_q_v_5:
    v_lshrrev_b32 v4, 4, v1
    v_lshlrev_b32 v210, 3, v4
    v_bfe_u32 v5, v1, 2, 2
    v_add_u32 v210, v210, v5
    v_mul_u32_u24 v210, 0x128, v210
    v_and_b32 v5, 3, v1
    v_lshl_add_u32 v210, v5, 3, v210
    s_mul_i32 s17, s16, 0xa0
    s_add_u32 s17, s17, s40
    v_add_u32 v210, s17, v210
    s_lshl_b32 s44, s16, 2
    s_add_u32 s44, s44, s42
    s_mul_i32 s44, s44, 0x28000
    s_mul_i32 s17, s18, 0xa00
    s_add_u32 s44, s44, s17
    s_add_u32 s44, s44, 0x240500
    v_mul_u32_u24 v211, 0x140, v4
    s_add_u32 s46, s40, 0x2600
    v_add_u32 v211, s46, v211
    v_and_b32 v212, 15, v1
    s_mul_i32 s17, s16, 0x50
    v_add_u32 v212, s17, v212
    s_mov_b32 s45, 0x500
    v_add_u32 v116, 0, v212
    v_mul_u32_u24 v117, 0xe38f, v116
    v_lshrrev_b32 v117, 20, v117
    v_mul_u32_u24 v118, 18, v117
    v_sub_u32 v118, v116, v118
    v_mad_u32_u24 v117, v117, s45, v211
    v_lshl_add_u32 v200, v118, 4, v117
    v_add_u32 v116, 16, v212
    v_mul_u32_u24 v117, 0xe38f, v116
    v_lshrrev_b32 v117, 20, v117
    v_mul_u32_u24 v118, 18, v117
    v_sub_u32 v118, v116, v118
    v_mad_u32_u24 v117, v117, s45, v211
    v_lshl_add_u32 v201, v118, 4, v117
    v_add_u32 v116, 32, v212
    v_mul_u32_u24 v117, 0xe38f, v116
    v_lshrrev_b32 v117, 20, v117
    v_mul_u32_u24 v118, 18, v117
    v_sub_u32 v118, v116, v118
    v_mad_u32_u24 v117, v117, s45, v211
    v_lshl_add_u32 v202, v118, 4, v117
    v_add_u32 v116, 48, v212
    v_mul_u32_u24 v117, 0xe38f, v116
    v_lshrrev_b32 v117, 20, v117
    v_mul_u32_u24 v118, 18, v117
    v_sub_u32 v118, v116, v118
    v_mad_u32_u24 v117, v117, s45, v211
    v_lshl_add_u32 v203, v118, 4, v117
    v_add_u32 v116, 64, v212
    v_mul_u32_u24 v117, 0xe38f, v116
    v_lshrrev_b32 v117, 20, v117
    v_mul_u32_u24 v118, 18, v117
    v_sub_u32 v118, v116, v118
    v_mad_u32_u24 v117, v117, s45, v211
    v_lshl_add_u32 v204, v118, 4, v117
    s_cmp_eq_u32 s16, 0
    s_cbranch_scc1 L_q_o_8
    v_lshrrev_b32 v4, 1, v1
    v_mul_u32_u24 v4, 0x140, v4
    v_and_b32 v5, 1, v1
    v_lshl_add_u32 v4, v5, 4, v4
    v_add_u32 v4, 0x120, v4
    v_add_u32 v204, s46, v4
L_q_o_8:
    v_add_u32 v116, 0, v1
    v_mul_u32_u24 v117, 0x3334, v116
    v_lshrrev_b32 v117, 20, v117
    v_mul_u32_u24 v118, 0x50, v117
    v_sub_u32 v118, v116, v118
    v_mul_u32_u24 v117, 0x28000, v117
    v_lshl_add_u32 v205, v118, 4, v117
    v_add_u32 v116, 64, v1
    v_mul_u32_u24 v117, 0x3334, v116
    v_lshrrev_b32 v117, 20, v117
    v_mul_u32_u24 v118, 0x50, v117
    v_sub_u32 v118, v116, v118
    v_mul_u32_u24 v117, 0x28000, v117
    v_lshl_add_u32 v206, v118, 4, v117
    v_add_u32 v116, 0x80, v1
    v_mul_u32_u24 v117, 0x3334, v116
    v_lshrrev_b32 v117, 20, v117
    v_mul_u32_u24 v118, 0x50, v117
    v_sub_u32 v118, v116, v118
    v_mul_u32_u24 v117, 0x28000, v117
    v_lshl_add_u32 v207, v118, 4, v117
    v_add_u32 v116, 0xc0, v1
    v_mul_u32_u24 v117, 0x3334, v116
    v_lshrrev_b32 v117, 20, v117
    v_mul_u32_u24 v118, 0x50, v117
    v_sub_u32 v118, v116, v118
    v_mul_u32_u24 v117, 0x28000, v117
    v_lshl_add_u32 v208, v118, 4, v117
    v_add_u32 v116, 0x100, v1
    v_mul_u32_u24 v117, 0x3334, v116
    v_lshrrev_b32 v117, 20, v117
    v_mul_u32_u24 v118, 0x50, v117
    v_sub_u32 v118, v116, v118
    v_mul_u32_u24 v117, 0x28000, v117
    v_lshl_add_u32 v209, v118, 4, v117
    s_mul_i32 s17, s16, 0x1400
    s_add_u32 s17, s17, s46
    v_add_u32 v212, s17, v214
L_q_j_7:
    s_waitcnt vmcnt(5) lgkmcnt(0)
    s_barrier
    ds_read_b128 v[60:63], v186
    ds_read_b64_tr_b16 v[128:129], v190 offset:128
    ds_read_b64_tr_b16 v[130:131], v190 offset:1408
    ds_read_b64_tr_b16 v[132:133], v190 offset:192
    ds_read_b64_tr_b16 v[134:135], v190 offset:1472
    ds_read_b128 v[64:67], v187
    ds_read_b64_tr_b16 v[140:141], v191 offset:128
    ds_read_b64_tr_b16 v[142:143], v191 offset:1408
    ds_read_b64_tr_b16 v[144:145], v191 offset:192
    ds_read_b64_tr_b16 v[146:147], v191 offset:1472
    s_waitcnt lgkmcnt(7)
    v_mfma_f32_32x32x16_bf16 v[12:27], v[128:131], v[60:63], 0
    ds_read_b128 v[68:71], v188
    ds_read_b64_tr_b16 v[152:153], v192 offset:128
    ds_read_b64_tr_b16 v[154:155], v192 offset:1408
    v_lshlrev_b32 v182, 16, v62
    v_and_b32 v183, 0xffff0000, v62
    v_fmac_f32 v180, v182, v182
    v_fmac_f32 v181, v183, v183
    s_add_u32 m0, s29, 0xa000
    s_mov_b64 exec, s[30:31]
    s_add_u32 s17, s28, 0x6c000
    buffer_load_dwordx4 v6, s[20:23], s17 offen lds
    s_mov_b64 exec, -1
    s_waitcnt lgkmcnt(8)
    v_mfma_f32_32x32x16_bf16 v[28:43], v[132:135], v[60:63], 0
    ds_read_b64_tr_b16 v[156:157], v192 offset:192
    ds_read_b64_tr_b16 v[158:159], v192 offset:1472
    v_lshlrev_b32 v184, 16, v63
    v_and_b32 v185, 0xffff0000, v63
    v_fmac_f32 v180, v184, v184
    v_fmac_f32 v181, v185, v185
    s_add_u32 m0, s29, 0xa400
    s_mov_b64 exec, s[32:33]
    s_add_u32 s17, s28, 0x6c000
    buffer_load_dwordx4 v7, s[20:23], s17 offen lds
    s_mov_b64 exec, -1
    s_waitcnt lgkmcnt(7)
    v_mfma_f32_32x32x16_bf16 v[12:27], v[140:143], v[64:67], v[12:27]
    ds_read_b128 v[60:63], v189
    ds_read_b64_tr_b16 v[128:129], v193 offset:128
    ds_read_b64_tr_b16 v[130:131], v193 offset:1408
    v_lshlrev_b32 v182, 16, v66
    v_and_b32 v183, 0xffff0000, v66
    v_fmac_f32 v180, v182, v182
    v_fmac_f32 v181, v183, v183
    s_add_u32 m0, s29, 0xa800
    s_mov_b64 exec, s[34:35]
    s_add_u32 s17, s28, 0x6c000
    buffer_load_dwordx4 v8, s[20:23], s17 offen lds
    s_mov_b64 exec, -1
    v_mfma_f32_16x16x32_bf16 v[164:167], v[176:179], v[140:143], 0
    s_waitcnt lgkmcnt(8)
    v_mfma_f32_32x32x16_bf16 v[28:43], v[144:147], v[64:67], v[28:43]
    ds_read_b64_tr_b16 v[132:133], v193 offset:192
    ds_read_b64_tr_b16 v[134:135], v193 offset:1472
    v_lshlrev_b32 v184, 16, v67
    v_and_b32 v185, 0xffff0000, v67
    v_fmac_f32 v180, v184, v184
    v_fmac_f32 v181, v185, v185
    s_add_u32 m0, s29, 0xac00
    s_mov_b64 exec, s[36:37]
    s_add_u32 s17, s28, 0x6c000
    buffer_load_dwordx4 v9, s[20:23], s17 offen lds
    s_mov_b64 exec, -1
    s_waitcnt vmcnt(4)
    s_barrier
    s_waitcnt lgkmcnt(7)
    v_mfma_f32_32x32x16_bf16 v[12:27], v[152:155], v[68:71], v[12:27]
    ds_read_b128 v[64:67], v186 offset:16384
    ds_read_b64_tr_b16 v[140:141], v190 offset:20608
    ds_read_b64_tr_b16 v[142:143], v190 offset:21888
    v_lshlrev_b32 v182, 16, v70
    v_and_b32 v183, 0xffff0000, v70
    v_fmac_f32 v180, v182, v182
    v_fmac_f32 v181, v183, v183
    s_add_u32 m0, s29, 0xb000
    s_mov_b64 exec, s[38:39]
    s_add_u32 s17, s28, 0x6c000
    buffer_load_dwordx4 v10, s[20:23], s17 offen lds
    s_mov_b64 exec, -1
    s_waitcnt lgkmcnt(8)
    v_mfma_f32_32x32x16_bf16 v[28:43], v[156:159], v[68:71], v[28:43]
    ds_read_b64_tr_b16 v[144:145], v190 offset:20672
    ds_read_b64_tr_b16 v[146:147], v190 offset:21952
    v_lshlrev_b32 v184, 16, v71
    v_and_b32 v185, 0xffff0000, v71
    v_fmac_f32 v180, v184, v184
    v_fmac_f32 v181, v185, v185
    s_add_u32 m0, s29, 0xf000
    s_mov_b64 exec, s[30:31]
    s_add_u32 s17, s28, 0xa2000
    buffer_load_dwordx4 v6, s[20:23], s17 offen lds
    s_mov_b64 exec, -1
    s_waitcnt lgkmcnt(7)
    v_mfma_f32_32x32x16_bf16 v[12:27], v[128:131], v[60:63], v[12:27]
    ds_read_b128 v[68:71], v187 offset:16384
    ds_read_b64_tr_b16 v[152:153], v191 offset:20608
    ds_read_b64_tr_b16 v[154:155], v191 offset:21888
    v_lshlrev_b32 v182, 16, v62
    v_and_b32 v183, 0xffff0000, v62
    v_fmac_f32 v180, v182, v182
    v_fmac_f32 v181, v183, v183
    s_add_u32 m0, s29, 0xf400
    s_mov_b64 exec, s[32:33]
    s_add_u32 s17, s28, 0xa2000
    buffer_load_dwordx4 v7, s[20:23], s17 offen lds
    s_mov_b64 exec, -1
    s_waitcnt lgkmcnt(8)
    v_mfma_f32_32x32x16_bf16 v[28:43], v[132:135], v[60:63], v[28:43]
    ds_read_b64_tr_b16 v[156:157], v191 offset:20672
    ds_read_b64_tr_b16 v[158:159], v191 offset:21952
    v_lshlrev_b32 v184, 16, v63
    v_and_b32 v185, 0xffff0000, v63
    v_fmac_f32 v180, v184, v184
    v_fmac_f32 v181, v185, v185
    s_add_u32 m0, s29, 0xf800
    s_mov_b64 exec, s[34:35]
    s_add_u32 s17, s28, 0xa2000
    buffer_load_dwordx4 v8, s[20:23], s17 offen lds
    s_mov_b64 exec, -1
    v_mfma_f32_16x16x32_bf16 v[168:171], v[176:179], v[132:135], 0
    s_waitcnt lgkmcnt(7)
    v_mfma_f32_32x32x16_bf16 v[12:27], v[140:143], v[64:67], v[12:27]
    ds_read_b128 v[60:63], v188 offset:16384
    ds_read_b64_tr_b16 v[128:129], v192 offset:20608
    ds_read_b64_tr_b16 v[130:131], v192 offset:21888
    v_lshlrev_b32 v182, 16, v66
    v_and_b32 v183, 0xffff0000, v66
    v_fmac_f32 v180, v182, v182
    v_fmac_f32 v181, v183, v183
    s_add_u32 m0, s29, 0xfc00
    s_mov_b64 exec, s[36:37]
    s_add_u32 s17, s28, 0xa2000
    buffer_load_dwordx4 v9, s[20:23], s17 offen lds
    s_mov_b64 exec, -1
    s_waitcnt lgkmcnt(8)
    v_mfma_f32_32x32x16_bf16 v[28:43], v[144:147], v[64:67], v[28:43]
    ds_read_b64_tr_b16 v[132:133], v192 offset:20672
    ds_read_b64_tr_b16 v[134:135], v192 offset:21952
    v_lshlrev_b32 v184, 16, v67
    v_and_b32 v185, 0xffff0000, v67
    v_fmac_f32 v180, v184, v184
    v_fmac_f32 v181, v185, v185
    s_add_u32 m0, s29, 0x10000
    s_mov_b64 exec, s[38:39]
    s_add_u32 s17, s28, 0xa2000
    buffer_load_dwordx4 v10, s[20:23], s17 offen lds
    s_mov_b64 exec, -1
    s_waitcnt lgkmcnt(7)
    v_mfma_f32_32x32x16_bf16 v[12:27], v[152:155], v[68:71], v[12:27]
    ds_read_b128 v[64:67], v189 offset:16384
    ds_read_b64_tr_b16 v[140:141], v193 offset:20608
    ds_read_b64_tr_b16 v[142:143], v193 offset:21888
    v_lshlrev_b32 v182, 16, v70
    v_and_b32 v183, 0xffff0000, v70
    v_fmac_f32 v180, v182, v182
    v_fmac_f32 v181, v183, v183
    v_mfma_f32_16x16x32_bf16 v[164:167], v[176:179], v[152:155], v[164:167]
    s_waitcnt lgkmcnt(8)
    v_mfma_f32_32x32x16_bf16 v[28:43], v[156:159], v[68:71], v[28:43]
    ds_read_b64_tr_b16 v[144:145], v193 offset:20672
    ds_read_b64_tr_b16 v[146:147], v193 offset:21952
    v_lshlrev_b32 v184, 16, v71
    v_and_b32 v185, 0xffff0000, v71
    v_fmac_f32 v180, v184, v184
    v_fmac_f32 v181, v185, v185
    s_waitcnt vmcnt(5)
    s_barrier
    s_waitcnt lgkmcnt(7)
    v_mfma_f32_32x32x16_bf16 v[12:27], v[128:131], v[60:63], v[12:27]
    ds_read_b128 v[68:71], v186 offset:32768
    ds_read_b64_tr_b16 v[152:153], v190 offset:41088
    ds_read_b64_tr_b16 v[154:155], v190 offset:42368
    v_lshlrev_b32 v182, 16, v62
    v_and_b32 v183, 0xffff0000, v62
    v_fmac_f32 v180, v182, v182
    v_fmac_f32 v181, v183, v183
    s_add_u32 m0, s29, 0
    s_mov_b64 exec, s[30:31]
    s_add_u32 s17, s28, 0xd8000
    buffer_load_dwordx4 v6, s[20:23], s17 offen lds
    s_mov_b64 exec, -1
    s_waitcnt lgkmcnt(8)
    v_mfma_f32_32x32x16_bf16 v[28:43], v[132:135], v[60:63], v[28:43]
    ds_read_b64_tr_b16 v[156:157], v190 offset:41152
    ds_read_b64_tr_b16 v[158:159], v190 offset:42432
    v_lshlrev_b32 v184, 16, v63
    v_and_b32 v185, 0xffff0000, v63
    v_fmac_f32 v180, v184, v184
    v_fmac_f32 v181, v185, v185
    s_add_u32 m0, s29, 0x400
    s_mov_b64 exec, s[32:33]
    s_add_u32 s17, s28, 0xd8000
    buffer_load_dwordx4 v7, s[20:23], s17 offen lds
    s_mov_b64 exec, -1
    s_waitcnt lgkmcnt(7)
    v_mfma_f32_32x32x16_bf16 v[12:27], v[140:143], v[64:67], v[12:27]
    ds_read_b128 v[60:63], v187 offset:32768
    ds_read_b64_tr_b16 v[128:129], v191 offset:41088
    ds_read_b64_tr_b16 v[130:131], v191 offset:42368
    v_lshlrev_b32 v182, 16, v66
    v_and_b32 v183, 0xffff0000, v66
    v_fmac_f32 v180, v182, v182
    v_fmac_f32 v181, v183, v183
    s_add_u32 m0, s29, 0x800
    s_mov_b64 exec, s[34:35]
    s_add_u32 s17, s28, 0xd8000
    buffer_load_dwordx4 v8, s[20:23], s17 offen lds
    s_mov_b64 exec, -1
    s_waitcnt lgkmcnt(8)
    v_mfma_f32_32x32x16_bf16 v[28:43], v[144:147], v[64:67], v[28:43]
    ds_read_b64_tr_b16 v[132:133], v191 offset:41152
    ds_read_b64_tr_b16 v[134:135], v191 offset:42432
    v_lshlrev_b32 v184, 16, v67
    v_and_b32 v185, 0xffff0000, v67
    v_fmac_f32 v180, v184, v184
    v_fmac_f32 v181, v185, v185
    s_add_u32 m0, s29, 0xc00
    s_mov_b64 exec, s[36:37]
    s_add_u32 s17, s28, 0xd8000
    buffer_load_dwordx4 v9, s[20:23], s17 offen lds
    s_mov_b64 exec, -1
    v_mfma_f32_16x16x32_bf16 v[168:171], v[176:179], v[144:147], v[168:171]
    s_waitcnt lgkmcnt(7)
    v_mfma_f32_32x32x16_bf16 v[12:27], v[152:155], v[68:71], v[12:27]
    ds_read_b128 v[64:67], v188 offset:32768
    ds_read_b64_tr_b16 v[140:141], v192 offset:41088
    ds_read_b64_tr_b16 v[142:143], v192 offset:42368
    v_lshlrev_b32 v182, 16, v70
    v_and_b32 v183, 0xffff0000, v70
    v_fmac_f32 v180, v182, v182
    v_fmac_f32 v181, v183, v183
    s_add_u32 m0, s29, 0x1000
    s_mov_b64 exec, s[38:39]
    s_add_u32 s17, s28, 0xd8000
    buffer_load_dwordx4 v10, s[20:23], s17 offen lds
    s_mov_b64 exec, -1
    s_waitcnt lgkmcnt(8)
    v_mfma_f32_32x32x16_bf16 v[28:43], v[156:159], v[68:71], v[28:43]
    ds_read_b64_tr_b16 v[144:145], v192 offset:41152
    ds_read_b64_tr_b16 v[146:147], v192 offset:42432
    v_lshlrev_b32 v184, 16, v71
    v_and_b32 v185, 0xffff0000, v71
    v_fmac_f32 v180, v184, v184
    v_fmac_f32 v181, v185, v185
    s_waitcnt lgkmcnt(7)
    v_mfma_f32_32x32x16_bf16 v[12:27], v[128:131], v[60:63], v[12:27]
    ds_read_b128 v[68:71], v189 offset:32768
    ds_read_b64_tr_b16 v[152:153], v193 offset:41088
    ds_read_b64_tr_b16 v[154:155], v193 offset:42368
    v_lshlrev_b32 v182, 16, v62
    v_and_b32 v183, 0xffff0000, v62
    v_fmac_f32 v180, v182, v182
    v_fmac_f32 v181, v183, v183
    v_mfma_f32_16x16x32_bf16 v[164:167], v[176:179], v[128:131], v[164:167]
    s_waitcnt lgkmcnt(8)
    v_mfma_f32_32x32x16_bf16 v[28:43], v[132:135], v[60:63], v[28:43]
    ds_read_b64_tr_b16 v[156:157], v193 offset:41152
    ds_read_b64_tr_b16 v[158:159], v193 offset:42432
    v_lshlrev_b32 v184, 16, v63
    v_and_b32 v185, 0xffff0000, v63
    v_fmac_f32 v180, v184, v184
    v_fmac_f32 v181, v185, v185
    s_waitcnt vmcnt(5)
    s_barrier
    s_waitcnt lgkmcnt(7)
    v_mfma_f32_32x32x16_bf16 v[12:27], v[140:143], v[64:67], v[12:27]
    ds_read_b128 v[60:63], v186 offset:49152
    ds_read_b64_tr_b16 v[128:129], v190 offset:61568
    ds_read_b64_tr_b16 v[130:131], v190 offset:62848
    v_lshlrev_b32 v182, 16, v66
    v_and_b32 v183, 0xffff0000, v66
    v_fmac_f32 v180, v182, v182
    v_fmac_f32 v181, v183, v183
    s_add_u32 m0, s29, 0x5000
    s_mov_b64 exec, s[30:31]
    s_add_u32 s17, s28, 0x10e000
    buffer_load_dwordx4 v6, s[20:23], s17 offen lds
    s_mov_b64 exec, -1
    s_waitcnt lgkmcnt(8)
    v_mfma_f32_32x32x16_bf16 v[28:43], v[144:147], v[64:67], v[28:43]
    ds_read_b64_tr_b16 v[132:133], v190 offset:61632
    ds_read_b64_tr_b16 v[134:135], v190 offset:62912
    v_lshlrev_b32 v184, 16, v67
    v_and_b32 v185, 0xffff0000, v67
    v_fmac_f32 v180, v184, v184
    v_fmac_f32 v181, v185, v185
    s_add_u32 m0, s29, 0x5400
    s_mov_b64 exec, s[32:33]
    s_add_u32 s17, s28, 0x10e000
    buffer_load_dwordx4 v7, s[20:23], s17 offen lds
    s_mov_b64 exec, -1
    s_waitcnt lgkmcnt(7)
    v_mfma_f32_32x32x16_bf16 v[12:27], v[152:155], v[68:71], v[12:27]
    ds_read_b128 v[64:67], v187 offset:49152
    ds_read_b64_tr_b16 v[140:141], v191 offset:61568
    ds_read_b64_tr_b16 v[142:143], v191 offset:62848
    v_lshlrev_b32 v182, 16, v70
    v_and_b32 v183, 0xffff0000, v70
    v_fmac_f32 v180, v182, v182
    v_fmac_f32 v181, v183, v183
    s_add_u32 m0, s29, 0x5800
    s_mov_b64 exec, s[34:35]
    s_add_u32 s17, s28, 0x10e000
    buffer_load_dwordx4 v8, s[20:23], s17 offen lds
    s_mov_b64 exec, -1
    s_waitcnt lgkmcnt(8)
    v_mfma_f32_32x32x16_bf16 v[28:43], v[156:159], v[68:71], v[28:43]
    ds_read_b64_tr_b16 v[144:145], v191 offset:61632
    ds_read_b64_tr_b16 v[146:147], v191 offset:62912
    v_lshlrev_b32 v184, 16, v71
    v_and_b32 v185, 0xffff0000, v71
    v_fmac_f32 v180, v184, v184
    v_fmac_f32 v181, v185, v185
    s_add_u32 m0, s29, 0x5c00
    s_mov_b64 exec, s[36:37]
    s_add_u32 s17, s28, 0x10e000
    buffer_load_dwordx4 v9, s[20:23], s17 offen lds
    s_mov_b64 exec, -1
    v_mfma_f32_16x16x32_bf16 v[168:171], v[176:179], v[156:159], v[168:171]
    s_waitcnt lgkmcnt(7)
    v_mfma_f32_32x32x16_bf16 v[12:27], v[128:131], v[60:63], v[12:27]
    ds_read_b128 v[68:71], v188 offset:49152
    ds_read_b64_tr_b16 v[152:153], v192 offset:61568
    ds_read_b64_tr_b16 v[154:155], v192 offset:62848
    v_lshlrev_b32 v182, 16, v62
    v_and_b32 v183, 0xffff0000, v62
    v_fmac_f32 v180, v182, v182
    v_fmac_f32 v181, v183, v183
    s_add_u32 m0, s29, 0x6000
    s_mov_b64 exec, s[38:39]
    s_add_u32 s17, s28, 0x10e000
    buffer_load_dwordx4 v10, s[20:23], s17 offen lds
    s_mov_b64 exec, -1
    s_waitcnt lgkmcnt(8)
    v_mfma_f32_32x32x16_bf16 v[28:43], v[132:135], v[60:63], v[28:43]
    ds_read_b64_tr_b16 v[156:157], v192 offset:61632
    ds_read_b64_tr_b16 v[158:159], v192 offset:62912
    v_lshlrev_b32 v184, 16, v63
    v_and_b32 v185, 0xffff0000, v63
    v_fmac_f32 v180, v184, v184
    v_fmac_f32 v181, v185, v185
    s_waitcnt lgkmcnt(7)
    v_mfma_f32_32x32x16_bf16 v[12:27], v[140:143], v[64:67], v[12:27]
    ds_read_b128 v[60:63], v189 offset:49152
    ds_read_b64_tr_b16 v[128:129], v193 offset:61568
    ds_read_b64_tr_b16 v[130:131], v193 offset:62848
    v_lshlrev_b32 v182, 16, v66
    v_and_b32 v183, 0xffff0000, v66
    v_fmac_f32 v180, v182, v182
    v_fmac_f32 v181, v183, v183
    v_mfma_f32_16x16x32_bf16 v[164:167], v[176:179], v[140:143], v[164:167]
    s_waitcnt lgkmcnt(8)
    v_mfma_f32_32x32x16_bf16 v[28:43], v[144:147], v[64:67], v[28:43]
    ds_read_b64_tr_b16 v[132:133], v193 offset:61632
    ds_read_b64_tr_b16 v[134:135], v193 offset:62912
    v_lshlrev_b32 v184, 16, v67
    v_and_b32 v185, 0xffff0000, v67
    v_fmac_f32 v180, v184, v184
    v_fmac_f32 v181, v185, v185
    s_waitcnt vmcnt(5)
    s_barrier
    s_waitcnt lgkmcnt(7)
    v_mfma_f32_32x32x16_bf16 v[12:27], v[152:155], v[68:71], v[12:27]
    ds_read_b128 v[64:67], v186
    ds_read_b64_tr_b16 v[140:141], v190 offset:128
    ds_read_b64_tr_b16 v[142:143], v190 offset:1408
    v_lshlrev_b32 v182, 16, v70
    v_and_b32 v183, 0xffff0000, v70
    v_fmac_f32 v180, v182, v182
    v_fmac_f32 v181, v183, v183
    s_add_u32 m0, s29, 0xa000
    s_mov_b64 exec, s[30:31]
    s_add_u32 s17, s28, 0x144000
    buffer_load_dwordx4 v6, s[20:23], s17 offen lds
    s_mov_b64 exec, -1
    s_waitcnt lgkmcnt(8)
    v_mfma_f32_32x32x16_bf16 v[28:43], v[156:159], v[68:71], v[28:43]
    ds_read_b64_tr_b16 v[144:145], v190 offset:192
    ds_read_b64_tr_b16 v[146:147], v190 offset:1472
    v_lshlrev_b32 v184, 16, v71
    v_and_b32 v185, 0xffff0000, v71
    v_fmac_f32 v180, v184, v184
    v_fmac_f32 v181, v185, v185
    s_add_u32 m0, s29, 0xa400
    s_mov_b64 exec, s[32:33]
    s_add_u32 s17, s28, 0x144000
    buffer_load_dwordx4 v7, s[20:23], s17 offen lds
    s_mov_b64 exec, -1
    s_waitcnt lgkmcnt(7)
    v_mfma_f32_32x32x16_bf16 v[12:27], v[128:131], v[60:63], v[12:27]
    ds_read_b128 v[68:71], v187
    ds_read_b64_tr_b16 v[152:153], v191 offset:128
    ds_read_b64_tr_b16 v[154:155], v191 offset:1408
    v_lshlrev_b32 v182, 16, v62
    v_and_b32 v183, 0xffff0000, v62
    v_fmac_f32 v180, v182, v182
    v_fmac_f32 v181, v183, v183
    s_add_u32 m0, s29, 0xa800
    s_mov_b64 exec, s[34:35]
    s_add_u32 s17, s28, 0x144000
    buffer_load_dwordx4 v8, s[20:23], s17 offen lds
    s_mov_b64 exec, -1
    s_waitcnt lgkmcnt(8)
    v_mfma_f32_32x32x16_bf16 v[28:43], v[132:135], v[60:63], v[28:43]
    ds_read_b64_tr_b16 v[156:157], v191 offset:192
    ds_read_b64_tr_b16 v[158:159], v191 offset:1472
    v_lshlrev_b32 v184, 16, v63
    v_and_b32 v185, 0xffff0000, v63
    v_fmac_f32 v180, v184, v184
    v_fmac_f32 v181, v185, v185
    s_add_u32 m0, s29, 0xac00
    s_mov_b64 exec, s[36:37]
    s_add_u32 s17, s28, 0x144000
    buffer_load_dwordx4 v9, s[20:23], s17 offen lds
    s_mov_b64 exec, -1
    v_mfma_f32_16x16x32_bf16 v[168:171], v[176:179], v[132:135], v[168:171]
    s_waitcnt lgkmcnt(7)
    v_mfma_f32_32x32x16_bf16 v[12:27], v[140:143], v[64:67], v[12:27]
    ds_read_b128 v[60:63], v188
    ds_read_b64_tr_b16 v[128:129], v192 offset:128
    ds_read_b64_tr_b16 v[130:131], v192 offset:1408
    v_lshlrev_b32 v182, 16, v66
    v_and_b32 v183, 0xffff0000, v66
    v_fmac_f32 v180, v182, v182
    v_fmac_f32 v181, v183, v183
    s_add_u32 m0, s29, 0xb000
    s_mov_b64 exec, s[38:39]
    s_add_u32 s17, s28, 0x144000
    buffer_load_dwordx4 v10, s[20:23], s17 offen lds
    s_mov_b64 exec, -1
    s_waitcnt lgkmcnt(8)
    v_mfma_f32_32x32x16_bf16 v[28:43], v[144:147], v[64:67], v[28:43]
    ds_read_b64_tr_b16 v[132:133], v192 offset:192
    ds_read_b64_tr_b16 v[134:135], v192 offset:1472
    v_lshlrev_b32 v184, 16, v67
    v_and_b32 v185, 0xffff0000, v67
    v_fmac_f32 v180, v184, v184
    v_fmac_f32 v181, v185, v185
    s_waitcnt lgkmcnt(7)
    v_mfma_f32_32x32x16_bf16 v[12:27], v[152:155], v[68:71], v[12:27]
    ds_read_b128 v[64:67], v189
    ds_read_b64_tr_b16 v[140:141], v193 offset:128
    ds_read_b64_tr_b16 v[142:143], v193 offset:1408
    v_lshlrev_b32 v182, 16, v70
    v_and_b32 v183, 0xffff0000, v70
    v_fmac_f32 v180, v182, v182
    v_fmac_f32 v181, v183, v183
    v_mfma_f32_16x16x32_bf16 v[164:167], v[176:179], v[152:155], v[164:167]
    s_waitcnt lgkmcnt(8)
    v_mfma_f32_32x32x16_bf16 v[28:43], v[156:159], v[68:71], v[28:43]
    ds_read_b64_tr_b16 v[144:145], v193 offset:192
    ds_read_b64_tr_b16 v[146:147], v193 offset:1472
    v_lshlrev_b32 v184, 16, v71
    v_and_b32 v185, 0xffff0000, v71
    v_fmac_f32 v180, v184, v184
    v_fmac_f32 v181, v185, v185
    s_waitcnt vmcnt(5)
    s_barrier
    s_waitcnt lgkmcnt(7)
    v_mfma_f32_32x32x16_bf16 v[12:27], v[128:131], v[60:63], v[12:27]
    ds_read_b128 v[68:71], v186 offset:16384
    ds_read_b64_tr_b16 v[152:153], v190 offset:20608
    ds_read_b64_tr_b16 v[154:155], v190 offset:21888
    v_lshlrev_b32 v182, 16, v62
    v_and_b32 v183, 0xffff0000, v62
    v_fmac_f32 v180, v182, v182
    v_fmac_f32 v181, v183, v183
    s_add_u32 m0, s29, 0xf000
    s_mov_b64 exec, s[30:31]
    s_add_u32 s17, s28, 0x17a000
    buffer_load_dwordx4 v6, s[20:23], s17 offen lds
    s_mov_b64 exec, -1
    s_waitcnt lgkmcnt(8)
    v_mfma_f32_32x32x16_bf16 v[28:43], v[132:135], v[60:63], v[28:43]
    ds_read_b64_tr_b16 v[156:157], v190 offset:20672
    ds_read_b64_tr_b16 v[158:159], v190 offset:21952
    v_lshlrev_b32 v184, 16, v63
    v_and_b32 v185, 0xffff0000, v63
    v_fmac_f32 v180, v184, v184
    v_fmac_f32 v181, v185, v185
    s_add_u32 m0, s29, 0xf400
    s_mov_b64 exec, s[32:33]
    s_add_u32 s17, s28, 0x17a000
    buffer_load_dwordx4 v7, s[20:23], s17 offen lds
    s_mov_b64 exec, -1
    s_waitcnt lgkmcnt(7)
    v_mfma_f32_32x32x16_bf16 v[12:27], v[140:143], v[64:67], v[12:27]
    ds_read_b128 v[60:63], v187 offset:16384
    ds_read_b64_tr_b16 v[128:129], v191 offset:20608
    ds_read_b64_tr_b16 v[130:131], v191 offset:21888
    v_lshlrev_b32 v182, 16, v66
    v_and_b32 v183, 0xffff0000, v66
    v_fmac_f32 v180, v182, v182
    v_fmac_f32 v181, v183, v183
    s_add_u32 m0, s29, 0xf800
    s_mov_b64 exec, s[34:35]
    s_add_u32 s17, s28, 0x17a000
    buffer_load_dwordx4 v8, s[20:23], s17 offen lds
    s_mov_b64 exec, -1
    s_waitcnt lgkmcnt(8)
    v_mfma_f32_32x32x16_bf16 v[28:43], v[144:147], v[64:67], v[28:43]
    ds_read_b64_tr_b16 v[132:133], v191 offset:20672
    ds_read_b64_tr_b16 v[134:135], v191 offset:21952
    v_lshlrev_b32 v184, 16, v67
    v_and_b32 v185, 0xffff0000, v67
    v_fmac_f32 v180, v184, v184
    v_fmac_f32 v181, v185, v185
    s_add_u32 m0, s29, 0xfc00
    s_mov_b64 exec, s[36:37]
    s_add_u32 s17, s28, 0x17a000
    buffer_load_dwordx4 v9, s[20:23], s17 offen lds
    s_mov_b64 exec, -1
    v_mfma_f32_16x16x32_bf16 v[168:171], v[176:179], v[144:147], v[168:171]
    s_waitcnt lgkmcnt(7)
    v_mfma_f32_32x32x16_bf16 v[12:27], v[152:155], v[68:71], v[12:27]
    ds_read_b128 v[64:67], v188 offset:16384
    ds_read_b64_tr_b16 v[140:141], v192 offset:20608
    ds_read_b64_tr_b16 v[142:143], v192 offset:21888
    v_lshlrev_b32 v182, 16, v70
    v_and_b32 v183, 0xffff0000, v70
    v_fmac_f32 v180, v182, v182
    v_fmac_f32 v181, v183, v183
    s_add_u32 m0, s29, 0x10000
    s_mov_b64 exec, s[38:39]
    s_add_u32 s17, s28, 0x17a000
    buffer_load_dwordx4 v10, s[20:23], s17 offen lds
    s_mov_b64 exec, -1
    s_waitcnt lgkmcnt(8)
    v_mfma_f32_32x32x16_bf16 v[28:43], v[156:159], v[68:71], v[28:43]
    ds_read_b64_tr_b16 v[144:145], v192 offset:20672
    ds_read_b64_tr_b16 v[146:147], v192 offset:21952
    v_lshlrev_b32 v184, 16, v71
    v_and_b32 v185, 0xffff0000, v71
    v_fmac_f32 v180, v184, v184
    v_fmac_f32 v181, v185, v185
    s_waitcnt lgkmcnt(7)
    v_mfma_f32_32x32x16_bf16 v[12:27], v[128:131], v[60:63], v[12:27]
    ds_read_b128 v[68:71], v189 offset:16384
    ds_read_b64_tr_b16 v[152:153], v193 offset:20608
    ds_read_b64_tr_b16 v[154:155], v193 offset:21888
    v_lshlrev_b32 v182, 16, v62
    v_and_b32 v183, 0xffff0000, v62
    v_fmac_f32 v180, v182, v182
    v_fmac_f32 v181, v183, v183
    v_mfma_f32_16x16x32_bf16 v[164:167], v[176:179], v[128:131], v[164:167]
    s_waitcnt lgkmcnt(8)
    v_mfma_f32_32x32x16_bf16 v[28:43], v[132:135], v[60:63], v[28:43]
    ds_read_b64_tr_b16 v[156:157], v193 offset:20672
    ds_read_b64_tr_b16 v[158:159], v193 offset:21952
    v_lshlrev_b32 v184, 16, v63
    v_and_b32 v185, 0xffff0000, v63
    v_fmac_f32 v180, v184, v184
    v_fmac_f32 v181, v185, v185
    s_waitcnt vmcnt(5)
    s_barrier
    s_waitcnt lgkmcnt(7)
    v_mfma_f32_32x32x16_bf16 v[12:27], v[140:143], v[64:67], v[12:27]
    ds_read_b128 v[60:63], v186 offset:32768
    ds_read_b64_tr_b16 v[128:129], v190 offset:41088
    ds_read_b64_tr_b16 v[130:131], v190 offset:42368
    v_lshlrev_b32 v182, 16, v66
    v_and_b32 v183, 0xffff0000, v66
    v_fmac_f32 v180, v182, v182
    v_fmac_f32 v181, v183, v183
    s_add_u32 m0, s29, 0
    s_mov_b64 exec, s[30:31]
    s_add_u32 s17, s28, 0x1b0000
    buffer_load_dwordx4 v6, s[20:23], s17 offen lds
    s_mov_b64 exec, -1
    s_waitcnt lgkmcnt(8)
    v_mfma_f32_32x32x16_bf16 v[28:43], v[144:147], v[64:67], v[28:43]
    ds_read_b64_tr_b16 v[132:133], v190 offset:41152
    ds_read_b64_tr_b16 v[134:135], v190 offset:42432
    v_lshlrev_b32 v184, 16, v67
    v_and_b32 v185, 0xffff0000, v67
    v_fmac_f32 v180, v184, v184
    v_fmac_f32 v181, v185, v185
    s_add_u32 m0, s29, 0x400
    s_mov_b64 exec, s[32:33]
    s_add_u32 s17, s28, 0x1b0000
    buffer_load_dwordx4 v7, s[20:23], s17 offen lds
    s_mov_b64 exec, -1
    s_waitcnt lgkmcnt(7)
    v_mfma_f32_32x32x16_bf16 v[12:27], v[152:155], v[68:71], v[12:27]
    ds_read_b128 v[64:67], v187 offset:32768
    ds_read_b64_tr_b16 v[140:141], v191 offset:41088
    ds_read_b64_tr_b16 v[142:143], v191 offset:42368
    v_lshlrev_b32 v182, 16, v70
    v_and_b32 v183, 0xffff0000, v70
    v_fmac_f32 v180, v182, v182
    v_fmac_f32 v181, v183, v183
    s_add_u32 m0, s29, 0x800
    s_mov_b64 exec, s[34:35]
    s_add_u32 s17, s28, 0x1b0000
    buffer_load_dwordx4 v8, s[20:23], s17 offen lds
    s_mov_b64 exec, -1
    s_waitcnt lgkmcnt(8)
    v_mfma_f32_32x32x16_bf16 v[28:43], v[156:159], v[68:71], v[28:43]
    ds_read_b64_tr_b16 v[144:145], v191 offset:41152
    ds_read_b64_tr_b16 v[146:147], v191 offset:42432
    v_lshlrev_b32 v184, 16, v71
    v_and_b32 v185, 0xffff0000, v71
    v_fmac_f32 v180, v184, v184
    v_fmac_f32 v181, v185, v185
    s_add_u32 m0, s29, 0xc00
    s_mov_b64 exec, s[36:37]
    s_add_u32 s17, s28, 0x1b0000
    buffer_load_dwordx4 v9, s[20:23], s17 offen lds
    s_mov_b64 exec, -1
    v_mfma_f32_16x16x32_bf16 v[168:171], v[176:179], v[156:159], v[168:171]
    s_waitcnt lgkmcnt(7)
    v_mfma_f32_32x32x16_bf16 v[12:27], v[128:131], v[60:63], v[12:27]
    ds_read_b128 v[68:71], v188 offset:32768
    ds_read_b64_tr_b16 v[152:153], v192 offset:41088
    ds_read_b64_tr_b16 v[154:155], v192 offset:42368
    v_lshlrev_b32 v182, 16, v62
    v_and_b32 v183, 0xffff0000, v62
    v_fmac_f32 v180, v182, v182
    v_fmac_f32 v181, v183, v183
    s_add_u32 m0, s29, 0x1000
    s_mov_b64 exec, s[38:39]
    s_add_u32 s17, s28, 0x1b0000
    buffer_load_dwordx4 v10, s[20:23], s17 offen lds
    s_mov_b64 exec, -1
    s_waitcnt lgkmcnt(8)
    v_mfma_f32_32x32x16_bf16 v[28:43], v[132:135], v[60:63], v[28:43]
    ds_read_b64_tr_b16 v[156:157], v192 offset:41152
    ds_read_b64_tr_b16 v[158:159], v192 offset:42432
    v_lshlrev_b32 v184, 16, v63
    v_and_b32 v185, 0xffff0000, v63
    v_fmac_f32 v180, v184, v184
    v_fmac_f32 v181, v185, v185
    s_waitcnt lgkmcnt(7)
    v_mfma_f32_32x32x16_bf16 v[12:27], v[140:143], v[64:67], v[12:27]
    ds_read_b128 v[60:63], v189 offset:32768
    ds_read_b64_tr_b16 v[128:129], v193 offset:41088
    ds_read_b64_tr_b16 v[130:131], v193 offset:42368
    v_lshlrev_b32 v182, 16, v66
    v_and_b32 v183, 0xffff0000, v66
    v_fmac_f32 v180, v182, v182
    v_fmac_f32 v181, v183, v183
    v_mfma_f32_16x16x32_bf16 v[164:167], v[176:179], v[140:143], v[164:167]
    s_waitcnt lgkmcnt(8)
    v_mfma_f32_32x32x16_bf16 v[28:43], v[144:147], v[64:67], v[28:43]
    ds_read_b64_tr_b16 v[132:133], v193 offset:41152
    ds_read_b64_tr_b16 v[134:135], v193 offset:42432
    v_lshlrev_b32 v184, 16, v67
    v_and_b32 v185, 0xffff0000, v67
    v_fmac_f32 v180, v184, v184
    v_fmac_f32 v181, v185, v185
    s_waitcnt vmcnt(5)
    s_barrier
    s_waitcnt lgkmcnt(7)
    v_mfma_f32_32x32x16_bf16 v[12:27], v[152:155], v[68:71], v[12:27]
    ds_read_b128 v[64:67], v186 offset:49152
    ds_read_b64_tr_b16 v[140:141], v190 offset:61568
    ds_read_b64_tr_b16 v[142:143], v190 offset:62848
    v_lshlrev_b32 v182, 16, v70
    v_and_b32 v183, 0xffff0000, v70
    v_fmac_f32 v180, v182, v182
    v_fmac_f32 v181, v183, v183
    s_waitcnt lgkmcnt(8)
    v_mfma_f32_32x32x16_bf16 v[28:43], v[156:159], v[68:71], v[28:43]
    ds_read_b64_tr_b16 v[144:145], v190 offset:61632
    ds_read_b64_tr_b16 v[146:147], v190 offset:62912
    v_lshlrev_b32 v184, 16, v71
    v_and_b32 v185, 0xffff0000, v71
    v_fmac_f32 v180, v184, v184
    v_fmac_f32 v181, v185, v185
    s_waitcnt lgkmcnt(7)
    v_mfma_f32_32x32x16_bf16 v[12:27], v[128:131], v[60:63], v[12:27]
    ds_read_b128 v[68:71], v187 offset:49152
    ds_read_b64_tr_b16 v[152:153], v191 offset:61568
    ds_read_b64_tr_b16 v[154:155], v191 offset:62848
    v_lshlrev_b32 v182, 16, v62
    v_and_b32 v183, 0xffff0000, v62
    v_fmac_f32 v180, v182, v182
    v_fmac_f32 v181, v183, v183
    s_waitcnt lgkmcnt(8)
    v_mfma_f32_32x32x16_bf16 v[28:43], v[132:135], v[60:63], v[28:43]
    ds_read_b64_tr_b16 v[156:157], v191 offset:61632
    ds_read_b64_tr_b16 v[158:159], v191 offset:62912
    v_lshlrev_b32 v184, 16, v63
    v_and_b32 v185, 0xffff0000, v63
    v_fmac_f32 v180, v184, v184
    v_fmac_f32 v181, v185, v185
    v_mfma_f32_16x16x32_bf16 v[168:171], v[176:179], v[132:135], v[168:171]
    s_waitcnt lgkmcnt(7)
    v_mfma_f32_32x32x16_bf16 v[12:27], v[140:143], v[64:67], v[12:27]
    ds_read_b128 v[60:63], v188 offset:49152
    ds_read_b64_tr_b16 v[128:129], v192 offset:61568
    ds_read_b64_tr_b16 v[130:131], v192 offset:62848
    v_lshlrev_b32 v182, 16, v66
    v_and_b32 v183, 0xffff0000, v66
    v_fmac_f32 v180, v182, v182
    v_fmac_f32 v181, v183, v183
    s_waitcnt lgkmcnt(8)
    v_mfma_f32_32x32x16_bf16 v[28:43], v[144:147], v[64:67], v[28:43]
    ds_read_b64_tr_b16 v[132:133], v192 offset:61632
    ds_read_b64_tr_b16 v[134:135], v192 offset:62912
    v_lshlrev_b32 v184, 16, v67
    v_and_b32 v185, 0xffff0000, v67
    v_fmac_f32 v180, v184, v184
    v_fmac_f32 v181, v185, v185
    s_waitcnt lgkmcnt(7)
    v_mfma_f32_32x32x16_bf16 v[12:27], v[152:155], v[68:71], v[12:27]
    ds_read_b128 v[64:67], v189 offset:49152
    ds_read_b64_tr_b16 v[140:141], v193 offset:61568
    ds_read_b64_tr_b16 v[142:143], v193 offset:62848
    v_lshlrev_b32 v182, 16, v70
    v_and_b32 v183, 0xffff0000, v70
    v_fmac_f32 v180, v182, v182
    v_fmac_f32 v181, v183, v183
    v_mfma_f32_16x16x32_bf16 v[164:167], v[176:179], v[152:155], v[164:167]
    s_waitcnt lgkmcnt(8)
    v_mfma_f32_32x32x16_bf16 v[28:43], v[156:159], v[68:71], v[28:43]
    ds_read_b64_tr_b16 v[144:145], v193 offset:61632
    ds_read_b64_tr_b16 v[146:147], v193 offset:62912
    v_lshlrev_b32 v184, 16, v71
    v_and_b32 v185, 0xffff0000, v71
    v_fmac_f32 v180, v184, v184
    v_fmac_f32 v181, v185, v185
    s_waitcnt vmcnt(0)
    s_barrier
    s_waitcnt lgkmcnt(7)
    v_mfma_f32_32x32x16_bf16 v[12:27], v[128:131], v[60:63], v[12:27]
    ds_read_b128 v[68:71], v186
    ds_read_b64_tr_b16 v[152:153], v190 offset:128
    ds_read_b64_tr_b16 v[154:155], v190 offset:1408
    v_lshlrev_b32 v182, 16, v62
    v_and_b32 v183, 0xffff0000, v62
    v_fmac_f32 v180, v182, v182
    v_fmac_f32 v181, v183, v183
    s_waitcnt lgkmcnt(8)
    v_mfma_f32_32x32x16_bf16 v[28:43], v[132:135], v[60:63], v[28:43]
    ds_read_b64_tr_b16 v[156:157], v190 offset:192
    ds_read_b64_tr_b16 v[158:159], v190 offset:1472
    v_lshlrev_b32 v184, 16, v63
    v_and_b32 v185, 0xffff0000, v63
    v_fmac_f32 v180, v184, v184
    v_fmac_f32 v181, v185, v185
    s_waitcnt lgkmcnt(7)
    v_mfma_f32_32x32x16_bf16 v[12:27], v[140:143], v[64:67], v[12:27]
    ds_read_b128 v[60:63], v187
    ds_read_b64_tr_b16 v[128:129], v191 offset:128
    ds_read_b64_tr_b16 v[130:131], v191 offset:1408
    v_lshlrev_b32 v182, 16, v66
    v_and_b32 v183, 0xffff0000, v66
    v_fmac_f32 v180, v182, v182
    v_fmac_f32 v181, v183, v183
    s_waitcnt lgkmcnt(8)
    v_mfma_f32_32x32x16_bf16 v[28:43], v[144:147], v[64:67], v[28:43]
    ds_read_b64_tr_b16 v[132:133], v191 offset:192
    ds_read_b64_tr_b16 v[134:135], v191 offset:1472
    v_lshlrev_b32 v184, 16, v67
    v_and_b32 v185, 0xffff0000, v67
    v_fmac_f32 v180, v184, v184
    v_fmac_f32 v181, v185, v185
    v_mfma_f32_16x16x32_bf16 v[168:171], v[176:179], v[144:147], v[168:171]
    s_waitcnt lgkmcnt(7)
    v_mfma_f32_32x32x16_bf16 v[12:27], v[152:155], v[68:71], v[12:27]
    ds_read_b128 v[64:67], v188
    ds_read_b64_tr_b16 v[140:141], v192 offset:128
    ds_read_b64_tr_b16 v[142:143], v192 offset:1408
    v_lshlrev_b32 v182, 16, v70
    v_and_b32 v183, 0xffff0000, v70
    v_fmac_f32 v180, v182, v182
    v_fmac_f32 v181, v183, v183
    s_waitcnt lgkmcnt(8)
    v_mfma_f32_32x32x16_bf16 v[28:43], v[156:159], v[68:71], v[28:43]
    ds_read_b64_tr_b16 v[144:145], v192 offset:192
    ds_read_b64_tr_b16 v[146:147], v192 offset:1472
    v_lshlrev_b32 v184, 16, v71
    v_and_b32 v185, 0xffff0000, v71
    v_fmac_f32 v180, v184, v184
    v_fmac_f32 v181, v185, v185
    s_waitcnt lgkmcnt(7)
    v_mfma_f32_32x32x16_bf16 v[12:27], v[128:131], v[60:63], v[12:27]
    ds_read_b128 v[68:71], v189
    ds_read_b64_tr_b16 v[152:153], v193 offset:128
    ds_read_b64_tr_b16 v[154:155], v193 offset:1408
    v_lshlrev_b32 v182, 16, v62
    v_and_b32 v183, 0xffff0000, v62
    v_fmac_f32 v180, v182, v182
    v_fmac_f32 v181, v183, v183
    v_mfma_f32_16x16x32_bf16 v[164:167], v[176:179], v[128:131], v[164:167]
    s_waitcnt lgkmcnt(8)
    v_mfma_f32_32x32x16_bf16 v[28:43], v[132:135], v[60:63], v[28:43]
    ds_read_b64_tr_b16 v[156:157], v193 offset:192
    ds_read_b64_tr_b16 v[158:159], v193 offset:1472
    v_lshlrev_b32 v184, 16, v63
    v_and_b32 v185, 0xffff0000, v63
    v_fmac_f32 v180, v184, v184
    v_fmac_f32 v181, v185, v185
    s_waitcnt lgkmcnt(7)
    v_mfma_f32_32x32x16_bf16 v[12:27], v[140:143], v[64:67], v[12:27]
    v_lshlrev_b32 v182, 16, v66
    v_and_b32 v183, 0xffff0000, v66
    v_fmac_f32 v180, v182, v182
    v_fmac_f32 v181, v183, v183
    s_waitcnt lgkmcnt(5)
    v_mfma_f32_32x32x16_bf16 v[28:43], v[144:147], v[64:67], v[28:43]
    v_lshlrev_b32 v184, 16, v67
    v_and_b32 v185, 0xffff0000, v67
    v_fmac_f32 v180, v184, v184
    v_fmac_f32 v181, v185, v185
    s_waitcnt lgkmcnt(2)
    v_mfma_f32_32x32x16_bf16 v[12:27], v[152:155], v[68:71], v[12:27]
    v_lshlrev_b32 v182, 16, v70
    v_and_b32 v183, 0xffff0000, v70
    v_fmac_f32 v180, v182, v182
    v_fmac_f32 v181, v183, v183
    s_waitcnt lgkmcnt(0)
    v_mfma_f32_32x32x16_bf16 v[28:43], v[156:159], v[68:71], v[28:43]
    v_lshlrev_b32 v184, 16, v71
    v_and_b32 v185, 0xffff0000, v71
    v_fmac_f32 v180, v184, v184
    v_fmac_f32 v181, v185, v185
    v_mfma_f32_16x16x32_bf16 v[168:171], v[176:179], v[156:159], v[168:171]
    v_add_f32 v180, v180, v181
    v_mov_b32 v72, v180
    v_lshlrev_b32 v3, 4, v2
    s_lshl_b32 s17, s15, 9
    s_add_u32 s17, s17, 0x24a00
    v_add_u32 v3, s17, v3
    v_permlane32_swap_b32 v180, v72
    v_lshlrev_b32 v4, 4, v1
    s_lshl_b32 s17, s15, 2
    s_add_u32 s17, s17, 0x24000
    v_add_u32 v4, s17, v4
    v_add_f32 v180, v180, v72
    ds_write_b32 v3, v180 offset:4
    s_mov_b64 exec, 0xffff
    ds_write_b32 v4, v164 offset:1024
    ds_write_b32 v4, v165 offset:1280
    ds_write_b32 v4, v168 offset:1536
    ds_write_b32 v4, v169 offset:1792
    s_mov_b64 exec, -1
    v_lshlrev_b32 v4, 4, v2
    v_add_u32 v4, 0x24000, v4
    s_waitcnt lgkmcnt(0)
    s_barrier
    ds_read_b128 v[72:75], v3
    ds_read_b128 v[128:131], v4 offset:1024
    ds_read_b128 v[132:135], v4 offset:1536
    s_waitcnt lgkmcnt(2)
    v_add_f32 v72, v72, v73
    v_mul_f32 v74, 0xbae38e39, v74
    v_mul_f32 v72, 0x3ae38e39, v72
    v_fma_f32 v72, -v74, v74, v72
    v_max_f32 v72, 0, v72
    v_add_f32 v72, 0x3727c5ac, v72
    v_rsq_f32 v73, v72
    v_cvt_pk_bf16_f32 v76, v74, v74
    v_lshlrev_b32 v76, 16, v76
    v_sub_f32 v77, v74, v76
    v_cvt_pk_bf16_f32 v88, v76, v77
    s_mov_b32 exec_lo, 0
    v_mov_b32 v88, 0
    s_mov_b32 exec_lo, -1
    v_mov_b32 v89, v88
    v_mul_f32 v73, s43, v73
    s_waitcnt lgkmcnt(1)
    v_add_f32 v128, v128, v129
    v_add_f32 v130, v130, v131
    v_add_f32 v128, v128, v130
    v_cvt_pk_bf16_f32 v140, v128, v128
    v_lshlrev_b32 v142, 16, v140
    v_sub_f32 v142, v128, v142
    v_cvt_pk_bf16_f32 v141, v142, v142
    s_nop 1
    v_mfma_f32_32x32x8_bf16 v[12:27], v[140:141], v[88:89], v[12:27]
    s_waitcnt lgkmcnt(0)
    v_add_f32 v132, v132, v133
    v_add_f32 v134, v134, v135
    v_add_f32 v132, v132, v134
    v_cvt_pk_bf16_f32 v144, v132, v132
    v_lshlrev_b32 v146, 16, v144
    v_sub_f32 v146, v132, v146
    v_cvt_pk_bf16_f32 v145, v146, v146
    s_nop 1
    v_mfma_f32_32x32x8_bf16 v[28:43], v[144:145], v[88:89], v[28:43]
    s_nop 0
    v_mul_f32 v12, v12, v73
    v_mul_f32 v13, v13, v73
    v_mul_f32 v14, v14, v73
    v_mul_f32 v15, v15, v73
    v_cvt_pk_bf16_f32 v80, v12, v13
    v_cvt_pk_bf16_f32 v81, v14, v15
    ds_write_b64 v213, v[80:81] offset:128
    v_mul_f32 v16, v16, v73
    v_mul_f32 v17, v17, v73
    v_mul_f32 v18, v18, v73
    v_mul_f32 v19, v19, v73
    v_cvt_pk_bf16_f32 v84, v16, v17
    v_cvt_pk_bf16_f32 v85, v18, v19
    ds_write_b64 v213, v[84:85] offset:144
    v_mul_f32 v20, v20, v73
    v_mul_f32 v21, v21, v73
    v_mul_f32 v22, v22, v73
    v_mul_f32 v23, v23, v73
    v_cvt_pk_bf16_f32 v80, v20, v21
    v_cvt_pk_bf16_f32 v81, v22, v23
    ds_write_b64 v213, v[80:81] offset:160
    v_mul_f32 v24, v24, v73
    v_mul_f32 v25, v25, v73
    v_mul_f32 v26, v26, v73
    v_mul_f32 v27, v27, v73
    v_cvt_pk_bf16_f32 v84, v24, v25
    v_cvt_pk_bf16_f32 v85, v26, v27
    ds_write_b64 v213, v[84:85] offset:176
    v_mul_f32 v28, v28, v73
    v_mul_f32 v29, v29, v73
    v_mul_f32 v30, v30, v73
    v_mul_f32 v31, v31, v73
    v_cvt_pk_bf16_f32 v80, v28, v29
    v_cvt_pk_bf16_f32 v81, v30, v31
    ds_write_b64 v213, v[80:81] offset:192
    v_mul_f32 v32, v32, v73
    v_mul_f32 v33, v33, v73
    v_mul_f32 v34, v34, v73
    v_mul_f32 v35, v35, v73
    v_cvt_pk_bf16_f32 v84, v32, v33
    v_cvt_pk_bf16_f32 v85, v34, v35
    ds_write_b64 v213, v[84:85] offset:208
    v_mul_f32 v36, v36, v73
    v_mul_f32 v37, v37, v73
    v_mul_f32 v38, v38, v73
    v_mul_f32 v39, v39, v73
    v_cvt_pk_bf16_f32 v80, v36, v37
    v_cvt_pk_bf16_f32 v81, v38, v39
    ds_write_b64 v213, v[80:81] offset:224
    v_mul_f32 v40, v40, v73
    v_mul_f32 v41, v41, v73
    v_mul_f32 v42, v42, v73
    v_mul_f32 v43, v43, v73
    v_cvt_pk_bf16_f32 v84, v40, v41
    v_cvt_pk_bf16_f32 v85, v42, v43
    ds_write_b64 v213, v[84:85] offset:240
    s_waitcnt lgkmcnt(0)
    s_barrier
L_qkv_out:
    s_cmp_eq_u32 s41, 2
    s_cbranch_scc1 L_qkv_v
    ds_read2_b32 v[80:81], v210 offset0:0 offset1:1
    ds_read2_b32 v[82:83], v210 offset0:2 offset1:3
    ds_read2_b32 v[84:85], v210 offset0:9 offset1:10
    ds_read2_b32 v[86:87], v210 offset0:11 offset1:12
    ds_read2_b32 v[88:89], v210 offset0:18 offset1:19
    ds_read2_b32 v[90:91], v210 offset0:20 offset1:21
    ds_read2_b32 v[92:93], v210 offset0:27 offset1:28
    ds_read2_b32 v[94:95], v210 offset0:29 offset1:30
    s_cmp_eq_u32 s41, 0
    s_cbranch_scc0 L_q_kt_9
    ds_read_b32 v112, v212 offset:32
    ds_read_b32 v113, v212 offset:328
    ds_read_b32 v114, v212 offset:624
    ds_read_b32 v115, v212 offset:920
    s_branch L_q_t_10
L_q_kt_9:
    ds_read_b32 v112, v212 offset:32
    v_mov_b32 v113, 0x3f803f80
    ds_read_b32 v114, v212 offset:328
    v_mov_b32 v115, 0x3f803f80
    ds_read_b32 v116, v212 offset:32
    ds_read_b32 v117, v212 offset:32
L_q_t_10:
    s_waitcnt lgkmcnt(10)
    buffer_store_dwordx4 v[80:83], v214, s[24:27], s44 offen sc1
    s_add_u32 s44, s44, s45
    s_waitcnt lgkmcnt(8)
    buffer_store_dwordx4 v[84:87], v214, s[24:27], s44 offen sc1
    s_add_u32 s44, s44, s45
    s_waitcnt lgkmcnt(6)
    buffer_store_dwordx4 v[88:91], v214, s[24:27], s44 offen sc1
    s_add_u32 s44, s44, s45
    s_waitcnt lgkmcnt(4)
    buffer_store_dwordx4 v[92:95], v214, s[24:27], s44 offen sc1
    s_add_u32 s44, s44, s45
    s_add_u32 s17, s41, s16
    s_cmp_eq_u32 s17, 0
    s_cbranch_scc1 L_qkv_end
    s_waitcnt lgkmcnt(0)
    buffer_store_dwordx4 v[112:115], v211, s[24:27], s46 offen sc1
    s_branch L_qkv_end
L_qkv_v:
    ds_read_b64_tr_b16 v[80:81], v210
    ds_read_b64_tr_b16 v[82:83], v210 offset:1184
    ds_read_b64_tr_b16 v[84:85], v210 offset:32
    ds_read_b64_tr_b16 v[86:87], v210 offset:1216
    ds_read_b64_tr_b16 v[88:89], v210 offset:64
    ds_read_b64_tr_b16 v[90:91], v210 offset:1248
    ds_read_b64_tr_b16 v[92:93], v210 offset:96
    ds_read_b64_tr_b16 v[94:95], v210 offset:1280
    ds_read_b64_tr_b16 v[96:97], v210 offset:128
    ds_read_b64_tr_b16 v[98:99], v210 offset:1312
    s_waitcnt lgkmcnt(8)
    ds_write_b128 v200, v[80:83]
    s_waitcnt lgkmcnt(7)
    ds_write_b128 v201, v[84:87]
    s_waitcnt lgkmcnt(6)
    ds_write_b128 v202, v[88:91]
    s_waitcnt lgkmcnt(5)
    ds_write_b128 v203, v[92:95]
    s_waitcnt lgkmcnt(4)
    s_cmp_eq_u32 s16, 0
    s_cbranch_scc1 L_q_o_11
    v_mov_b32 v96, 0x3f803f80
    v_mov_b32 v97, 0x3f803f80
    v_mov_b32 v98, 0x3f803f80
    v_mov_b32 v99, 0x3f803f80
L_q_o_11:
    ds_write_b128 v204, v[96:99]
    s_waitcnt lgkmcnt(0)
    s_barrier
    ds_read_b128 v[72:75], v212
    ds_read_b128 v[76:79], v212 offset:1024
    ds_read_b128 v[80:83], v212 offset:2048
    ds_read_b128 v[84:87], v212 offset:3072
    ds_read_b128 v[88:91], v212 offset:4096
    s_waitcnt lgkmcnt(4)
    buffer_store_dwordx4 v[72:75], v205, s[24:27], s44 offen sc1
    s_waitcnt lgkmcnt(3)
    buffer_store_dwordx4 v[76:79], v206, s[24:27], s44 offen sc1
    s_waitcnt lgkmcnt(2)
    buffer_store_dwordx4 v[80:83], v207, s[24:27], s44 offen sc1
    s_waitcnt lgkmcnt(1)
    buffer_store_dwordx4 v[84:87], v208, s[24:27], s44 offen sc1
    s_waitcnt lgkmcnt(0)
    buffer_store_dwordx4 v[88:91], v209, s[24:27], s44 offen sc1
    s_endpgm
L_qkv_pack:
    s_load_dwordx4 s[4:7], s[0:1], 0
    v_lshrrev_b32 v1, 6, v0
    v_and_b32 v2, 63, v0
    v_readfirstlane_b32 s13, v1
    s_and_b32 s8, s2, 7
    s_sub_u32 s10, s2, 0xc0
    s_lshr_b32 s10, s10, 3
    s_lshl_b32 s10, s10, 2
    s_and_b32 s9, s13, 3
    s_add_u32 s9, s9, s10
    s_cmp_ge_u32 s13, 4
    s_cbranch_scc1 L_pf_e_12
    s_cmp_ge_u32 s9, 22
    s_cbranch_scc1 L_qkv_end
    s_waitcnt lgkmcnt(0)
    s_cmp_ge_u32 s9, 14
    s_cbranch_scc1 L_pf_x_13
    s_mov_b32 s16, s6
    s_and_b32 s17, s7, 0xffff
    s_mov_b32 s18, 0x1e6000
    s_mov_b32 s19, 0x20000
    v_mul_u32_u24 v3, 0xd80, v2
    s_and_b32 s10, s8, 1
    s_mul_i32 s10, s10, 13
    s_add_u32 s11, s10, s9
    s_lshl_b32 s11, s11, 7
    s_mov_b32 s12, 0x36000
    s_branch L_pf_go_14
L_pf_x_13:
    s_mov_b32 s16, s4
    s_and_b32 s17, s5, 0xffff
    s_mov_b32 s18, 0x240000
    s_mov_b32 s19, 0x20000
    v_mul_u32_u24 v3, 0x480, v2
    s_lshr_b32 s10, s8, 1
    s_lshl_b32 s10, s10, 3
    s_add_u32 s10, s10, s9
    s_sub_u32 s10, s10, 14
    s_mul_i32 s11, s10, 0x12000
    s_mov_b32 s12, 0x80
L_pf_go_14:
    buffer_load_dword v4, v3, s[16:19], s11 offen
    s_add_u32 s11, s11, s12
    buffer_load_dword v4, v3, s[16:19], s11 offen
    s_add_u32 s11, s11, s12
    s_sleep 16
    buffer_load_dword v4, v3, s[16:19], s11 offen
    s_add_u32 s11, s11, s12
    buffer_load_dword v4, v3, s[16:19], s11 offen
    s_add_u32 s11, s11, s12
    buffer_load_dword v4, v3, s[16:19], s11 offen
    s_add_u32 s11, s11, s12
    buffer_load_dword v4, v3, s[16:19], s11 offen
    s_add_u32 s11, s11, s12
    buffer_load_dword v4, v3, s[16:19], s11 offen
    s_add_u32 s11, s11, s12
    buffer_load_dword v4, v3, s[16:19], s11 offen
    s_add_u32 s11, s11, s12
    buffer_load_dword v4, v3, s[16:19], s11 offen
    s_add_u32 s11, s11, s12
    s_waitcnt vmcnt(0)
    s_endpgm
L_pf_e_12:
    s_cmp_ge_u32 s9, 30
    s_cbranch_scc1 L_qkv_end
    v_lshrrev_b32 v1, 4, v2
    v_and_b32 v2, 15, v2
    s_waitcnt lgkmcnt(0)
    s_cmp_ge_u32 s9, 14
    s_cbranch_scc1 L_pf_x_15
    s_mov_b32 s16, s6
    s_and_b32 s17, s7, 0xffff
    s_mov_b32 s18, 0x1e6000
    s_mov_b32 s19, 0x20000
    v_lshl_add_u32 v3, v1, 4, v2
    v_mul_u32_u24 v3, 0x3600, v3
    s_and_b32 s10, s8, 1
    s_mul_i32 s10, s10, 13
    s_add_u32 s11, s10, s9
    s_lshl_b32 s11, s11, 7
    s_lshr_b32 s10, s8, 1
    s_add_u32 s10, s10, 64
    s_mul_i32 s10, s10, 0xd80
    s_add_u32 s11, s11, s10
    s_mov_b32 s12, 0xd8000
    s_branch L_pf_go_16
L_pf_x_15:
    s_mov_b32 s16, s4
    s_and_b32 s17, s5, 0xffff
    s_mov_b32 s18, 0x240000
    s_mov_b32 s19, 0x20000
    v_mul_u32_u24 v3, 0x480, v2
    v_lshl_add_u32 v3, v1, 7, v3
    s_lshl_b32 s10, s8, 4
    s_add_u32 s10, s10, s9
    s_sub_u32 s10, s10, 14
    s_mul_i32 s11, s10, 0x4800
    s_add_u32 s11, s11, 0x80
    s_mov_b32 s12, 0x200
L_pf_go_16:
    buffer_load_dword v4, v3, s[16:19], s11 offen
    s_add_u32 s11, s11, s12
    buffer_load_dword v4, v3, s[16:19], s11 offen
    s_add_u32 s11, s11, s12
    s_waitcnt vmcnt(0)
L_qkv_end:
    s_endpgm
.text
.globl attn_kernel
.p2align 8
.type attn_kernel,@function
attn_kernel:
    s_cmp_ge_u32 s2, 0x100
    s_cbranch_scc1 L_at_end
    s_load_dwordx2 s[4:5], s[0:1], 0x48
    s_load_dwordx8 s[8:15], s[0:1], 16
    s_load_dwordx2 s[16:17], s[0:1], 48
    s_and_b32 s18, s2, 7
    s_lshr_b32 s19, s2, 3
    s_lshl_b32 s20, s18, 2
    s_and_b32 s23, s19, 3
    s_add_u32 s20, s20, s23
    s_lshr_b32 s21, s19, 2
    v_lshrrev_b32 v3, 6, v0
    v_and_b32 v1, 63, v0
    v_readfirstlane_b32 s22, v3
    v_lshlrev_b32 v2, 4, v1
    s_lshl_b32 s21, s21, 3
    s_add_u32 s21, s21, s22
    s_mul_i32 s24, s20, 0x28000
    s_lshl_b32 s27, s22, 10
    s_add_u32 s24, s24, s27
    s_lshl_b32 s23, s20, 6
    s_add_u32 s23, s23, s21
    s_lshl_b32 s25, s23, 10
    s_lshl_b32 s26, s23, 7
    v_and_b32 v8, 31, v1
    v_lshlrev_b32 v6, 3, v8
    v_add_u32 v6, 0x400, v6
    v_min_u32 v3, 18, v8
    v_subrev_u32 v4, 20, v8
    v_cmp_gt_u32 vcc, 8, v4
    s_nop 1
    v_cndmask_b32 v3, v3, 0, vcc
    v_lshrrev_b32 v4, 5, v1
    v_mul_u32_u24 v4, 20, v4
    v_add_u32 v3, v3, v4
    v_lshlrev_b32 v7, 4, v3
    v_add_u32 v7, 0x500, v7
    v_lshlrev_b32 v5, 2, v8
    s_waitcnt lgkmcnt(0)
    s_add_u32 s28, s4, 0x240000
    s_addc_u32 s29, s5, 0
    s_and_b32 s29, s29, 0xffff
    s_mov_b32 s30, 0x500000
    s_mov_b32 s31, 0x20000
    s_mov_b32 s32, s4
    s_and_b32 s33, s5, 0xffff
    s_mov_b32 s34, 0x200000
    s_mov_b32 s35, 0x20000
    s_add_u32 s36, s4, 0x200000
    s_addc_u32 s37, s5, 0
    s_and_b32 s37, s37, 0xffff
    s_mov_b32 s38, 0x40000
    s_mov_b32 s39, 0x20000
    s_add_u32 s40, s4, 0x800000
    s_addc_u32 s41, s5, 0
    s_and_b32 s41, s41, 0xffff
    s_mov_b32 s42, 0x240000
    s_mov_b32 s43, 0x20000
    s_mov_b32 m0, s27
    s_add_u32 s27, s27, 0x2000
    buffer_load_dwordx4 v2, s[28:31], s24 offen lds
    s_add_u32 s24, s24, 0x2000
    s_mov_b32 m0, s27
    s_add_u32 s27, s27, 0x2000
    buffer_load_dwordx4 v2, s[28:31], s24 offen lds
    s_add_u32 s24, s24, 0x2000
    buffer_load_dwordx4 v[12:15], v2, s[32:35], s25 offen
    buffer_load_dword v16, v5, s[36:39], s26 offen
    s_barrier
    s_mov_b32 m0, s27
    s_add_u32 s27, s27, 0x2000
    buffer_load_dwordx4 v2, s[28:31], s24 offen lds
    s_add_u32 s24, s24, 0x2000
    s_mov_b32 m0, s27
    s_add_u32 s27, s27, 0x2000
    buffer_load_dwordx4 v2, s[28:31], s24 offen lds
    s_add_u32 s24, s24, 0x2000
    s_mov_b32 m0, s27
    s_add_u32 s27, s27, 0x2000
    buffer_load_dwordx4 v2, s[28:31], s24 offen lds
    s_add_u32 s24, s24, 0x2000
    s_lshl_b32 s70, s22, 5
    s_add_u32 s70, s70, s2
    s_and_b32 s70, s70, 0xff
    s_lshr_b32 s71, s70, 3
    s_mov_b32 s66, -1
    s_mul_i32 s67, s18, 9
    s_add_u32 s67, s67, s71
    s_cmp_lt_u32 s71, 9
    s_cbranch_scc1 L_pj_18
    s_mov_b32 s67, s18
    s_cmp_eq_u32 s71, 9
    s_cbranch_scc1 L_pj_19
    s_mov_b32 s67, 8
    s_cmp_eq_u32 s70, 0xff
    s_cbranch_scc1 L_pj_19
    s_sub_u32 s69, s70, 0x50
    s_lshl_b32 s69, s69, 3
    s_add_u32 s69, s69, s22
    s_cmp_lt_u32 s69, 0x510
    s_cbranch_scc1 L_pj_17
    s_sub_u32 s69, s69, 0x510
    s_mov_b32 s67, s69
    s_cmp_lt_u32 s69, 0x48
    s_cbranch_scc1 L_pj_20
L_pj_17:
    s_and_b32 s68, s69, 1
    s_lshr_b32 s69, s69, 1
    s_mul_i32 s62, s69, 0x38f
    s_lshr_b32 s62, s62, 16
    s_mul_i32 s67, s62, 0x48
    s_sub_u32 s67, s69, s67
    s_mov_b32 s69, s62
    s_cmp_eq_u32 s68, 0
    s_cselect_b32 s44, s12, s14
    s_cselect_b32 s45, s13, s15
    s_mov_b32 s46, 0x510000
    s_mul_i32 s56, s69, 0x90000
    s_lshl_b32 s62, s67, 7
    s_add_u32 s56, s56, s62
    s_mul_i32 s66, s69, 0x2400
    s_add_u32 s66, s66, s62
    s_lshl_b32 s62, s68, 6
    s_add_u32 s66, s66, s62
    s_lshl_b32 s66, s66, 2
    s_mul_i32 s59, s67, 36
    s_add_u32 s59, s59, s69
    s_lshl_b32 s59, s59, 12
    s_lshl_b32 s62, s68, 10
    s_add_u32 s59, s59, s62
    s_mov_b32 s57, 0x2400
    s_mov_b32 s58, 0x9000
    s_mov_b32 s60, 0x9000
    s_mov_b32 s61, 0x80
    s_mov_b32 s62, 0x12000
    s_mov_b32 s63, 0x24000
    s_mov_b32 s64, 0x100
    s_mov_b32 s65, 0x800
    s_branch L_pj_22
L_pj_20:
    s_mov_b32 s56, 0x400
    s_mov_b32 s59, 0xc02000
    s_mov_b32 s60, 0x144000
    s_branch L_pj_21
L_pj_18:
    s_lshr_b32 s64, s22, 1
    s_and_b32 s65, s22, 1
    s_lshl_b32 s56, s22, 7
    s_mul_i32 s59, s64, 0x144000
    s_lshl_b32 s62, s65, 12
    s_add_u32 s59, s59, s62
    s_add_u32 s59, s59, 0xc00000
    s_mov_b32 s60, 0x400
L_pj_21:
    s_mov_b32 s44, s16
    s_mov_b32 s45, s17
    s_mov_b32 s46, 0x510000
    s_mul_i32 s64, s67, 0x12000
    s_add_u32 s56, s56, s64
    s_mul_i32 s64, s67, 0x4800
    s_add_u32 s59, s59, s64
    s_mov_b32 s57, 0x2400
    s_mov_b32 s58, 0x480
    s_mov_b32 s62, 0x9000
    s_mov_b32 s63, 0x900
    s_mov_b32 s64, 0x100
    s_mov_b32 s65, 0x2400
    s_mov_b32 s66, -2
    s_mov_b32 s61, 0x80
    s_branch L_pj_22
L_pj_19:
    s_mov_b32 s44, s8
    s_mov_b32 s45, s9
    s_mov_b32 s46, 0xa2000
    s_mul_i32 s56, s67, 0x14400
    s_mul_i32 s59, s67, 0x2400
    s_add_u32 s59, s59, 0x1200000
    s_cmp_eq_u32 s67, 8
    s_cselect_b32 s56, 0x4800, s56
    s_cselect_b32 s57, 18, 1
    s_mul_i32 s57, s57, 0x480
    s_cselect_b32 s58, 1, 4
    s_mul_i32 s58, s58, 0x480
    s_cselect_b32 s62, 9, 1
    s_mul_i32 s62, s62, 0x2400
    s_cselect_b32 s63, 8, 1
    s_mul_i32 s63, s63, 0x5100
    s_mul_i32 s64, s22, 0x90
    s_add_u32 s56, s56, s64
    s_mul_i32 s64, s22, 0x14400
    s_add_u32 s59, s59, s64
    s_mov_b32 s64, 0x100
    s_mov_b32 s65, 0x1000
    s_mov_b32 s60, 0x400
    s_mov_b32 s61, 0x80
L_pj_22:
    s_and_b32 s45, s45, 0xffff
    s_mov_b32 s47, 0x20000
    s_add_u32 s48, s4, 0x2400000
    s_addc_u32 s49, s5, 0
    s_and_b32 s49, s49, 0xffff
    s_mov_b32 s50, 0x2400000
    s_mov_b32 s51, 0x20000
    s_add_u32 s52, s4, 0xd80000
    s_addc_u32 s53, s5, 0
    s_and_b32 s53, s53, 0xffff
    s_mov_b32 s54, 0x51000
    s_mov_b32 s55, 0x20000
    v_and_b32 v3, 7, v1
    v_lshlrev_b32 v168, 4, v3
    v_lshlrev_b32 v169, 4, v3
    v_lshlrev_b32 v170, 3, v3
    v_lshlrev_b32 v171, 1, v3
    v_add_u32 v171, 0x80, v171
    v_bfe_u32 v4, v1, 3, 1
    v_mad_u32_u24 v168, v4, s62, v168
    v_lshlrev_b32 v3, 1, v4
    v_lshrrev_b32 v4, 4, v1
    v_mad_u32_u24 v168, v4, s63, v168
    v_lshl_add_u32 v170, v4, 6, v170
    v_lshrrev_b32 v4, 5, v1
    v_mad_u32_u24 v169, v4, s65, v169
    v_add_u32 v3, v3, v4
    v_mad_u32_u24 v171, v3, s63, v171
    v_bfe_u32 v4, v1, 4, 1
    v_mad_u32_u24 v171, v4, s62, v171
    v_bfe_u32 v4, v1, 3, 2
    v_mad_u32_u24 v169, v4, s64, v169
    v_mov_b32 v172, 0x3f803f80
    v_mov_b32 v173, 0x3f803f80
    v_mov_b32 v174, 0x3f803f80
    v_mov_b32 v175, 0x3f803f80
    s_mov_b32 s8, 0xffff0000
    s_mov_b32 s9, 0
    s_mov_b32 s10, 0
    s_mov_b32 s11, 0xffff
    s_mov_b32 s12, 0
    s_mov_b32 s13, 0xffff0000
    s_mov_b32 s62, 0x5040100
    s_mov_b32 s63, 0x7060302
    v_mov_b32 v17, 0
    s_mov_b32 s72, 0
    s_mov_b32 s73, 8
    s_mov_b32 s75, 0
    s_waitcnt vmcnt(3)
    s_barrier
    s_mov_b32 exec_lo, 0
    v_mov_b32 v16, 0
    s_mov_b32 exec_lo, -1
    ds_read_b64 v[80:81], v6
    ds_read_b128 v[76:79], v2
    s_waitcnt lgkmcnt(0)
    v_mfma_f32_32x32x8_bf16 v[20:35], v[80:81], v[16:17], 0
    v_mfma_f32_32x32x16_bf16 v[20:35], v[76:79], v[12:15], v[20:35]
    s_nop 11
    v_max3_f32 v92, v20, v21, v22
    v_max_f32 v92, v92, v35
    v_max3_f32 v92, v92, v23, v24
    v_max3_f32 v92, v92, v25, v26
    v_max3_f32 v92, v92, v27, v28
    v_max3_f32 v92, v92, v29, v30
    v_max3_f32 v92, v92, v31, v32
    v_max3_f32 v92, v92, v33, v34
    v_mov_b32 v93, v92
    s_nop 1
    v_permlane32_swap_b32 v92, v93
    v_max_f32 v92, v92, v93
    v_mul_f32 v92, -1.0, v92
    v_cvt_pk_bf16_f32 v93, v92, v92
    v_lshlrev_b32 v93, 16, v93
    v_sub_f32 v92, v92, v93
    s_mov_b32 exec_hi, 0
    v_cvt_pk_bf16_f32 v17, v93, v92
    s_mov_b32 exec_hi, -1
L_at_run:
    v_mov_b32 v9, v2
    v_mov_b32 v10, v6
    v_mov_b32 v11, v7
    ds_read_b64 v[80:81], v6
    ds_read_b128 v[76:79], v2
    v_mov_b32 v52, 0
    v_mov_b32 v53, 0
    v_mov_b32 v54, 0
    v_mov_b32 v55, 0
    v_mov_b32 v56, 0
    v_mov_b32 v57, 0
    v_mov_b32 v58, 0
    v_mov_b32 v59, 0
    v_mov_b32 v60, 0
    v_mov_b32 v61, 0
    v_mov_b32 v62, 0
    v_mov_b32 v63, 0
    v_mov_b32 v64, 0
    v_mov_b32 v65, 0
    v_mov_b32 v66, 0
    v_mov_b32 v67, 0
    s_mov_b32 s74, 0
    s_waitcnt lgkmcnt(0)
    v_mfma_f32_32x32x8_bf16 v[20:35], v[80:81], v[16:17], 0
    v_mfma_f32_32x32x16_bf16 v[20:35], v[76:79], v[12:15], v[20:35]
    ds_read_b64 v[80:81], v6 offset:2560
    ds_read_b128 v[76:79], v2 offset:2560
    ds_read_b128 v[84:87], v7
    ds_read_b128 v[88:91], v7 offset:640
L_at_loop:
    s_cmp_eq_u32 s74, s72
    s_cbranch_scc1 L_at_spa
    s_cmp_eq_u32 s74, s73
    s_cbranch_scc1 L_at_spb
    s_waitcnt lgkmcnt(2)
    v_mfma_f32_32x32x8_bf16 v[36:51], v[80:81], v[16:17], 0
    s_nop 1
    v_exp_f32 v20, v20
    v_exp_f32 v21, v21
    v_exp_f32 v22, v22
    v_exp_f32 v23, v23
    v_mfma_f32_32x32x16_bf16 v[36:51], v[76:79], v[12:15], v[36:51]
    ds_read_b64 v[80:81], v10 offset:5120
    ds_read_b128 v[76:79], v9 offset:5120
    v_exp_f32 v24, v24
    v_exp_f32 v25, v25
    v_exp_f32 v26, v26
    v_exp_f32 v27, v27
    v_cvt_pk_bf16_f32 v68, v20, v21
    v_cvt_pk_bf16_f32 v69, v22, v23
    v_cvt_pk_bf16_f32 v70, v24, v25
    v_cvt_pk_bf16_f32 v71, v26, v27
    v_exp_f32 v28, v28
    v_exp_f32 v29, v29
    s_waitcnt lgkmcnt(3)
    v_mfma_f32_32x32x16_bf16 v[52:67], v[84:87], v[68:71], v[52:67]
    ds_read_b128 v[84:87], v11 offset:2560
    v_exp_f32 v30, v30
    v_exp_f32 v31, v31
    v_exp_f32 v32, v32
    v_exp_f32 v33, v33
    v_exp_f32 v34, v34
    v_exp_f32 v35, v35
    v_cvt_pk_bf16_f32 v72, v28, v29
    v_cvt_pk_bf16_f32 v73, v30, v31
    v_cvt_pk_bf16_f32 v74, v32, v33
    v_cvt_pk_bf16_f32 v75, v34, v35
    s_waitcnt lgkmcnt(3)
    s_nop 0
    v_mfma_f32_32x32x16_bf16 v[52:67], v[88:91], v[72:75], v[52:67]
    ds_read_b128 v[88:91], v11 offset:3200
    s_waitcnt lgkmcnt(2)
    v_mfma_f32_32x32x8_bf16 v[20:35], v[80:81], v[16:17], 0
    v_exp_f32 v36, v36
    v_exp_f32 v37, v37
    v_exp_f32 v38, v38
    v_exp_f32 v39, v39
    v_mfma_f32_32x32x16_bf16 v[20:35], v[76:79], v[12:15], v[20:35]
    ds_read_b64 v[80:81], v10 offset:7680
    ds_read_b128 v[76:79], v9 offset:7680
    v_exp_f32 v40, v40
    v_exp_f32 v41, v41
    v_exp_f32 v42, v42
    v_exp_f32 v43, v43
    v_cvt_pk_bf16_f32 v68, v36, v37
    v_cvt_pk_bf16_f32 v69, v38, v39
    v_cvt_pk_bf16_f32 v70, v40, v41
    v_cvt_pk_bf16_f32 v71, v42, v43
    v_exp_f32 v44, v44
    v_exp_f32 v45, v45
    s_waitcnt lgkmcnt(3)
    v_mfma_f32_32x32x16_bf16 v[52:67], v[84:87], v[68:71], v[52:67]
    ds_read_b128 v[84:87], v11 offset:5120
    v_exp_f32 v46, v46
    v_exp_f32 v47, v47
    v_exp_f32 v48, v48
    v_exp_f32 v49, v49
    v_exp_f32 v50, v50
    v_exp_f32 v51, v51
    v_cvt_pk_bf16_f32 v72, v44, v45
    v_cvt_pk_bf16_f32 v73, v46, v47
    v_cvt_pk_bf16_f32 v74, v48, v49
    v_cvt_pk_bf16_f32 v75, v50, v51
    s_waitcnt lgkmcnt(3)
    s_nop 0
    v_mfma_f32_32x32x16_bf16 v[52:67], v[88:91], v[72:75], v[52:67]
    ds_read_b128 v[88:91], v11 offset:5760
    s_waitcnt lgkmcnt(2)
    v_mfma_f32_32x32x8_bf16 v[36:51], v[80:81], v[16:17], 0
    v_exp_f32 v20, v20
    v_exp_f32 v21, v21
    v_exp_f32 v22, v22
    v_exp_f32 v23, v23
    v_mfma_f32_32x32x16_bf16 v[36:51], v[76:79], v[12:15], v[36:51]
    ds_read_b64 v[80:81], v10 offset:10240
    ds_read_b128 v[76:79], v9 offset:10240
    v_exp_f32 v24, v24
    v_exp_f32 v25, v25
    v_exp_f32 v26, v26
    v_exp_f32 v27, v27
    v_cvt_pk_bf16_f32 v68, v20, v21
    v_cvt_pk_bf16_f32 v69, v22, v23
    v_cvt_pk_bf16_f32 v70, v24, v25
    v_cvt_pk_bf16_f32 v71, v26, v27
    v_exp_f32 v28, v28
    v_exp_f32 v29, v29
    s_waitcnt lgkmcnt(3)
    v_mfma_f32_32x32x16_bf16 v[52:67], v[84:87], v[68:71], v[52:67]
    ds_read_b128 v[84:87], v11 offset:7680
    v_exp_f32 v30, v30
    v_exp_f32 v31, v31
    v_exp_f32 v32, v32
    v_exp_f32 v33, v33
    v_exp_f32 v34, v34
    v_exp_f32 v35, v35
    v_cvt_pk_bf16_f32 v72, v28, v29
    v_cvt_pk_bf16_f32 v73, v30, v31
    v_cvt_pk_bf16_f32 v74, v32, v33
    v_cvt_pk_bf16_f32 v75, v34, v35
    s_waitcnt lgkmcnt(3)
    s_nop 0
    v_mfma_f32_32x32x16_bf16 v[52:67], v[88:91], v[72:75], v[52:67]
    ds_read_b128 v[88:91], v11 offset:8320
    s_waitcnt lgkmcnt(2)
    v_mfma_f32_32x32x8_bf16 v[20:35], v[80:81], v[16:17], 0
    v_exp_f32 v36, v36
    v_exp_f32 v37, v37
    v_exp_f32 v38, v38
    v_exp_f32 v39, v39
    v_mfma_f32_32x32x16_bf16 v[20:35], v[76:79], v[12:15], v[20:35]
    ds_read_b64 v[80:81], v10 offset:12800
    ds_read_b128 v[76:79], v9 offset:12800
    v_exp_f32 v40, v40
    v_exp_f32 v41, v41
    v_exp_f32 v42, v42
    v_exp_f32 v43, v43
    v_cvt_pk_bf16_f32 v68, v36, v37
    v_cvt_pk_bf16_f32 v69, v38, v39
    v_cvt_pk_bf16_f32 v70, v40, v41
    v_cvt_pk_bf16_f32 v71, v42, v43
    v_exp_f32 v44, v44
    v_exp_f32 v45, v45
    s_waitcnt lgkmcnt(3)
    v_mfma_f32_32x32x16_bf16 v[52:67], v[84:87], v[68:71], v[52:67]
    ds_read_b128 v[84:87], v11 offset:10240
    v_exp_f32 v46, v46
    v_exp_f32 v47, v47
    v_exp_f32 v48, v48
    v_exp_f32 v49, v49
    v_exp_f32 v50, v50
    v_exp_f32 v51, v51
    v_cvt_pk_bf16_f32 v72, v44, v45
    v_cvt_pk_bf16_f32 v73, v46, v47
    v_cvt_pk_bf16_f32 v74, v48, v49
    v_cvt_pk_bf16_f32 v75, v50, v51
    v_add_u32 v9, 0x2800, v9
    v_add_u32 v10, 0x2800, v10
    s_waitcnt lgkmcnt(3)
    v_mfma_f32_32x32x16_bf16 v[52:67], v[88:91], v[72:75], v[52:67]
    ds_read_b128 v[88:91], v11 offset:10880
    v_add_u32 v11, 0x2800, v11
    s_add_u32 s74, s74, 1
    s_cmp_lt_u32 s74, 16
    s_cbranch_scc1 L_at_loop
    s_branch L_at_done
L_at_spa:
    s_waitcnt lgkmcnt(2)
    v_mfma_f32_32x32x8_bf16 v[36:51], v[80:81], v[16:17], 0
    s_nop 3
    v_exp_f32 v20, v20
    v_exp_f32 v21, v21
    v_exp_f32 v22, v22
    v_exp_f32 v23, v23
    v_mfma_f32_32x32x16_bf16 v[36:51], v[76:79], v[12:15], v[36:51]
    ds_read_b64 v[80:81], v10 offset:5120
    ds_read_b128 v[76:79], v9 offset:5120
    s_mov_b32 m0, s27
    s_add_u32 s27, s27, 0x2000
    buffer_load_dwordx4 v2, s[28:31], s24 offen lds
    s_add_u32 s24, s24, 0x2000
    v_exp_f32 v24, v24
    v_exp_f32 v25, v25
    v_exp_f32 v26, v26
    v_exp_f32 v27, v27
    v_cvt_pk_bf16_f32 v68, v20, v21
    v_cvt_pk_bf16_f32 v69, v22, v23
    v_cvt_pk_bf16_f32 v70, v24, v25
    v_cvt_pk_bf16_f32 v71, v26, v27
    v_exp_f32 v28, v28
    v_exp_f32 v29, v29
    s_waitcnt lgkmcnt(3)
    v_mfma_f32_32x32x16_bf16 v[52:67], v[84:87], v[68:71], v[52:67]
    ds_read_b128 v[84:87], v11 offset:2560
    s_mov_b32 m0, s27
    s_add_u32 s27, s27, 0x2000
    buffer_load_dwordx4 v2, s[28:31], s24 offen lds
    s_add_u32 s24, s24, 0x2000
    v_exp_f32 v30, v30
    v_exp_f32 v31, v31
    v_exp_f32 v32, v32
    v_exp_f32 v33, v33
    v_exp_f32 v34, v34
    v_exp_f32 v35, v35
    v_cvt_pk_bf16_f32 v72, v28, v29
    v_cvt_pk_bf16_f32 v73, v30, v31
    v_cvt_pk_bf16_f32 v74, v32, v33
    v_cvt_pk_bf16_f32 v75, v34, v35
    s_waitcnt lgkmcnt(3)
    s_nop 0
    v_mfma_f32_32x32x16_bf16 v[52:67], v[88:91], v[72:75], v[52:67]
    ds_read_b128 v[88:91], v11 offset:3200
    s_mov_b32 m0, s27
    s_add_u32 s27, s27, 0x2000
    buffer_load_dwordx4 v2, s[28:31], s24 offen lds
    s_add_u32 s24, s24, 0x2000
    s_waitcnt lgkmcnt(2)
    v_mfma_f32_32x32x8_bf16 v[20:35], v[80:81], v[16:17], 0
    v_exp_f32 v36, v36
    v_exp_f32 v37, v37
    v_exp_f32 v38, v38
    v_exp_f32 v39, v39
    v_mfma_f32_32x32x16_bf16 v[20:35], v[76:79], v[12:15], v[20:35]
    ds_read_b64 v[80:81], v10 offset:7680
    ds_read_b128 v[76:79], v9 offset:7680
    s_mov_b32 m0, s27
    s_add_u32 s27, s27, 0x2000
    buffer_load_dwordx4 v2, s[28:31], s24 offen lds
    s_add_u32 s24, s24, 0x2000
    v_exp_f32 v40, v40
    v_exp_f32 v41, v41
    v_exp_f32 v42, v42
    v_exp_f32 v43, v43
    v_cvt_pk_bf16_f32 v68, v36, v37
    v_cvt_pk_bf16_f32 v69, v38, v39
    v_cvt_pk_bf16_f32 v70, v40, v41
    v_cvt_pk_bf16_f32 v71, v42, v43
    v_exp_f32 v44, v44
    v_exp_f32 v45, v45
    s_waitcnt lgkmcnt(3)
    v_mfma_f32_32x32x16_bf16 v[52:67], v[84:87], v[68:71], v[52:67]
    ds_read_b128 v[84:87], v11 offset:5120
    s_mov_b32 m0, s27
    s_add_u32 s27, s27, 0x2000
    buffer_load_dwordx4 v2, s[28:31], s24 offen lds
    s_add_u32 s24, s24, 0x2000
    v_exp_f32 v46, v46
    v_exp_f32 v47, v47
    v_exp_f32 v48, v48
    v_exp_f32 v49, v49
    v_exp_f32 v50, v50
    v_exp_f32 v51, v51
    v_cvt_pk_bf16_f32 v72, v44, v45
    v_cvt_pk_bf16_f32 v73, v46, v47
    v_cvt_pk_bf16_f32 v74, v48, v49
    v_cvt_pk_bf16_f32 v75, v50, v51
    s_waitcnt lgkmcnt(3)
    s_nop 0
    v_mfma_f32_32x32x16_bf16 v[52:67], v[88:91], v[72:75], v[52:67]
    ds_read_b128 v[88:91], v11 offset:5760
    s_mov_b32 m0, s27
    s_add_u32 s27, s27, 0x2000
    buffer_load_dwordx4 v2, s[28:31], s24 offen lds
    s_add_u32 s24, s24, 0x2000
    s_waitcnt lgkmcnt(2)
    v_mfma_f32_32x32x8_bf16 v[36:51], v[80:81], v[16:17], 0
    v_exp_f32 v20, v20
    v_exp_f32 v21, v21
    v_exp_f32 v22, v22
    v_exp_f32 v23, v23
    v_mfma_f32_32x32x16_bf16 v[36:51], v[76:79], v[12:15], v[36:51]
    ds_read_b64 v[80:81], v10 offset:10240
    ds_read_b128 v[76:79], v9 offset:10240
    v_exp_f32 v24, v24
    v_exp_f32 v25, v25
    v_exp_f32 v26, v26
    v_exp_f32 v27, v27
    v_cvt_pk_bf16_f32 v68, v20, v21
    v_cvt_pk_bf16_f32 v69, v22, v23
    v_cvt_pk_bf16_f32 v70, v24, v25
    v_cvt_pk_bf16_f32 v71, v26, v27
    v_exp_f32 v28, v28
    v_exp_f32 v29, v29
    s_waitcnt lgkmcnt(3)
    v_mfma_f32_32x32x16_bf16 v[52:67], v[84:87], v[68:71], v[52:67]
    ds_read_b128 v[84:87], v11 offset:7680
    v_exp_f32 v30, v30
    v_exp_f32 v31, v31
    v_exp_f32 v32, v32
    v_exp_f32 v33, v33
    v_exp_f32 v34, v34
    v_exp_f32 v35, v35
    v_cvt_pk_bf16_f32 v72, v28, v29
    v_cvt_pk_bf16_f32 v73, v30, v31
    v_cvt_pk_bf16_f32 v74, v32, v33
    v_cvt_pk_bf16_f32 v75, v34, v35
    s_waitcnt lgkmcnt(3)
    s_nop 0
    v_mfma_f32_32x32x16_bf16 v[52:67], v[88:91], v[72:75], v[52:67]
    ds_read_b128 v[88:91], v11 offset:8320
    s_waitcnt lgkmcnt(2)
    v_mfma_f32_32x32x8_bf16 v[20:35], v[80:81], v[16:17], 0
    v_exp_f32 v36, v36
    v_exp_f32 v37, v37
    v_exp_f32 v38, v38
    v_exp_f32 v39, v39
    v_mfma_f32_32x32x16_bf16 v[20:35], v[76:79], v[12:15], v[20:35]
    ds_read_b64 v[80:81], v10 offset:12800
    ds_read_b128 v[76:79], v9 offset:12800
    v_exp_f32 v40, v40
    v_exp_f32 v41, v41
    v_exp_f32 v42, v42
    v_exp_f32 v43, v43
    v_cvt_pk_bf16_f32 v68, v36, v37
    v_cvt_pk_bf16_f32 v69, v38, v39
    v_cvt_pk_bf16_f32 v70, v40, v41
    v_cvt_pk_bf16_f32 v71, v42, v43
    v_exp_f32 v44, v44
    v_exp_f32 v45, v45
    s_waitcnt lgkmcnt(3)
    v_mfma_f32_32x32x16_bf16 v[52:67], v[84:87], v[68:71], v[52:67]
    ds_read_b128 v[84:87], v11 offset:10240
    v_exp_f32 v46, v46
    v_exp_f32 v47, v47
    v_exp_f32 v48, v48
    v_exp_f32 v49, v49
    v_exp_f32 v50, v50
    v_exp_f32 v51, v51
    v_cvt_pk_bf16_f32 v72, v44, v45
    v_cvt_pk_bf16_f32 v73, v46, v47
    v_cvt_pk_bf16_f32 v74, v48, v49
    v_cvt_pk_bf16_f32 v75, v50, v51
    v_add_u32 v9, 0x2800, v9
    v_add_u32 v10, 0x2800, v10
    s_waitcnt lgkmcnt(3)
    v_mfma_f32_32x32x16_bf16 v[52:67], v[88:91], v[72:75], v[52:67]
    ds_read_b128 v[88:91], v11 offset:10880
    v_add_u32 v11, 0x2800, v11
    s_waitcnt vmcnt(6)
    s_barrier
    s_waitcnt lgkmcnt(2)
    v_mfma_f32_32x32x8_bf16 v[36:51], v[80:81], v[16:17], 0
    v_exp_f32 v20, v20
    v_exp_f32 v21, v21
    v_exp_f32 v22, v22
    v_exp_f32 v23, v23
    v_mfma_f32_32x32x16_bf16 v[36:51], v[76:79], v[12:15], v[36:51]
    ds_read_b64 v[80:81], v10 offset:5120
    ds_read_b128 v[76:79], v9 offset:5120
    s_mov_b32 m0, s27
    s_add_u32 s27, s27, 0x2000
    buffer_load_dwordx4 v2, s[28:31], s24 offen lds
    s_add_u32 s24, s24, 0x2000
    v_exp_f32 v24, v24
    v_exp_f32 v25, v25
    v_exp_f32 v26, v26
    v_exp_f32 v27, v27
    v_cvt_pk_bf16_f32 v68, v20, v21
    v_cvt_pk_bf16_f32 v69, v22, v23
    v_cvt_pk_bf16_f32 v70, v24, v25
    v_cvt_pk_bf16_f32 v71, v26, v27
    v_exp_f32 v28, v28
    v_exp_f32 v29, v29
    s_waitcnt lgkmcnt(3)
    v_mfma_f32_32x32x16_bf16 v[52:67], v[84:87], v[68:71], v[52:67]
    ds_read_b128 v[84:87], v11 offset:2560
    s_mov_b32 m0, s27
    s_add_u32 s27, s27, 0x2000
    buffer_load_dwordx4 v2, s[28:31], s24 offen lds
    s_add_u32 s24, s24, 0x2000
    v_exp_f32 v30, v30
    v_exp_f32 v31, v31
    v_exp_f32 v32, v32
    v_exp_f32 v33, v33
    v_exp_f32 v34, v34
    v_exp_f32 v35, v35
    v_cvt_pk_bf16_f32 v72, v28, v29
    v_cvt_pk_bf16_f32 v73, v30, v31
    v_cvt_pk_bf16_f32 v74, v32, v33
    v_cvt_pk_bf16_f32 v75, v34, v35
    s_waitcnt lgkmcnt(3)
    s_nop 0
    v_mfma_f32_32x32x16_bf16 v[52:67], v[88:91], v[72:75], v[52:67]
    ds_read_b128 v[88:91], v11 offset:3200
    s_mov_b32 m0, s27
    s_add_u32 s27, s27, 0x2000
    buffer_load_dwordx4 v2, s[28:31], s24 offen lds
    s_add_u32 s24, s24, 0x2000
    s_waitcnt lgkmcnt(2)
    v_mfma_f32_32x32x8_bf16 v[20:35], v[80:81], v[16:17], 0
    v_exp_f32 v36, v36
    v_exp_f32 v37, v37
    v_exp_f32 v38, v38
    v_exp_f32 v39, v39
    v_mfma_f32_32x32x16_bf16 v[20:35], v[76:79], v[12:15], v[20:35]
    ds_read_b64 v[80:81], v10 offset:7680
    ds_read_b128 v[76:79], v9 offset:7680
    s_mov_b32 m0, s27
    s_add_u32 s27, s27, 0x2000
    buffer_load_dwordx4 v2, s[28:31], s24 offen lds
    s_add_u32 s24, s24, 0x2000
    v_exp_f32 v40, v40
    v_exp_f32 v41, v41
    v_exp_f32 v42, v42
    v_exp_f32 v43, v43
    v_cvt_pk_bf16_f32 v68, v36, v37
    v_cvt_pk_bf16_f32 v69, v38, v39
    v_cvt_pk_bf16_f32 v70, v40, v41
    v_cvt_pk_bf16_f32 v71, v42, v43
    v_exp_f32 v44, v44
    v_exp_f32 v45, v45
    s_waitcnt lgkmcnt(3)
    v_mfma_f32_32x32x16_bf16 v[52:67], v[84:87], v[68:71], v[52:67]
    ds_read_b128 v[84:87], v11 offset:5120
    s_mov_b32 m0, s27
    s_add_u32 s27, s27, 0x2000
    buffer_load_dwordx4 v2, s[28:31], s24 offen lds
    s_add_u32 s24, s24, 0x2000
    v_exp_f32 v46, v46
    v_exp_f32 v47, v47
    v_exp_f32 v48, v48
    v_exp_f32 v49, v49
    v_exp_f32 v50, v50
    v_exp_f32 v51, v51
    v_cvt_pk_bf16_f32 v72, v44, v45
    v_cvt_pk_bf16_f32 v73, v46, v47
    v_cvt_pk_bf16_f32 v74, v48, v49
    v_cvt_pk_bf16_f32 v75, v50, v51
    s_waitcnt lgkmcnt(3)
    s_nop 0
    v_mfma_f32_32x32x16_bf16 v[52:67], v[88:91], v[72:75], v[52:67]
    ds_read_b128 v[88:91], v11 offset:5760
    s_waitcnt lgkmcnt(2)
    v_mfma_f32_32x32x8_bf16 v[36:51], v[80:81], v[16:17], 0
    v_exp_f32 v20, v20
    v_exp_f32 v21, v21
    v_exp_f32 v22, v22
    v_exp_f32 v23, v23
    v_mfma_f32_32x32x16_bf16 v[36:51], v[76:79], v[12:15], v[36:51]
    ds_read_b64 v[80:81], v10 offset:10240
    ds_read_b128 v[76:79], v9 offset:10240
    v_exp_f32 v24, v24
    v_exp_f32 v25, v25
    v_exp_f32 v26, v26
    v_exp_f32 v27, v27
    v_cvt_pk_bf16_f32 v68, v20, v21
    v_cvt_pk_bf16_f32 v69, v22, v23
    v_cvt_pk_bf16_f32 v70, v24, v25
    v_cvt_pk_bf16_f32 v71, v26, v27
    v_exp_f32 v28, v28
    v_exp_f32 v29, v29
    s_waitcnt lgkmcnt(3)
    v_mfma_f32_32x32x16_bf16 v[52:67], v[84:87], v[68:71], v[52:67]
    ds_read_b128 v[84:87], v11 offset:7680
    v_exp_f32 v30, v30
    v_exp_f32 v31, v31
    v_exp_f32 v32, v32
    v_exp_f32 v33, v33
    v_exp_f32 v34, v34
    v_exp_f32 v35, v35
    v_cvt_pk_bf16_f32 v72, v28, v29
    v_cvt_pk_bf16_f32 v73, v30, v31
    v_cvt_pk_bf16_f32 v74, v32, v33
    v_cvt_pk_bf16_f32 v75, v34, v35
    s_waitcnt lgkmcnt(3)
    s_nop 0
    v_mfma_f32_32x32x16_bf16 v[52:67], v[88:91], v[72:75], v[52:67]
    ds_read_b128 v[88:91], v11 offset:8320
    s_waitcnt lgkmcnt(2)
    v_mfma_f32_32x32x8_bf16 v[20:35], v[80:81], v[16:17], 0
    v_exp_f32 v36, v36
    v_exp_f32 v37, v37
    v_exp_f32 v38, v38
    v_exp_f32 v39, v39
    v_mfma_f32_32x32x16_bf16 v[20:35], v[76:79], v[12:15], v[20:35]
    ds_read_b64 v[80:81], v10 offset:12800
    ds_read_b128 v[76:79], v9 offset:12800
    v_exp_f32 v40, v40
    v_exp_f32 v41, v41
    v_exp_f32 v42, v42
    v_exp_f32 v43, v43
    v_cvt_pk_bf16_f32 v68, v36, v37
    v_cvt_pk_bf16_f32 v69, v38, v39
    v_cvt_pk_bf16_f32 v70, v40, v41
    v_cvt_pk_bf16_f32 v71, v42, v43
    v_exp_f32 v44, v44
    v_exp_f32 v45, v45
    s_waitcnt lgkmcnt(3)
    v_mfma_f32_32x32x16_bf16 v[52:67], v[84:87], v[68:71], v[52:67]
    ds_read_b128 v[84:87], v11 offset:10240
    v_exp_f32 v46, v46
    v_exp_f32 v47, v47
    v_exp_f32 v48, v48
    v_exp_f32 v49, v49
    v_exp_f32 v50, v50
    v_exp_f32 v51, v51
    v_cvt_pk_bf16_f32 v72, v44, v45
    v_cvt_pk_bf16_f32 v73, v46, v47
    v_cvt_pk_bf16_f32 v74, v48, v49
    v_cvt_pk_bf16_f32 v75, v50, v51
    v_add_u32 v9, 0x2800, v9
    v_add_u32 v10, 0x2800, v10
    s_waitcnt lgkmcnt(3)
    v_mfma_f32_32x32x16_bf16 v[52:67], v[88:91], v[72:75], v[52:67]
    ds_read_b128 v[88:91], v11 offset:10880
    v_add_u32 v11, 0x2800, v11
    s_waitcnt lgkmcnt(2)
    v_mfma_f32_32x32x8_bf16 v[36:51], v[80:81], v[16:17], 0
    v_exp_f32 v20, v20
    v_exp_f32 v21, v21
    v_exp_f32 v22, v22
    v_exp_f32 v23, v23
    v_mfma_f32_32x32x16_bf16 v[36:51], v[76:79], v[12:15], v[36:51]
    ds_read_b64 v[80:81], v10 offset:5120
    ds_read_b128 v[76:79], v9 offset:5120
    s_mov_b32 m0, s27
    s_add_u32 s27, s27, 0x2000
    buffer_load_dwordx4 v2, s[28:31], s24 offen lds
    s_add_u32 s24, s24, 0x2000
    v_exp_f32 v24, v24
    v_exp_f32 v25, v25
    v_exp_f32 v26, v26
    v_exp_f32 v27, v27
    v_cvt_pk_bf16_f32 v68, v20, v21
    v_cvt_pk_bf16_f32 v69, v22, v23
    v_cvt_pk_bf16_f32 v70, v24, v25
    v_cvt_pk_bf16_f32 v71, v26, v27
    v_exp_f32 v28, v28
    v_exp_f32 v29, v29
    s_waitcnt lgkmcnt(3)
    v_mfma_f32_32x32x16_bf16 v[52:67], v[84:87], v[68:71], v[52:67]
    ds_read_b128 v[84:87], v11 offset:2560
    s_mov_b32 m0, s27
    s_add_u32 s27, s27, 0x2000
    buffer_load_dwordx4 v2, s[28:31], s24 offen lds
    s_add_u32 s24, s24, 0x2000
    v_exp_f32 v30, v30
    v_exp_f32 v31, v31
    v_exp_f32 v32, v32
    v_exp_f32 v33, v33
    v_exp_f32 v34, v34
    v_exp_f32 v35, v35
    v_cvt_pk_bf16_f32 v72, v28, v29
    v_cvt_pk_bf16_f32 v73, v30, v31
    v_cvt_pk_bf16_f32 v74, v32, v33
    v_cvt_pk_bf16_f32 v75, v34, v35
    s_waitcnt lgkmcnt(3)
    s_nop 0
    v_mfma_f32_32x32x16_bf16 v[52:67], v[88:91], v[72:75], v[52:67]
    ds_read_b128 v[88:91], v11 offset:3200
    s_mov_b32 m0, s27
    s_add_u32 s27, s27, 0x2000
    buffer_load_dwordx4 v2, s[28:31], s24 offen lds
    s_add_u32 s24, s24, 0x2000
    s_waitcnt lgkmcnt(2)
    v_mfma_f32_32x32x8_bf16 v[20:35], v[80:81], v[16:17], 0
    v_exp_f32 v36, v36
    v_exp_f32 v37, v37
    v_exp_f32 v38, v38
    v_exp_f32 v39, v39
    v_mfma_f32_32x32x16_bf16 v[20:35], v[76:79], v[12:15], v[20:35]
    ds_read_b64 v[80:81], v10 offset:7680
    ds_read_b128 v[76:79], v9 offset:7680
    s_mov_b32 m0, s27
    s_add_u32 s27, s27, 0x2000
    buffer_load_dwordx4 v2, s[28:31], s24 offen lds
    s_add_u32 s24, s24, 0x2000
    v_exp_f32 v40, v40
    v_exp_f32 v41, v41
    v_exp_f32 v42, v42
    v_exp_f32 v43, v43
    v_cvt_pk_bf16_f32 v68, v36, v37
    v_cvt_pk_bf16_f32 v69, v38, v39
    v_cvt_pk_bf16_f32 v70, v40, v41
    v_cvt_pk_bf16_f32 v71, v42, v43
    v_exp_f32 v44, v44
    v_exp_f32 v45, v45
    s_waitcnt lgkmcnt(3)
    v_mfma_f32_32x32x16_bf16 v[52:67], v[84:87], v[68:71], v[52:67]
    ds_read_b128 v[84:87], v11 offset:5120
    v_exp_f32 v46, v46
    v_exp_f32 v47, v47
    v_exp_f32 v48, v48
    v_exp_f32 v49, v49
    v_exp_f32 v50, v50
    v_exp_f32 v51, v51
    v_cvt_pk_bf16_f32 v72, v44, v45
    v_cvt_pk_bf16_f32 v73, v46, v47
    v_cvt_pk_bf16_f32 v74, v48, v49
    v_cvt_pk_bf16_f32 v75, v50, v51
    s_waitcnt lgkmcnt(3)
    s_nop 0
    v_mfma_f32_32x32x16_bf16 v[52:67], v[88:91], v[72:75], v[52:67]
    ds_read_b128 v[88:91], v11 offset:5760
    s_waitcnt lgkmcnt(2)
    v_mfma_f32_32x32x8_bf16 v[36:51], v[80:81], v[16:17], 0
    v_exp_f32 v20, v20
    v_exp_f32 v21, v21
    v_exp_f32 v22, v22
    v_exp_f32 v23, v23
    v_mfma_f32_32x32x16_bf16 v[36:51], v[76:79], v[12:15], v[36:51]
    ds_read_b64 v[80:81], v10 offset:10240
    ds_read_b128 v[76:79], v9 offset:10240
    v_exp_f32 v24, v24
    v_exp_f32 v25, v25
    v_exp_f32 v26, v26
    v_exp_f32 v27, v27
    v_cvt_pk_bf16_f32 v68, v20, v21
    v_cvt_pk_bf16_f32 v69, v22, v23
    v_cvt_pk_bf16_f32 v70, v24, v25
    v_cvt_pk_bf16_f32 v71, v26, v27
    v_exp_f32 v28, v28
    v_exp_f32 v29, v29
    s_waitcnt lgkmcnt(3)
    v_mfma_f32_32x32x16_bf16 v[52:67], v[84:87], v[68:71], v[52:67]
    ds_read_b128 v[84:87], v11 offset:7680
    v_exp_f32 v30, v30
    v_exp_f32 v31, v31
    v_exp_f32 v32, v32
    v_exp_f32 v33, v33
    v_exp_f32 v34, v34
    v_exp_f32 v35, v35
    v_cvt_pk_bf16_f32 v72, v28, v29
    v_cvt_pk_bf16_f32 v73, v30, v31
    v_cvt_pk_bf16_f32 v74, v32, v33
    v_cvt_pk_bf16_f32 v75, v34, v35
    s_waitcnt lgkmcnt(3)
    s_nop 0
    v_mfma_f32_32x32x16_bf16 v[52:67], v[88:91], v[72:75], v[52:67]
    ds_read_b128 v[88:91], v11 offset:8320
    s_waitcnt lgkmcnt(2)
    v_mfma_f32_32x32x8_bf16 v[20:35], v[80:81], v[16:17], 0
    v_exp_f32 v36, v36
    v_exp_f32 v37, v37
    v_exp_f32 v38, v38
    v_exp_f32 v39, v39
    v_mfma_f32_32x32x16_bf16 v[20:35], v[76:79], v[12:15], v[20:35]
    ds_read_b64 v[80:81], v10 offset:12800
    ds_read_b128 v[76:79], v9 offset:12800
    v_exp_f32 v40, v40
    v_exp_f32 v41, v41
    v_exp_f32 v42, v42
    v_exp_f32 v43, v43
    v_cvt_pk_bf16_f32 v68, v36, v37
    v_cvt_pk_bf16_f32 v69, v38, v39
    v_cvt_pk_bf16_f32 v70, v40, v41
    v_cvt_pk_bf16_f32 v71, v42, v43
    v_exp_f32 v44, v44
    v_exp_f32 v45, v45
    s_waitcnt lgkmcnt(3)
    v_mfma_f32_32x32x16_bf16 v[52:67], v[84:87], v[68:71], v[52:67]
    ds_read_b128 v[84:87], v11 offset:10240
    v_exp_f32 v46, v46
    v_exp_f32 v47, v47
    v_exp_f32 v48, v48
    v_exp_f32 v49, v49
    v_exp_f32 v50, v50
    v_exp_f32 v51, v51
    v_cvt_pk_bf16_f32 v72, v44, v45
    v_cvt_pk_bf16_f32 v73, v46, v47
    v_cvt_pk_bf16_f32 v74, v48, v49
    v_cvt_pk_bf16_f32 v75, v50, v51
    v_add_u32 v9, 0x2800, v9
    v_add_u32 v10, 0x2800, v10
    s_waitcnt lgkmcnt(3)
    v_mfma_f32_32x32x16_bf16 v[52:67], v[88:91], v[72:75], v[52:67]
    ds_read_b128 v[88:91], v11 offset:10880
    v_add_u32 v11, 0x2800, v11
    s_waitcnt vmcnt(9)
    s_barrier
    s_waitcnt lgkmcnt(2)
    v_mfma_f32_32x32x8_bf16 v[36:51], v[80:81], v[16:17], 0
    v_exp_f32 v20, v20
    v_exp_f32 v21, v21
    v_exp_f32 v22, v22
    v_exp_f32 v23, v23
    v_mfma_f32_32x32x16_bf16 v[36:51], v[76:79], v[12:15], v[36:51]
    ds_read_b64 v[80:81], v10 offset:5120
    ds_read_b128 v[76:79], v9 offset:5120
    s_mov_b32 s67, s56
    s_cmp_eq_u32 s66, -1
    s_cbranch_scc1 L_pj_l_24
    buffer_load_dwordx4 v[96:99], v168, s[44:47], s67 offen nt
    s_branch L_pj_l_23
L_pj_l_24:
    buffer_load_dwordx4 v[96:99], v168, s[44:47], s67 offen
    buffer_load_ushort v160, v171, s[44:47], s67 offen
L_pj_l_23:
    v_exp_f32 v24, v24
    v_exp_f32 v25, v25
    v_exp_f32 v26, v26
    v_exp_f32 v27, v27
    v_cvt_pk_bf16_f32 v68, v20, v21
    v_cvt_pk_bf16_f32 v69, v22, v23
    v_cvt_pk_bf16_f32 v70, v24, v25
    v_cvt_pk_bf16_f32 v71, v26, v27
    v_exp_f32 v28, v28
    v_exp_f32 v29, v29
    s_waitcnt lgkmcnt(3)
    v_mfma_f32_32x32x16_bf16 v[52:67], v[84:87], v[68:71], v[52:67]
    ds_read_b128 v[84:87], v11 offset:2560
    v_exp_f32 v30, v30
    v_exp_f32 v31, v31
    v_exp_f32 v32, v32
    v_exp_f32 v33, v33
    v_exp_f32 v34, v34
    v_exp_f32 v35, v35
    v_cvt_pk_bf16_f32 v72, v28, v29
    v_cvt_pk_bf16_f32 v73, v30, v31
    v_cvt_pk_bf16_f32 v74, v32, v33
    v_cvt_pk_bf16_f32 v75, v34, v35
    s_waitcnt lgkmcnt(3)
    s_nop 0
    v_mfma_f32_32x32x16_bf16 v[52:67], v[88:91], v[72:75], v[52:67]
    ds_read_b128 v[88:91], v11 offset:3200
    s_waitcnt lgkmcnt(2)
    v_mfma_f32_32x32x8_bf16 v[20:35], v[80:81], v[16:17], 0
    v_exp_f32 v36, v36
    v_exp_f32 v37, v37
    v_exp_f32 v38, v38
    v_exp_f32 v39, v39
    v_mfma_f32_32x32x16_bf16 v[20:35], v[76:79], v[12:15], v[20:35]
    ds_read_b64 v[80:81], v10 offset:7680
    ds_read_b128 v[76:79], v9 offset:7680
    v_exp_f32 v40, v40
    v_exp_f32 v41, v41
    v_exp_f32 v42, v42
    v_exp_f32 v43, v43
    v_cvt_pk_bf16_f32 v68, v36, v37
    v_cvt_pk_bf16_f32 v69, v38, v39
    v_cvt_pk_bf16_f32 v70, v40, v41
    v_cvt_pk_bf16_f32 v71, v42, v43
    v_exp_f32 v44, v44
    v_exp_f32 v45, v45
    s_waitcnt lgkmcnt(3)
    v_mfma_f32_32x32x16_bf16 v[52:67], v[84:87], v[68:71], v[52:67]
    ds_read_b128 v[84:87], v11 offset:5120
    s_add_u32 s67, s67, s57
    s_cmp_eq_u32 s66, -1
    s_cbranch_scc1 L_pj_l_26
    buffer_load_dwordx4 v[100:103], v168, s[44:47], s67 offen nt
    s_branch L_pj_l_25
L_pj_l_26:
    buffer_load_dwordx4 v[100:103], v168, s[44:47], s67 offen
    buffer_load_ushort v161, v171, s[44:47], s67 offen
L_pj_l_25:
    v_exp_f32 v46, v46
    v_exp_f32 v47, v47
    v_exp_f32 v48, v48
    v_exp_f32 v49, v49
    v_exp_f32 v50, v50
    v_exp_f32 v51, v51
    v_cvt_pk_bf16_f32 v72, v44, v45
    v_cvt_pk_bf16_f32 v73, v46, v47
    v_cvt_pk_bf16_f32 v74, v48, v49
    v_cvt_pk_bf16_f32 v75, v50, v51
    s_waitcnt lgkmcnt(3)
    s_nop 0
    v_mfma_f32_32x32x16_bf16 v[52:67], v[88:91], v[72:75], v[52:67]
    ds_read_b128 v[88:91], v11 offset:5760
    s_waitcnt lgkmcnt(2)
    v_mfma_f32_32x32x8_bf16 v[36:51], v[80:81], v[16:17], 0
    v_exp_f32 v20, v20
    v_exp_f32 v21, v21
    v_exp_f32 v22, v22
    v_exp_f32 v23, v23
    v_mfma_f32_32x32x16_bf16 v[36:51], v[76:79], v[12:15], v[36:51]
    ds_read_b64 v[80:81], v10 offset:10240
    ds_read_b128 v[76:79], v9 offset:10240
    v_exp_f32 v24, v24
    v_exp_f32 v25, v25
    v_exp_f32 v26, v26
    v_exp_f32 v27, v27
    v_cvt_pk_bf16_f32 v68, v20, v21
    v_cvt_pk_bf16_f32 v69, v22, v23
    v_cvt_pk_bf16_f32 v70, v24, v25
    v_cvt_pk_bf16_f32 v71, v26, v27
    v_exp_f32 v28, v28
    v_exp_f32 v29, v29
    s_waitcnt lgkmcnt(3)
    v_mfma_f32_32x32x16_bf16 v[52:67], v[84:87], v[68:71], v[52:67]
    ds_read_b128 v[84:87], v11 offset:7680
    v_exp_f32 v30, v30
    v_exp_f32 v31, v31
    v_exp_f32 v32, v32
    v_exp_f32 v33, v33
    v_exp_f32 v34, v34
    v_exp_f32 v35, v35
    v_cvt_pk_bf16_f32 v72, v28, v29
    v_cvt_pk_bf16_f32 v73, v30, v31
    v_cvt_pk_bf16_f32 v74, v32, v33
    v_cvt_pk_bf16_f32 v75, v34, v35
    s_waitcnt lgkmcnt(3)
    s_nop 0
    v_mfma_f32_32x32x16_bf16 v[52:67], v[88:91], v[72:75], v[52:67]
    ds_read_b128 v[88:91], v11 offset:8320
    s_add_u32 s67, s67, s57
    s_cmp_eq_u32 s66, -1
    s_cbranch_scc1 L_pj_l_28
    buffer_load_dwordx4 v[104:107], v168, s[44:47], s67 offen nt
    s_branch L_pj_l_27
L_pj_l_28:
    buffer_load_dwordx4 v[104:107], v168, s[44:47], s67 offen
    buffer_load_ushort v162, v171, s[44:47], s67 offen
L_pj_l_27:
    s_waitcnt lgkmcnt(2)
    v_mfma_f32_32x32x8_bf16 v[20:35], v[80:81], v[16:17], 0
    v_exp_f32 v36, v36
    v_exp_f32 v37, v37
    v_exp_f32 v38, v38
    v_exp_f32 v39, v39
    v_mfma_f32_32x32x16_bf16 v[20:35], v[76:79], v[12:15], v[20:35]
    ds_read_b64 v[80:81], v10 offset:12800
    ds_read_b128 v[76:79], v9 offset:12800
    v_exp_f32 v40, v40
    v_exp_f32 v41, v41
    v_exp_f32 v42, v42
    v_exp_f32 v43, v43
    v_cvt_pk_bf16_f32 v68, v36, v37
    v_cvt_pk_bf16_f32 v69, v38, v39
    v_cvt_pk_bf16_f32 v70, v40, v41
    v_cvt_pk_bf16_f32 v71, v42, v43
    v_exp_f32 v44, v44
    v_exp_f32 v45, v45
    s_waitcnt lgkmcnt(3)
    v_mfma_f32_32x32x16_bf16 v[52:67], v[84:87], v[68:71], v[52:67]
    ds_read_b128 v[84:87], v11 offset:10240
    v_exp_f32 v46, v46
    v_exp_f32 v47, v47
    v_exp_f32 v48, v48
    v_exp_f32 v49, v49
    v_exp_f32 v50, v50
    v_exp_f32 v51, v51
    v_cvt_pk_bf16_f32 v72, v44, v45
    v_cvt_pk_bf16_f32 v73, v46, v47
    v_cvt_pk_bf16_f32 v74, v48, v49
    v_cvt_pk_bf16_f32 v75, v50, v51
    v_add_u32 v9, 0x2800, v9
    v_add_u32 v10, 0x2800, v10
    s_waitcnt lgkmcnt(3)
    v_mfma_f32_32x32x16_bf16 v[52:67], v[88:91], v[72:75], v[52:67]
    ds_read_b128 v[88:91], v11 offset:10880
    v_add_u32 v11, 0x2800, v11
    s_waitcnt lgkmcnt(2)
    v_mfma_f32_32x32x8_bf16 v[36:51], v[80:81], v[16:17], 0
    v_exp_f32 v20, v20
    v_exp_f32 v21, v21
    v_exp_f32 v22, v22
    v_exp_f32 v23, v23
    v_mfma_f32_32x32x16_bf16 v[36:51], v[76:79], v[12:15], v[36:51]
    ds_read_b64 v[80:81], v10 offset:5120
    ds_read_b128 v[76:79], v9 offset:5120
    s_add_u32 s67, s67, s57
    s_cmp_eq_u32 s66, -1
    s_cbranch_scc1 L_pj_l_30
    buffer_load_dwordx4 v[108:111], v168, s[44:47], s67 offen nt
    s_branch L_pj_l_29
L_pj_l_30:
    buffer_load_dwordx4 v[108:111], v168, s[44:47], s67 offen
    buffer_load_ushort v163, v171, s[44:47], s67 offen
L_pj_l_29:
    v_exp_f32 v24, v24
    v_exp_f32 v25, v25
    v_exp_f32 v26, v26
    v_exp_f32 v27, v27
    v_cvt_pk_bf16_f32 v68, v20, v21
    v_cvt_pk_bf16_f32 v69, v22, v23
    v_cvt_pk_bf16_f32 v70, v24, v25
    v_cvt_pk_bf16_f32 v71, v26, v27
    v_exp_f32 v28, v28
    v_exp_f32 v29, v29
    s_waitcnt lgkmcnt(3)
    v_mfma_f32_32x32x16_bf16 v[52:67], v[84:87], v[68:71], v[52:67]
    ds_read_b128 v[84:87], v11 offset:2560
    v_exp_f32 v30, v30
    v_exp_f32 v31, v31
    v_exp_f32 v32, v32
    v_exp_f32 v33, v33
    v_exp_f32 v34, v34
    v_exp_f32 v35, v35
    v_cvt_pk_bf16_f32 v72, v28, v29
    v_cvt_pk_bf16_f32 v73, v30, v31
    v_cvt_pk_bf16_f32 v74, v32, v33
    v_cvt_pk_bf16_f32 v75, v34, v35
    s_waitcnt lgkmcnt(3)
    s_nop 0
    v_mfma_f32_32x32x16_bf16 v[52:67], v[88:91], v[72:75], v[52:67]
    ds_read_b128 v[88:91], v11 offset:3200
    s_waitcnt lgkmcnt(2)
    v_mfma_f32_32x32x8_bf16 v[20:35], v[80:81], v[16:17], 0
    v_exp_f32 v36, v36
    v_exp_f32 v37, v37
    v_exp_f32 v38, v38
    v_exp_f32 v39, v39
    v_mfma_f32_32x32x16_bf16 v[20:35], v[76:79], v[12:15], v[20:35]
    ds_read_b64 v[80:81], v10 offset:7680
    ds_read_b128 v[76:79], v9 offset:7680
    v_exp_f32 v40, v40
    v_exp_f32 v41, v41
    v_exp_f32 v42, v42
    v_exp_f32 v43, v43
    v_cvt_pk_bf16_f32 v68, v36, v37
    v_cvt_pk_bf16_f32 v69, v38, v39
    v_cvt_pk_bf16_f32 v70, v40, v41
    v_cvt_pk_bf16_f32 v71, v42, v43
    v_exp_f32 v44, v44
    v_exp_f32 v45, v45
    s_waitcnt lgkmcnt(3)
    v_mfma_f32_32x32x16_bf16 v[52:67], v[84:87], v[68:71], v[52:67]
    ds_read_b128 v[84:87], v11 offset:5120
    s_add_u32 s56, s56, s58
    s_mov_b32 s67, s56
    s_cmp_eq_u32 s66, -1
    s_cbranch_scc1 L_pj_l_32
    buffer_load_dwordx4 v[112:115], v168, s[44:47], s67 offen nt
    s_branch L_pj_l_31
L_pj_l_32:
    buffer_load_dwordx4 v[112:115], v168, s[44:47], s67 offen
    buffer_load_ushort v164, v171, s[44:47], s67 offen
L_pj_l_31:
    v_exp_f32 v46, v46
    v_exp_f32 v47, v47
    v_exp_f32 v48, v48
    v_exp_f32 v49, v49
    v_exp_f32 v50, v50
    v_exp_f32 v51, v51
    v_cvt_pk_bf16_f32 v72, v44, v45
    v_cvt_pk_bf16_f32 v73, v46, v47
    v_cvt_pk_bf16_f32 v74, v48, v49
    v_cvt_pk_bf16_f32 v75, v50, v51
    s_waitcnt lgkmcnt(3)
    s_nop 0
    v_mfma_f32_32x32x16_bf16 v[52:67], v[88:91], v[72:75], v[52:67]
    ds_read_b128 v[88:91], v11 offset:5760
    s_waitcnt lgkmcnt(2)
    v_mfma_f32_32x32x8_bf16 v[36:51], v[80:81], v[16:17], 0
    v_exp_f32 v20, v20
    v_exp_f32 v21, v21
    v_exp_f32 v22, v22
    v_exp_f32 v23, v23
    v_mfma_f32_32x32x16_bf16 v[36:51], v[76:79], v[12:15], v[36:51]
    ds_read_b64 v[80:81], v10 offset:10240
    ds_read_b128 v[76:79], v9 offset:10240
    v_exp_f32 v24, v24
    v_exp_f32 v25, v25
    v_exp_f32 v26, v26
    v_exp_f32 v27, v27
    v_cvt_pk_bf16_f32 v68, v20, v21
    v_cvt_pk_bf16_f32 v69, v22, v23
    v_cvt_pk_bf16_f32 v70, v24, v25
    v_cvt_pk_bf16_f32 v71, v26, v27
    v_exp_f32 v28, v28
    v_exp_f32 v29, v29
    s_waitcnt lgkmcnt(3)
    v_mfma_f32_32x32x16_bf16 v[52:67], v[84:87], v[68:71], v[52:67]
    ds_read_b128 v[84:87], v11 offset:7680
    v_exp_f32 v30, v30
    v_exp_f32 v31, v31
    v_exp_f32 v32, v32
    v_exp_f32 v33, v33
    v_exp_f32 v34, v34
    v_exp_f32 v35, v35
    v_cvt_pk_bf16_f32 v72, v28, v29
    v_cvt_pk_bf16_f32 v73, v30, v31
    v_cvt_pk_bf16_f32 v74, v32, v33
    v_cvt_pk_bf16_f32 v75, v34, v35
    s_waitcnt lgkmcnt(3)
    s_nop 0
    v_mfma_f32_32x32x16_bf16 v[52:67], v[88:91], v[72:75], v[52:67]
    ds_read_b128 v[88:91], v11 offset:8320
    s_add_u32 s67, s67, s57
    s_cmp_eq_u32 s66, -1
    s_cbranch_scc1 L_pj_l_34
    buffer_load_dwordx4 v[116:119], v168, s[44:47], s67 offen nt
    s_branch L_pj_l_33
L_pj_l_34:
    buffer_load_dwordx4 v[116:119], v168, s[44:47], s67 offen
    buffer_load_ushort v165, v171, s[44:47], s67 offen
L_pj_l_33:
    s_waitcnt lgkmcnt(2)
    v_mfma_f32_32x32x8_bf16 v[20:35], v[80:81], v[16:17], 0
    v_exp_f32 v36, v36
    v_exp_f32 v37, v37
    v_exp_f32 v38, v38
    v_exp_f32 v39, v39
    v_mfma_f32_32x32x16_bf16 v[20:35], v[76:79], v[12:15], v[20:35]
    ds_read_b64 v[80:81], v10 offset:12800
    ds_read_b128 v[76:79], v9 offset:12800
    v_exp_f32 v40, v40
    v_exp_f32 v41, v41
    v_exp_f32 v42, v42
    v_exp_f32 v43, v43
    v_cvt_pk_bf16_f32 v68, v36, v37
    v_cvt_pk_bf16_f32 v69, v38, v39
    v_cvt_pk_bf16_f32 v70, v40, v41
    v_cvt_pk_bf16_f32 v71, v42, v43
    v_exp_f32 v44, v44
    v_exp_f32 v45, v45
    s_waitcnt lgkmcnt(3)
    v_mfma_f32_32x32x16_bf16 v[52:67], v[84:87], v[68:71], v[52:67]
    ds_read_b128 v[84:87], v11 offset:10240
    v_exp_f32 v46, v46
    v_exp_f32 v47, v47
    v_exp_f32 v48, v48
    v_exp_f32 v49, v49
    v_exp_f32 v50, v50
    v_exp_f32 v51, v51
    v_cvt_pk_bf16_f32 v72, v44, v45
    v_cvt_pk_bf16_f32 v73, v46, v47
    v_cvt_pk_bf16_f32 v74, v48, v49
    v_cvt_pk_bf16_f32 v75, v50, v51
    v_add_u32 v9, 0x2800, v9
    v_add_u32 v10, 0x2800, v10
    s_waitcnt lgkmcnt(3)
    v_mfma_f32_32x32x16_bf16 v[52:67], v[88:91], v[72:75], v[52:67]
    ds_read_b128 v[88:91], v11 offset:10880
    v_add_u32 v11, 0x2800, v11
    s_waitcnt lgkmcnt(2)
    v_mfma_f32_32x32x8_bf16 v[36:51], v[80:81], v[16:17], 0
    v_exp_f32 v20, v20
    v_exp_f32 v21, v21
    v_exp_f32 v22, v22
    v_exp_f32 v23, v23
    v_mfma_f32_32x32x16_bf16 v[36:51], v[76:79], v[12:15], v[36:51]
    ds_read_b64 v[80:81], v10 offset:5120
    ds_read_b128 v[76:79], v9 offset:5120
    s_add_u32 s67, s67, s57
    s_cmp_eq_u32 s66, -1
    s_cbranch_scc1 L_pj_l_36
    buffer_load_dwordx4 v[120:123], v168, s[44:47], s67 offen nt
    s_branch L_pj_l_35
L_pj_l_36:
    buffer_load_dwordx4 v[120:123], v168, s[44:47], s67 offen
    buffer_load_ushort v166, v171, s[44:47], s67 offen
L_pj_l_35:
    v_exp_f32 v24, v24
    v_exp_f32 v25, v25
    v_exp_f32 v26, v26
    v_exp_f32 v27, v27
    v_cvt_pk_bf16_f32 v68, v20, v21
    v_cvt_pk_bf16_f32 v69, v22, v23
    v_cvt_pk_bf16_f32 v70, v24, v25
    v_cvt_pk_bf16_f32 v71, v26, v27
    v_exp_f32 v28, v28
    v_exp_f32 v29, v29
    s_waitcnt lgkmcnt(3)
    v_mfma_f32_32x32x16_bf16 v[52:67], v[84:87], v[68:71], v[52:67]
    ds_read_b128 v[84:87], v11 offset:2560
    v_exp_f32 v30, v30
    v_exp_f32 v31, v31
    v_exp_f32 v32, v32
    v_exp_f32 v33, v33
    v_exp_f32 v34, v34
    v_exp_f32 v35, v35
    v_cvt_pk_bf16_f32 v72, v28, v29
    v_cvt_pk_bf16_f32 v73, v30, v31
    v_cvt_pk_bf16_f32 v74, v32, v33
    v_cvt_pk_bf16_f32 v75, v34, v35
    s_waitcnt lgkmcnt(3)
    s_nop 0
    v_mfma_f32_32x32x16_bf16 v[52:67], v[88:91], v[72:75], v[52:67]
    ds_read_b128 v[88:91], v11 offset:3200
    s_waitcnt lgkmcnt(2)
    v_mfma_f32_32x32x8_bf16 v[20:35], v[80:81], v[16:17], 0
    v_exp_f32 v36, v36
    v_exp_f32 v37, v37
    v_exp_f32 v38, v38
    v_exp_f32 v39, v39
    v_mfma_f32_32x32x16_bf16 v[20:35], v[76:79], v[12:15], v[20:35]
    ds_read_b64 v[80:81], v10 offset:7680
    ds_read_b128 v[76:79], v9 offset:7680
    v_exp_f32 v40, v40
    v_exp_f32 v41, v41
    v_exp_f32 v42, v42
    v_exp_f32 v43, v43
    v_cvt_pk_bf16_f32 v68, v36, v37
    v_cvt_pk_bf16_f32 v69, v38, v39
    v_cvt_pk_bf16_f32 v70, v40, v41
    v_cvt_pk_bf16_f32 v71, v42, v43
    v_exp_f32 v44, v44
    v_exp_f32 v45, v45
    s_waitcnt lgkmcnt(3)
    v_mfma_f32_32x32x16_bf16 v[52:67], v[84:87], v[68:71], v[52:67]
    ds_read_b128 v[84:87], v11 offset:5120
    s_add_u32 s67, s67, s57
    s_cmp_eq_u32 s66, -1
    s_cbranch_scc1 L_pj_l_38
    buffer_load_dwordx4 v[124:127], v168, s[44:47], s67 offen nt
    s_branch L_pj_l_37
L_pj_l_38:
    buffer_load_dwordx4 v[124:127], v168, s[44:47], s67 offen
    buffer_load_ushort v167, v171, s[44:47], s67 offen
L_pj_l_37:
    v_exp_f32 v46, v46
    v_exp_f32 v47, v47
    v_exp_f32 v48, v48
    v_exp_f32 v49, v49
    v_exp_f32 v50, v50
    v_exp_f32 v51, v51
    v_cvt_pk_bf16_f32 v72, v44, v45
    v_cvt_pk_bf16_f32 v73, v46, v47
    v_cvt_pk_bf16_f32 v74, v48, v49
    v_cvt_pk_bf16_f32 v75, v50, v51
    s_waitcnt lgkmcnt(3)
    s_nop 0
    v_mfma_f32_32x32x16_bf16 v[52:67], v[88:91], v[72:75], v[52:67]
    ds_read_b128 v[88:91], v11 offset:5760
    s_waitcnt lgkmcnt(2)
    v_mfma_f32_32x32x8_bf16 v[36:51], v[80:81], v[16:17], 0
    v_exp_f32 v20, v20
    v_exp_f32 v21, v21
    v_exp_f32 v22, v22
    v_exp_f32 v23, v23
    v_mfma_f32_32x32x16_bf16 v[36:51], v[76:79], v[12:15], v[36:51]
    ds_read_b64 v[80:81], v10 offset:10240
    ds_read_b128 v[76:79], v9 offset:10240
    v_exp_f32 v24, v24
    v_exp_f32 v25, v25
    v_exp_f32 v26, v26
    v_exp_f32 v27, v27
    v_cvt_pk_bf16_f32 v68, v20, v21
    v_cvt_pk_bf16_f32 v69, v22, v23
    v_cvt_pk_bf16_f32 v70, v24, v25
    v_cvt_pk_bf16_f32 v71, v26, v27
    v_exp_f32 v28, v28
    v_exp_f32 v29, v29
    s_waitcnt lgkmcnt(3)
    v_mfma_f32_32x32x16_bf16 v[52:67], v[84:87], v[68:71], v[52:67]
    ds_read_b128 v[84:87], v11 offset:7680
    v_exp_f32 v30, v30
    v_exp_f32 v31, v31
    v_exp_f32 v32, v32
    v_exp_f32 v33, v33
    v_exp_f32 v34, v34
    v_exp_f32 v35, v35
    v_cvt_pk_bf16_f32 v72, v28, v29
    v_cvt_pk_bf16_f32 v73, v30, v31
    v_cvt_pk_bf16_f32 v74, v32, v33
    v_cvt_pk_bf16_f32 v75, v34, v35
    s_waitcnt lgkmcnt(3)
    s_nop 0
    v_mfma_f32_32x32x16_bf16 v[52:67], v[88:91], v[72:75], v[52:67]
    ds_read_b128 v[88:91], v11 offset:8320
    v_mov_b32 v128, -1
    v_mov_b32 v129, -1
    v_mov_b32 v130, -1
    v_mov_b32 v131, -1
    s_lshl_b32 s67, s2, 3
    s_add_u32 s67, s67, s22
    s_lshl_b32 s67, s67, 12
    s_add_u32 s67, s67, 0x1c00000
    buffer_store_dwordx4 v[128:131], v2, s[48:51], s67 offen sc1
    s_waitcnt lgkmcnt(2)
    v_mfma_f32_32x32x8_bf16 v[20:35], v[80:81], v[16:17], 0
    v_exp_f32 v36, v36
    v_exp_f32 v37, v37
    v_exp_f32 v38, v38
    v_exp_f32 v39, v39
    v_mfma_f32_32x32x16_bf16 v[20:35], v[76:79], v[12:15], v[20:35]
    ds_read_b64 v[80:81], v10 offset:12800
    ds_read_b128 v[76:79], v9 offset:12800
    v_exp_f32 v40, v40
    v_exp_f32 v41, v41
    v_exp_f32 v42, v42
    v_exp_f32 v43, v43
    v_cvt_pk_bf16_f32 v68, v36, v37
    v_cvt_pk_bf16_f32 v69, v38, v39
    v_cvt_pk_bf16_f32 v70, v40, v41
    v_cvt_pk_bf16_f32 v71, v42, v43
    v_exp_f32 v44, v44
    v_exp_f32 v45, v45
    s_waitcnt lgkmcnt(3)
    v_mfma_f32_32x32x16_bf16 v[52:67], v[84:87], v[68:71], v[52:67]
    ds_read_b128 v[84:87], v11 offset:10240
    v_exp_f32 v46, v46
    v_exp_f32 v47, v47
    v_exp_f32 v48, v48
    v_exp_f32 v49, v49
    v_exp_f32 v50, v50
    v_exp_f32 v51, v51
    v_cvt_pk_bf16_f32 v72, v44, v45
    v_cvt_pk_bf16_f32 v73, v46, v47
    v_cvt_pk_bf16_f32 v74, v48, v49
    v_cvt_pk_bf16_f32 v75, v50, v51
    v_add_u32 v9, 0x2800, v9
    v_add_u32 v10, 0x2800, v10
    s_waitcnt lgkmcnt(3)
    v_mfma_f32_32x32x16_bf16 v[52:67], v[88:91], v[72:75], v[52:67]
    ds_read_b128 v[88:91], v11 offset:10880
    v_add_u32 v11, 0x2800, v11
    s_waitcnt lgkmcnt(2)
    v_mfma_f32_32x32x8_bf16 v[36:51], v[80:81], v[16:17], 0
    v_exp_f32 v20, v20
    v_exp_f32 v21, v21
    v_exp_f32 v22, v22
    v_exp_f32 v23, v23
    v_mfma_f32_32x32x16_bf16 v[36:51], v[76:79], v[12:15], v[36:51]
    ds_read_b64 v[80:81], v10 offset:5120
    ds_read_b128 v[76:79], v9 offset:5120
    buffer_store_dwordx4 v[128:131], v2, s[48:51], s67 offen offset:1024 sc1
    v_exp_f32 v24, v24
    v_exp_f32 v25, v25
    v_exp_f32 v26, v26
    v_exp_f32 v27, v27
    v_cvt_pk_bf16_f32 v68, v20, v21
    v_cvt_pk_bf16_f32 v69, v22, v23
    v_cvt_pk_bf16_f32 v70, v24, v25
    v_cvt_pk_bf16_f32 v71, v26, v27
    v_exp_f32 v28, v28
    v_exp_f32 v29, v29
    s_waitcnt lgkmcnt(3)
    v_mfma_f32_32x32x16_bf16 v[52:67], v[84:87], v[68:71], v[52:67]
    ds_read_b128 v[84:87], v11 offset:2560
    v_exp_f32 v30, v30
    v_exp_f32 v31, v31
    v_exp_f32 v32, v32
    v_exp_f32 v33, v33
    v_exp_f32 v34, v34
    v_exp_f32 v35, v35
    v_cvt_pk_bf16_f32 v72, v28, v29
    v_cvt_pk_bf16_f32 v73, v30, v31
    v_cvt_pk_bf16_f32 v74, v32, v33
    v_cvt_pk_bf16_f32 v75, v34, v35
    s_waitcnt lgkmcnt(3)
    s_nop 0
    v_mfma_f32_32x32x16_bf16 v[52:67], v[88:91], v[72:75], v[52:67]
    ds_read_b128 v[88:91], v11 offset:3200
    s_waitcnt lgkmcnt(2)
    v_mfma_f32_32x32x8_bf16 v[20:35], v[80:81], v[16:17], 0
    v_exp_f32 v36, v36
    v_exp_f32 v37, v37
    v_exp_f32 v38, v38
    v_exp_f32 v39, v39
    v_mfma_f32_32x32x16_bf16 v[20:35], v[76:79], v[12:15], v[20:35]
    ds_read_b64 v[80:81], v10 offset:7680
    ds_read_b128 v[76:79], v9 offset:7680
    v_exp_f32 v40, v40
    v_exp_f32 v41, v41
    v_exp_f32 v42, v42
    v_exp_f32 v43, v43
    v_cvt_pk_bf16_f32 v68, v36, v37
    v_cvt_pk_bf16_f32 v69, v38, v39
    v_cvt_pk_bf16_f32 v70, v40, v41
    v_cvt_pk_bf16_f32 v71, v42, v43
    v_exp_f32 v44, v44
    v_exp_f32 v45, v45
    s_waitcnt lgkmcnt(3)
    v_mfma_f32_32x32x16_bf16 v[52:67], v[84:87], v[68:71], v[52:67]
    ds_read_b128 v[84:87], v11 offset:5120
    buffer_store_dwordx4 v[128:131], v2, s[48:51], s67 offen offset:2048 sc1
    v_exp_f32 v46, v46
    v_exp_f32 v47, v47
    v_exp_f32 v48, v48
    v_exp_f32 v49, v49
    v_exp_f32 v50, v50
    v_exp_f32 v51, v51
    v_cvt_pk_bf16_f32 v72, v44, v45
    v_cvt_pk_bf16_f32 v73, v46, v47
    v_cvt_pk_bf16_f32 v74, v48, v49
    v_cvt_pk_bf16_f32 v75, v50, v51
    s_waitcnt lgkmcnt(3)
    s_nop 0
    v_mfma_f32_32x32x16_bf16 v[52:67], v[88:91], v[72:75], v[52:67]
    ds_read_b128 v[88:91], v11 offset:5760
    s_waitcnt lgkmcnt(2)
    v_mfma_f32_32x32x8_bf16 v[36:51], v[80:81], v[16:17], 0
    v_exp_f32 v20, v20
    v_exp_f32 v21, v21
    v_exp_f32 v22, v22
    v_exp_f32 v23, v23
    v_mfma_f32_32x32x16_bf16 v[36:51], v[76:79], v[12:15], v[36:51]
    ds_read_b64 v[80:81], v10 offset:10240
    ds_read_b128 v[76:79], v9 offset:10240
    v_exp_f32 v24, v24
    v_exp_f32 v25, v25
    v_exp_f32 v26, v26
    v_exp_f32 v27, v27
    v_cvt_pk_bf16_f32 v68, v20, v21
    v_cvt_pk_bf16_f32 v69, v22, v23
    v_cvt_pk_bf16_f32 v70, v24, v25
    v_cvt_pk_bf16_f32 v71, v26, v27
    v_exp_f32 v28, v28
    v_exp_f32 v29, v29
    s_waitcnt lgkmcnt(3)
    v_mfma_f32_32x32x16_bf16 v[52:67], v[84:87], v[68:71], v[52:67]
    ds_read_b128 v[84:87], v11 offset:7680
    v_exp_f32 v30, v30
    v_exp_f32 v31, v31
    v_exp_f32 v32, v32
    v_exp_f32 v33, v33
    v_exp_f32 v34, v34
    v_exp_f32 v35, v35
    v_cvt_pk_bf16_f32 v72, v28, v29
    v_cvt_pk_bf16_f32 v73, v30, v31
    v_cvt_pk_bf16_f32 v74, v32, v33
    v_cvt_pk_bf16_f32 v75, v34, v35
    s_waitcnt lgkmcnt(3)
    s_nop 0
    v_mfma_f32_32x32x16_bf16 v[52:67], v[88:91], v[72:75], v[52:67]
    ds_read_b128 v[88:91], v11 offset:8320
    buffer_store_dwordx4 v[128:131], v2, s[48:51], s67 offen offset:3072 sc1
    s_waitcnt lgkmcnt(2)
    v_mfma_f32_32x32x8_bf16 v[20:35], v[80:81], v[16:17], 0
    v_exp_f32 v36, v36
    v_exp_f32 v37, v37
    v_exp_f32 v38, v38
    v_exp_f32 v39, v39
    v_mfma_f32_32x32x16_bf16 v[20:35], v[76:79], v[12:15], v[20:35]
    ds_read_b64 v[80:81], v10 offset:12800
    ds_read_b128 v[76:79], v9 offset:12800
    v_exp_f32 v40, v40
    v_exp_f32 v41, v41
    v_exp_f32 v42, v42
    v_exp_f32 v43, v43
    v_cvt_pk_bf16_f32 v68, v36, v37
    v_cvt_pk_bf16_f32 v69, v38, v39
    v_cvt_pk_bf16_f32 v70, v40, v41
    v_cvt_pk_bf16_f32 v71, v42, v43
    v_exp_f32 v44, v44
    v_exp_f32 v45, v45
    s_waitcnt lgkmcnt(3)
    v_mfma_f32_32x32x16_bf16 v[52:67], v[84:87], v[68:71], v[52:67]
    ds_read_b128 v[84:87], v11 offset:10240
    v_exp_f32 v46, v46
    v_exp_f32 v47, v47
    v_exp_f32 v48, v48
    v_exp_f32 v49, v49
    v_exp_f32 v50, v50
    v_exp_f32 v51, v51
    v_cvt_pk_bf16_f32 v72, v44, v45
    v_cvt_pk_bf16_f32 v73, v46, v47
    v_cvt_pk_bf16_f32 v74, v48, v49
    v_cvt_pk_bf16_f32 v75, v50, v51
    v_add_u32 v9, 0x2800, v9
    v_add_u32 v10, 0x2800, v10
    s_waitcnt lgkmcnt(3)
    v_mfma_f32_32x32x16_bf16 v[52:67], v[88:91], v[72:75], v[52:67]
    ds_read_b128 v[88:91], v11 offset:10880
    v_add_u32 v11, 0x2800, v11
    s_mov_b32 s74, 7
    s_branch L_at_loop
L_at_spb:
    s_waitcnt vmcnt(8)
    s_barrier
    s_waitcnt lgkmcnt(2)
    v_mfma_f32_32x32x8_bf16 v[36:51], v[80:81], v[16:17], 0
    v_exp_f32 v20, v20
    v_exp_f32 v21, v21
    v_exp_f32 v22, v22
    v_exp_f32 v23, v23
    v_mfma_f32_32x32x16_bf16 v[36:51], v[76:79], v[12:15], v[36:51]
    ds_read_b64 v[80:81], v10 offset:5120
    ds_read_b128 v[76:79], v9 offset:5120
    v_exp_f32 v24, v24
    v_exp_f32 v25, v25
    v_exp_f32 v26, v26
    v_exp_f32 v27, v27
    v_cvt_pk_bf16_f32 v68, v20, v21
    v_cvt_pk_bf16_f32 v69, v22, v23
    v_cvt_pk_bf16_f32 v70, v24, v25
    v_cvt_pk_bf16_f32 v71, v26, v27
    v_exp_f32 v28, v28
    v_exp_f32 v29, v29
    s_waitcnt lgkmcnt(3)
    v_mfma_f32_32x32x16_bf16 v[52:67], v[84:87], v[68:71], v[52:67]
    ds_read_b128 v[84:87], v11 offset:2560
    v_exp_f32 v30, v30
    v_exp_f32 v31, v31
    v_exp_f32 v32, v32
    v_exp_f32 v33, v33
    v_exp_f32 v34, v34
    v_exp_f32 v35, v35
    v_cvt_pk_bf16_f32 v72, v28, v29
    v_cvt_pk_bf16_f32 v73, v30, v31
    v_cvt_pk_bf16_f32 v74, v32, v33
    v_cvt_pk_bf16_f32 v75, v34, v35
    s_waitcnt lgkmcnt(3)
    s_nop 0
    v_mfma_f32_32x32x16_bf16 v[52:67], v[88:91], v[72:75], v[52:67]
    ds_read_b128 v[88:91], v11 offset:3200
    s_waitcnt lgkmcnt(2)
    v_mfma_f32_32x32x8_bf16 v[20:35], v[80:81], v[16:17], 0
    v_exp_f32 v36, v36
    v_exp_f32 v37, v37
    v_exp_f32 v38, v38
    v_exp_f32 v39, v39
    v_mfma_f32_32x32x16_bf16 v[20:35], v[76:79], v[12:15], v[20:35]
    ds_read_b64 v[80:81], v10 offset:7680
    ds_read_b128 v[76:79], v9 offset:7680
    v_exp_f32 v40, v40
    v_exp_f32 v41, v41
    v_exp_f32 v42, v42
    v_exp_f32 v43, v43
    v_cvt_pk_bf16_f32 v68, v36, v37
    v_cvt_pk_bf16_f32 v69, v38, v39
    v_cvt_pk_bf16_f32 v70, v40, v41
    v_cvt_pk_bf16_f32 v71, v42, v43
    v_exp_f32 v44, v44
    v_exp_f32 v45, v45
    s_waitcnt lgkmcnt(3)
    v_mfma_f32_32x32x16_bf16 v[52:67], v[84:87], v[68:71], v[52:67]
    ds_read_b128 v[84:87], v11 offset:5120
    v_exp_f32 v46, v46
    v_exp_f32 v47, v47
    v_exp_f32 v48, v48
    v_exp_f32 v49, v49
    v_exp_f32 v50, v50
    v_exp_f32 v51, v51
    v_cvt_pk_bf16_f32 v72, v44, v45
    v_cvt_pk_bf16_f32 v73, v46, v47
    v_cvt_pk_bf16_f32 v74, v48, v49
    v_cvt_pk_bf16_f32 v75, v50, v51
    s_waitcnt lgkmcnt(3)
    s_nop 0
    v_mfma_f32_32x32x16_bf16 v[52:67], v[88:91], v[72:75], v[52:67]
    ds_read_b128 v[88:91], v11 offset:5760
    s_waitcnt lgkmcnt(2)
    v_mfma_f32_32x32x8_bf16 v[36:51], v[80:81], v[16:17], 0
    v_exp_f32 v20, v20
    v_exp_f32 v21, v21
    v_exp_f32 v22, v22
    v_exp_f32 v23, v23
    v_mfma_f32_32x32x16_bf16 v[36:51], v[76:79], v[12:15], v[36:51]
    ds_read_b64 v[80:81], v10 offset:10240
    ds_read_b128 v[76:79], v9 offset:10240
    v_exp_f32 v24, v24
    v_exp_f32 v25, v25
    v_exp_f32 v26, v26
    v_exp_f32 v27, v27
    v_cvt_pk_bf16_f32 v68, v20, v21
    v_cvt_pk_bf16_f32 v69, v22, v23
    v_cvt_pk_bf16_f32 v70, v24, v25
    v_cvt_pk_bf16_f32 v71, v26, v27
    v_exp_f32 v28, v28
    v_exp_f32 v29, v29
    s_waitcnt lgkmcnt(3)
    v_mfma_f32_32x32x16_bf16 v[52:67], v[84:87], v[68:71], v[52:67]
    ds_read_b128 v[84:87], v11 offset:7680
    v_exp_f32 v30, v30
    v_exp_f32 v31, v31
    v_exp_f32 v32, v32
    v_exp_f32 v33, v33
    v_exp_f32 v34, v34
    v_exp_f32 v35, v35
    v_cvt_pk_bf16_f32 v72, v28, v29
    v_cvt_pk_bf16_f32 v73, v30, v31
    v_cvt_pk_bf16_f32 v74, v32, v33
    v_cvt_pk_bf16_f32 v75, v34, v35
    s_waitcnt lgkmcnt(3)
    s_nop 0
    v_mfma_f32_32x32x16_bf16 v[52:67], v[88:91], v[72:75], v[52:67]
    ds_read_b128 v[88:91], v11 offset:8320
    s_waitcnt lgkmcnt(2)
    v_mfma_f32_32x32x8_bf16 v[20:35], v[80:81], v[16:17], 0
    v_exp_f32 v36, v36
    v_exp_f32 v37, v37
    v_exp_f32 v38, v38
    v_exp_f32 v39, v39
    v_mfma_f32_32x32x16_bf16 v[20:35], v[76:79], v[12:15], v[20:35]
    ds_read_b64 v[80:81], v10 offset:12800
    ds_read_b128 v[76:79], v9 offset:12800
    v_exp_f32 v40, v40
    v_exp_f32 v41, v41
    v_exp_f32 v42, v42
    v_exp_f32 v43, v43
    v_cvt_pk_bf16_f32 v68, v36, v37
    v_cvt_pk_bf16_f32 v69, v38, v39
    v_cvt_pk_bf16_f32 v70, v40, v41
    v_cvt_pk_bf16_f32 v71, v42, v43
    v_exp_f32 v44, v44
    v_exp_f32 v45, v45
    s_waitcnt lgkmcnt(3)
    v_mfma_f32_32x32x16_bf16 v[52:67], v[84:87], v[68:71], v[52:67]
    ds_read_b128 v[84:87], v11 offset:10240
    v_exp_f32 v46, v46
    v_exp_f32 v47, v47
    v_exp_f32 v48, v48
    v_exp_f32 v49, v49
    v_exp_f32 v50, v50
    v_exp_f32 v51, v51
    v_cvt_pk_bf16_f32 v72, v44, v45
    v_cvt_pk_bf16_f32 v73, v46, v47
    v_cvt_pk_bf16_f32 v74, v48, v49
    v_cvt_pk_bf16_f32 v75, v50, v51
    v_add_u32 v9, 0x2800, v9
    v_add_u32 v10, 0x2800, v10
    s_waitcnt lgkmcnt(3)
    v_mfma_f32_32x32x16_bf16 v[52:67], v[88:91], v[72:75], v[52:67]
    ds_read_b128 v[88:91], v11 offset:10880
    v_add_u32 v11, 0x2800, v11
    s_waitcnt lgkmcnt(2)
    v_mfma_f32_32x32x8_bf16 v[36:51], v[80:81], v[16:17], 0
    v_exp_f32 v20, v20
    v_exp_f32 v21, v21
    v_exp_f32 v22, v22
    v_exp_f32 v23, v23
    v_mfma_f32_32x32x16_bf16 v[36:51], v[76:79], v[12:15], v[36:51]
    ds_read_b64 v[80:81], v10 offset:5120
    ds_read_b128 v[76:79], v9 offset:5120
    v_exp_f32 v24, v24
    v_exp_f32 v25, v25
    v_exp_f32 v26, v26
    v_exp_f32 v27, v27
    v_cvt_pk_bf16_f32 v68, v20, v21
    v_cvt_pk_bf16_f32 v69, v22, v23
    v_cvt_pk_bf16_f32 v70, v24, v25
    v_cvt_pk_bf16_f32 v71, v26, v27
    v_exp_f32 v28, v28
    v_exp_f32 v29, v29
    s_waitcnt lgkmcnt(3)
    v_mfma_f32_32x32x16_bf16 v[52:67], v[84:87], v[68:71], v[52:67]
    ds_read_b128 v[84:87], v11 offset:2560
    v_exp_f32 v30, v30
    v_exp_f32 v31, v31
    v_exp_f32 v32, v32
    v_exp_f32 v33, v33
    v_exp_f32 v34, v34
    v_exp_f32 v35, v35
    v_cvt_pk_bf16_f32 v72, v28, v29
    v_cvt_pk_bf16_f32 v73, v30, v31
    v_cvt_pk_bf16_f32 v74, v32, v33
    v_cvt_pk_bf16_f32 v75, v34, v35
    s_waitcnt lgkmcnt(3)
    s_nop 0
    v_mfma_f32_32x32x16_bf16 v[52:67], v[88:91], v[72:75], v[52:67]
    ds_read_b128 v[88:91], v11 offset:3200
    s_waitcnt lgkmcnt(2)
    v_mfma_f32_32x32x8_bf16 v[20:35], v[80:81], v[16:17], 0
    v_exp_f32 v36, v36
    v_exp_f32 v37, v37
    v_exp_f32 v38, v38
    v_exp_f32 v39, v39
    v_mfma_f32_32x32x16_bf16 v[20:35], v[76:79], v[12:15], v[20:35]
    ds_read_b64 v[80:81], v10 offset:7680
    ds_read_b128 v[76:79], v9 offset:7680
    v_exp_f32 v40, v40
    v_exp_f32 v41, v41
    v_exp_f32 v42, v42
    v_exp_f32 v43, v43
    v_cvt_pk_bf16_f32 v68, v36, v37
    v_cvt_pk_bf16_f32 v69, v38, v39
    v_cvt_pk_bf16_f32 v70, v40, v41
    v_cvt_pk_bf16_f32 v71, v42, v43
    v_exp_f32 v44, v44
    v_exp_f32 v45, v45
    s_waitcnt lgkmcnt(3)
    v_mfma_f32_32x32x16_bf16 v[52:67], v[84:87], v[68:71], v[52:67]
    ds_read_b128 v[84:87], v11 offset:5120
    v_exp_f32 v46, v46
    v_exp_f32 v47, v47
    v_exp_f32 v48, v48
    v_exp_f32 v49, v49
    v_exp_f32 v50, v50
    v_exp_f32 v51, v51
    v_cvt_pk_bf16_f32 v72, v44, v45
    v_cvt_pk_bf16_f32 v73, v46, v47
    v_cvt_pk_bf16_f32 v74, v48, v49
    v_cvt_pk_bf16_f32 v75, v50, v51
    s_waitcnt lgkmcnt(3)
    s_nop 0
    v_mfma_f32_32x32x16_bf16 v[52:67], v[88:91], v[72:75], v[52:67]
    ds_read_b128 v[88:91], v11 offset:5760
    s_waitcnt lgkmcnt(2)
    v_mfma_f32_32x32x8_bf16 v[36:51], v[80:81], v[16:17], 0
    v_exp_f32 v20, v20
    v_exp_f32 v21, v21
    v_exp_f32 v22, v22
    v_exp_f32 v23, v23
    v_mfma_f32_32x32x16_bf16 v[36:51], v[76:79], v[12:15], v[36:51]
    ds_read_b64 v[80:81], v10 offset:10240
    ds_read_b128 v[76:79], v9 offset:10240
    v_exp_f32 v24, v24
    v_exp_f32 v25, v25
    v_exp_f32 v26, v26
    v_exp_f32 v27, v27
    v_cvt_pk_bf16_f32 v68, v20, v21
    v_cvt_pk_bf16_f32 v69, v22, v23
    v_cvt_pk_bf16_f32 v70, v24, v25
    v_cvt_pk_bf16_f32 v71, v26, v27
    v_exp_f32 v28, v28
    v_exp_f32 v29, v29
    s_waitcnt lgkmcnt(3)
    v_mfma_f32_32x32x16_bf16 v[52:67], v[84:87], v[68:71], v[52:67]
    ds_read_b128 v[84:87], v11 offset:7680
    v_exp_f32 v30, v30
    v_exp_f32 v31, v31
    v_exp_f32 v32, v32
    v_exp_f32 v33, v33
    v_exp_f32 v34, v34
    v_exp_f32 v35, v35
    v_cvt_pk_bf16_f32 v72, v28, v29
    v_cvt_pk_bf16_f32 v73, v30, v31
    v_cvt_pk_bf16_f32 v74, v32, v33
    v_cvt_pk_bf16_f32 v75, v34, v35
    s_waitcnt lgkmcnt(3)
    s_nop 0
    v_mfma_f32_32x32x16_bf16 v[52:67], v[88:91], v[72:75], v[52:67]
    ds_read_b128 v[88:91], v11 offset:8320
    s_waitcnt lgkmcnt(2)
    v_mfma_f32_32x32x8_bf16 v[20:35], v[80:81], v[16:17], 0
    v_exp_f32 v36, v36
    v_exp_f32 v37, v37
    v_exp_f32 v38, v38
    v_exp_f32 v39, v39
    v_mfma_f32_32x32x16_bf16 v[20:35], v[76:79], v[12:15], v[20:35]
    ds_read_b64 v[80:81], v10 offset:12800
    ds_read_b128 v[76:79], v9 offset:12800
    v_exp_f32 v40, v40
    v_exp_f32 v41, v41
    v_exp_f32 v42, v42
    v_exp_f32 v43, v43
    v_cvt_pk_bf16_f32 v68, v36, v37
    v_cvt_pk_bf16_f32 v69, v38, v39
    v_cvt_pk_bf16_f32 v70, v40, v41
    v_cvt_pk_bf16_f32 v71, v42, v43
    v_exp_f32 v44, v44
    v_exp_f32 v45, v45
    s_waitcnt lgkmcnt(3)
    v_mfma_f32_32x32x16_bf16 v[52:67], v[84:87], v[68:71], v[52:67]
    ds_read_b128 v[84:87], v11 offset:10240
    v_exp_f32 v46, v46
    v_exp_f32 v47, v47
    v_exp_f32 v48, v48
    v_exp_f32 v49, v49
    v_exp_f32 v50, v50
    v_exp_f32 v51, v51
    v_cvt_pk_bf16_f32 v72, v44, v45
    v_cvt_pk_bf16_f32 v73, v46, v47
    v_cvt_pk_bf16_f32 v74, v48, v49
    v_cvt_pk_bf16_f32 v75, v50, v51
    v_add_u32 v9, 0x2800, v9
    v_add_u32 v10, 0x2800, v10
    s_waitcnt lgkmcnt(3)
    v_mfma_f32_32x32x16_bf16 v[52:67], v[88:91], v[72:75], v[52:67]
    ds_read_b128 v[88:91], v11 offset:10880
    v_add_u32 v11, 0x2800, v11
    s_waitcnt lgkmcnt(2)
    v_mfma_f32_32x32x8_bf16 v[36:51], v[80:81], v[16:17], 0
    v_exp_f32 v20, v20
    v_exp_f32 v21, v21
    v_exp_f32 v22, v22
    v_exp_f32 v23, v23
    v_mfma_f32_32x32x16_bf16 v[36:51], v[76:79], v[12:15], v[36:51]
    ds_read_b64 v[80:81], v10 offset:5120
    ds_read_b128 v[76:79], v9 offset:5120
    v_exp_f32 v24, v24
    v_exp_f32 v25, v25
    v_exp_f32 v26, v26
    v_exp_f32 v27, v27
    v_cvt_pk_bf16_f32 v68, v20, v21
    v_cvt_pk_bf16_f32 v69, v22, v23
    v_cvt_pk_bf16_f32 v70, v24, v25
    v_cvt_pk_bf16_f32 v71, v26, v27
    v_exp_f32 v28, v28
    v_exp_f32 v29, v29
    s_waitcnt lgkmcnt(3)
    v_mfma_f32_32x32x16_bf16 v[52:67], v[84:87], v[68:71], v[52:67]
    ds_read_b128 v[84:87], v11 offset:2560
    v_exp_f32 v30, v30
    v_exp_f32 v31, v31
    v_exp_f32 v32, v32
    v_exp_f32 v33, v33
    v_exp_f32 v34, v34
    v_exp_f32 v35, v35
    v_cvt_pk_bf16_f32 v72, v28, v29
    v_cvt_pk_bf16_f32 v73, v30, v31
    v_cvt_pk_bf16_f32 v74, v32, v33
    v_cvt_pk_bf16_f32 v75, v34, v35
    s_waitcnt lgkmcnt(3)
    s_nop 0
    v_mfma_f32_32x32x16_bf16 v[52:67], v[88:91], v[72:75], v[52:67]
    ds_read_b128 v[88:91], v11 offset:3200
    s_waitcnt lgkmcnt(2)
    v_mfma_f32_32x32x8_bf16 v[20:35], v[80:81], v[16:17], 0
    v_exp_f32 v36, v36
    v_exp_f32 v37, v37
    v_exp_f32 v38, v38
    v_exp_f32 v39, v39
    v_mfma_f32_32x32x16_bf16 v[20:35], v[76:79], v[12:15], v[20:35]
    ds_read_b64 v[80:81], v10 offset:7680
    ds_read_b128 v[76:79], v9 offset:7680
    v_exp_f32 v40, v40
    v_exp_f32 v41, v41
    v_exp_f32 v42, v42
    v_exp_f32 v43, v43
    v_cvt_pk_bf16_f32 v68, v36, v37
    v_cvt_pk_bf16_f32 v69, v38, v39
    v_cvt_pk_bf16_f32 v70, v40, v41
    v_cvt_pk_bf16_f32 v71, v42, v43
    v_exp_f32 v44, v44
    v_exp_f32 v45, v45
    s_waitcnt lgkmcnt(3)
    v_mfma_f32_32x32x16_bf16 v[52:67], v[84:87], v[68:71], v[52:67]
    ds_read_b128 v[84:87], v11 offset:5120
    v_exp_f32 v46, v46
    v_exp_f32 v47, v47
    v_exp_f32 v48, v48
    v_exp_f32 v49, v49
    v_exp_f32 v50, v50
    v_exp_f32 v51, v51
    v_cvt_pk_bf16_f32 v72, v44, v45
    v_cvt_pk_bf16_f32 v73, v46, v47
    v_cvt_pk_bf16_f32 v74, v48, v49
    v_cvt_pk_bf16_f32 v75, v50, v51
    s_waitcnt lgkmcnt(3)
    s_nop 0
    v_mfma_f32_32x32x16_bf16 v[52:67], v[88:91], v[72:75], v[52:67]
    ds_read_b128 v[88:91], v11 offset:5760
    s_waitcnt lgkmcnt(2)
    v_mfma_f32_32x32x8_bf16 v[36:51], v[80:81], v[16:17], 0
    v_exp_f32 v20, v20
    v_exp_f32 v21, v21
    v_exp_f32 v22, v22
    v_exp_f32 v23, v23
    v_mfma_f32_32x32x16_bf16 v[36:51], v[76:79], v[12:15], v[36:51]
    ds_read_b64 v[80:81], v10 offset:10240
    ds_read_b128 v[76:79], v9 offset:10240
    v_exp_f32 v24, v24
    v_exp_f32 v25, v25
    v_exp_f32 v26, v26
    v_exp_f32 v27, v27
    v_cvt_pk_bf16_f32 v68, v20, v21
    v_cvt_pk_bf16_f32 v69, v22, v23
    v_cvt_pk_bf16_f32 v70, v24, v25
    v_cvt_pk_bf16_f32 v71, v26, v27
    v_exp_f32 v28, v28
    v_exp_f32 v29, v29
    s_waitcnt lgkmcnt(3)
    v_mfma_f32_32x32x16_bf16 v[52:67], v[84:87], v[68:71], v[52:67]
    ds_read_b128 v[84:87], v11 offset:7680
    v_exp_f32 v30, v30
    v_exp_f32 v31, v31
    v_exp_f32 v32, v32
    v_exp_f32 v33, v33
    v_exp_f32 v34, v34
    v_exp_f32 v35, v35
    v_cvt_pk_bf16_f32 v72, v28, v29
    v_cvt_pk_bf16_f32 v73, v30, v31
    v_cvt_pk_bf16_f32 v74, v32, v33
    v_cvt_pk_bf16_f32 v75, v34, v35
    s_waitcnt lgkmcnt(3)
    s_nop 0
    v_mfma_f32_32x32x16_bf16 v[52:67], v[88:91], v[72:75], v[52:67]
    ds_read_b128 v[88:91], v11 offset:8320
    s_waitcnt lgkmcnt(2)
    v_mfma_f32_32x32x8_bf16 v[20:35], v[80:81], v[16:17], 0
    v_exp_f32 v36, v36
    v_exp_f32 v37, v37
    v_exp_f32 v38, v38
    v_exp_f32 v39, v39
    v_mfma_f32_32x32x16_bf16 v[20:35], v[76:79], v[12:15], v[20:35]
    ds_read_b64 v[80:81], v10 offset:12800
    ds_read_b128 v[76:79], v9 offset:12800
    v_exp_f32 v40, v40
    v_exp_f32 v41, v41
    v_exp_f32 v42, v42
    v_exp_f32 v43, v43
    v_cvt_pk_bf16_f32 v68, v36, v37
    v_cvt_pk_bf16_f32 v69, v38, v39
    v_cvt_pk_bf16_f32 v70, v40, v41
    v_cvt_pk_bf16_f32 v71, v42, v43
    v_exp_f32 v44, v44
    v_exp_f32 v45, v45
    s_waitcnt lgkmcnt(3)
    v_mfma_f32_32x32x16_bf16 v[52:67], v[84:87], v[68:71], v[52:67]
    ds_read_b128 v[84:87], v11 offset:10240
    v_exp_f32 v46, v46
    v_exp_f32 v47, v47
    v_exp_f32 v48, v48
    v_exp_f32 v49, v49
    v_exp_f32 v50, v50
    v_exp_f32 v51, v51
    v_cvt_pk_bf16_f32 v72, v44, v45
    v_cvt_pk_bf16_f32 v73, v46, v47
    v_cvt_pk_bf16_f32 v74, v48, v49
    v_cvt_pk_bf16_f32 v75, v50, v51
    v_add_u32 v9, 0x2800, v9
    v_add_u32 v10, 0x2800, v10
    s_waitcnt lgkmcnt(3)
    v_mfma_f32_32x32x16_bf16 v[52:67], v[88:91], v[72:75], v[52:67]
    ds_read_b128 v[88:91], v11 offset:10880
    v_add_u32 v11, 0x2800, v11
    s_waitcnt lgkmcnt(2)
    v_mfma_f32_32x32x8_bf16 v[36:51], v[80:81], v[16:17], 0
    v_exp_f32 v20, v20
    v_exp_f32 v21, v21
    v_exp_f32 v22, v22
    v_exp_f32 v23, v23
    v_mfma_f32_32x32x16_bf16 v[36:51], v[76:79], v[12:15], v[36:51]
    ds_read_b64 v[80:81], v10 offset:5120
    ds_read_b128 v[76:79], v9 offset:5120
    v_exp_f32 v24, v24
    v_exp_f32 v25, v25
    v_exp_f32 v26, v26
    v_exp_f32 v27, v27
    v_cvt_pk_bf16_f32 v68, v20, v21
    v_cvt_pk_bf16_f32 v69, v22, v23
    v_cvt_pk_bf16_f32 v70, v24, v25
    v_cvt_pk_bf16_f32 v71, v26, v27
    v_exp_f32 v28, v28
    v_exp_f32 v29, v29
    s_waitcnt lgkmcnt(3)
    v_mfma_f32_32x32x16_bf16 v[52:67], v[84:87], v[68:71], v[52:67]
    ds_read_b128 v[84:87], v11 offset:2560
    v_exp_f32 v30, v30
    v_exp_f32 v31, v31
    v_exp_f32 v32, v32
    v_exp_f32 v33, v33
    v_exp_f32 v34, v34
    v_exp_f32 v35, v35
    v_cvt_pk_bf16_f32 v72, v28, v29
    v_cvt_pk_bf16_f32 v73, v30, v31
    v_cvt_pk_bf16_f32 v74, v32, v33
    v_cvt_pk_bf16_f32 v75, v34, v35
    s_waitcnt lgkmcnt(3)
    s_nop 0
    v_mfma_f32_32x32x16_bf16 v[52:67], v[88:91], v[72:75], v[52:67]
    ds_read_b128 v[88:91], v11 offset:3200
    s_waitcnt lgkmcnt(2)
    v_mfma_f32_32x32x8_bf16 v[20:35], v[80:81], v[16:17], 0
    v_exp_f32 v36, v36
    v_exp_f32 v37, v37
    v_exp_f32 v38, v38
    v_exp_f32 v39, v39
    v_mfma_f32_32x32x16_bf16 v[20:35], v[76:79], v[12:15], v[20:35]
    ds_read_b64 v[80:81], v10 offset:7680
    ds_read_b128 v[76:79], v9 offset:7680
    v_exp_f32 v40, v40
    v_exp_f32 v41, v41
    v_exp_f32 v42, v42
    v_exp_f32 v43, v43
    v_cvt_pk_bf16_f32 v68, v36, v37
    v_cvt_pk_bf16_f32 v69, v38, v39
    v_cvt_pk_bf16_f32 v70, v40, v41
    v_cvt_pk_bf16_f32 v71, v42, v43
    v_exp_f32 v44, v44
    v_exp_f32 v45, v45
    s_waitcnt lgkmcnt(3)
    v_mfma_f32_32x32x16_bf16 v[52:67], v[84:87], v[68:71], v[52:67]
    ds_read_b128 v[84:87], v11 offset:5120
    v_exp_f32 v46, v46
    v_exp_f32 v47, v47
    v_exp_f32 v48, v48
    v_exp_f32 v49, v49
    v_exp_f32 v50, v50
    v_exp_f32 v51, v51
    v_cvt_pk_bf16_f32 v72, v44, v45
    v_cvt_pk_bf16_f32 v73, v46, v47
    v_cvt_pk_bf16_f32 v74, v48, v49
    v_cvt_pk_bf16_f32 v75, v50, v51
    s_waitcnt lgkmcnt(3)
    s_nop 0
    v_mfma_f32_32x32x16_bf16 v[52:67], v[88:91], v[72:75], v[52:67]
    ds_read_b128 v[88:91], v11 offset:5760
    s_waitcnt lgkmcnt(2)
    v_mfma_f32_32x32x8_bf16 v[36:51], v[80:81], v[16:17], 0
    v_exp_f32 v20, v20
    v_exp_f32 v21, v21
    v_exp_f32 v22, v22
    v_exp_f32 v23, v23
    v_mfma_f32_32x32x16_bf16 v[36:51], v[76:79], v[12:15], v[36:51]
    ds_read_b64 v[80:81], v10 offset:10240
    ds_read_b128 v[76:79], v9 offset:10240
    v_exp_f32 v24, v24
    v_exp_f32 v25, v25
    v_exp_f32 v26, v26
    v_exp_f32 v27, v27
    v_cvt_pk_bf16_f32 v68, v20, v21
    v_cvt_pk_bf16_f32 v69, v22, v23
    v_cvt_pk_bf16_f32 v70, v24, v25
    v_cvt_pk_bf16_f32 v71, v26, v27
    v_exp_f32 v28, v28
    v_exp_f32 v29, v29
    s_waitcnt lgkmcnt(3)
    v_mfma_f32_32x32x16_bf16 v[52:67], v[84:87], v[68:71], v[52:67]
    ds_read_b128 v[84:87], v11 offset:7680
    v_exp_f32 v30, v30
    v_exp_f32 v31, v31
    v_exp_f32 v32, v32
    v_exp_f32 v33, v33
    v_exp_f32 v34, v34
    v_exp_f32 v35, v35
    v_cvt_pk_bf16_f32 v72, v28, v29
    v_cvt_pk_bf16_f32 v73, v30, v31
    v_cvt_pk_bf16_f32 v74, v32, v33
    v_cvt_pk_bf16_f32 v75, v34, v35
    s_waitcnt lgkmcnt(3)
    s_nop 0
    v_mfma_f32_32x32x16_bf16 v[52:67], v[88:91], v[72:75], v[52:67]
    ds_read_b128 v[88:91], v11 offset:8320
    s_waitcnt lgkmcnt(2)
    v_mfma_f32_32x32x8_bf16 v[20:35], v[80:81], v[16:17], 0
    v_exp_f32 v36, v36
    v_exp_f32 v37, v37
    v_exp_f32 v38, v38
    v_exp_f32 v39, v39
    v_mfma_f32_32x32x16_bf16 v[20:35], v[76:79], v[12:15], v[20:35]
    ds_read_b64 v[80:81], v10 offset:12800
    ds_read_b128 v[76:79], v9 offset:12800
    v_exp_f32 v40, v40
    v_exp_f32 v41, v41
    v_exp_f32 v42, v42
    v_exp_f32 v43, v43
    v_cvt_pk_bf16_f32 v68, v36, v37
    v_cvt_pk_bf16_f32 v69, v38, v39
    v_cvt_pk_bf16_f32 v70, v40, v41
    v_cvt_pk_bf16_f32 v71, v42, v43
    v_exp_f32 v44, v44
    v_exp_f32 v45, v45
    s_waitcnt lgkmcnt(3)
    v_mfma_f32_32x32x16_bf16 v[52:67], v[84:87], v[68:71], v[52:67]
    ds_read_b128 v[84:87], v11 offset:10240
    v_exp_f32 v46, v46
    v_exp_f32 v47, v47
    v_exp_f32 v48, v48
    v_exp_f32 v49, v49
    v_exp_f32 v50, v50
    v_exp_f32 v51, v51
    v_cvt_pk_bf16_f32 v72, v44, v45
    v_cvt_pk_bf16_f32 v73, v46, v47
    v_cvt_pk_bf16_f32 v74, v48, v49
    v_cvt_pk_bf16_f32 v75, v50, v51
    v_add_u32 v9, 0x2800, v9
    v_add_u32 v10, 0x2800, v10
    s_waitcnt lgkmcnt(3)
    v_mfma_f32_32x32x16_bf16 v[52:67], v[88:91], v[72:75], v[52:67]
    ds_read_b128 v[88:91], v11 offset:10880
    v_add_u32 v11, 0x2800, v11
    s_waitcnt vmcnt(0)
    s_waitcnt lgkmcnt(2)
    v_mfma_f32_32x32x8_bf16 v[36:51], v[80:81], v[16:17], 0
    v_exp_f32 v20, v20
    v_exp_f32 v21, v21
    v_exp_f32 v22, v22
    v_exp_f32 v23, v23
    v_mfma_f32_32x32x16_bf16 v[36:51], v[76:79], v[12:15], v[36:51]
    ds_read_b64 v[80:81], v10 offset:5120
    ds_read_b128 v[76:79], v9 offset:5120
    v_perm_b32 v128, v100, v96, s62
    v_perm_b32 v129, v108, v104, s62
    v_exp_f32 v24, v24
    v_exp_f32 v25, v25
    v_exp_f32 v26, v26
    v_exp_f32 v27, v27
    v_cvt_pk_bf16_f32 v68, v20, v21
    v_cvt_pk_bf16_f32 v69, v22, v23
    v_cvt_pk_bf16_f32 v70, v24, v25
    v_cvt_pk_bf16_f32 v71, v26, v27
    v_exp_f32 v28, v28
    v_exp_f32 v29, v29
    s_waitcnt lgkmcnt(3)
    v_mfma_f32_32x32x16_bf16 v[52:67], v[84:87], v[68:71], v[52:67]
    ds_read_b128 v[84:87], v11 offset:2560
    v_perm_b32 v130, v116, v112, s62
    v_perm_b32 v131, v124, v120, s62
    v_exp_f32 v30, v30
    v_exp_f32 v31, v31
    v_exp_f32 v32, v32
    v_exp_f32 v33, v33
    v_exp_f32 v34, v34
    v_exp_f32 v35, v35
    v_cvt_pk_bf16_f32 v72, v28, v29
    v_cvt_pk_bf16_f32 v73, v30, v31
    v_cvt_pk_bf16_f32 v74, v32, v33
    v_cvt_pk_bf16_f32 v75, v34, v35
    s_waitcnt lgkmcnt(3)
    s_nop 0
    v_mfma_f32_32x32x16_bf16 v[52:67], v[88:91], v[72:75], v[52:67]
    ds_read_b128 v[88:91], v11 offset:3200
    buffer_store_dwordx4 v[128:131], v169, s[48:51], s59 offen sc1
    v_perm_b32 v132, v100, v96, s63
    s_waitcnt lgkmcnt(2)
    v_mfma_f32_32x32x8_bf16 v[20:35], v[80:81], v[16:17], 0
    v_exp_f32 v36, v36
    v_exp_f32 v37, v37
    v_exp_f32 v38, v38
    v_exp_f32 v39, v39
    v_mfma_f32_32x32x16_bf16 v[20:35], v[76:79], v[12:15], v[20:35]
    ds_read_b64 v[80:81], v10 offset:7680
    ds_read_b128 v[76:79], v9 offset:7680
    v_perm_b32 v133, v108, v104, s63
    v_perm_b32 v134, v116, v112, s63
    v_exp_f32 v40, v40
    v_exp_f32 v41, v41
    v_exp_f32 v42, v42
    v_exp_f32 v43, v43
    v_cvt_pk_bf16_f32 v68, v36, v37
    v_cvt_pk_bf16_f32 v69, v38, v39
    v_cvt_pk_bf16_f32 v70, v40, v41
    v_cvt_pk_bf16_f32 v71, v42, v43
    v_exp_f32 v44, v44
    v_exp_f32 v45, v45
    s_waitcnt lgkmcnt(3)
    v_mfma_f32_32x32x16_bf16 v[52:67], v[84:87], v[68:71], v[52:67]
    ds_read_b128 v[84:87], v11 offset:5120
    v_perm_b32 v135, v124, v120, s63
    s_add_u32 s67, s59, s61
    buffer_store_dwordx4 v[132:135], v169, s[48:51], s67 offen sc1
    s_add_u32 s59, s59, s60
    v_exp_f32 v46, v46
    v_exp_f32 v47, v47
    v_exp_f32 v48, v48
    v_exp_f32 v49, v49
    v_exp_f32 v50, v50
    v_exp_f32 v51, v51
    v_cvt_pk_bf16_f32 v72, v44, v45
    v_cvt_pk_bf16_f32 v73, v46, v47
    v_cvt_pk_bf16_f32 v74, v48, v49
    v_cvt_pk_bf16_f32 v75, v50, v51
    s_waitcnt lgkmcnt(3)
    s_nop 0
    v_mfma_f32_32x32x16_bf16 v[52:67], v[88:91], v[72:75], v[52:67]
    ds_read_b128 v[88:91], v11 offset:5760
    v_perm_b32 v136, v101, v97, s62
    v_perm_b32 v137, v109, v105, s62
    s_waitcnt lgkmcnt(2)
    v_mfma_f32_32x32x8_bf16 v[36:51], v[80:81], v[16:17], 0
    v_exp_f32 v20, v20
    v_exp_f32 v21, v21
    v_exp_f32 v22, v22
    v_exp_f32 v23, v23
    v_mfma_f32_32x32x16_bf16 v[36:51], v[76:79], v[12:15], v[36:51]
    ds_read_b64 v[80:81], v10 offset:10240
    ds_read_b128 v[76:79], v9 offset:10240
    v_perm_b32 v138, v117, v113, s62
    v_perm_b32 v139, v125, v121, s62
    v_exp_f32 v24, v24
    v_exp_f32 v25, v25
    v_exp_f32 v26, v26
    v_exp_f32 v27, v27
    v_cvt_pk_bf16_f32 v68, v20, v21
    v_cvt_pk_bf16_f32 v69, v22, v23
    v_cvt_pk_bf16_f32 v70, v24, v25
    v_cvt_pk_bf16_f32 v71, v26, v27
    v_exp_f32 v28, v28
    v_exp_f32 v29, v29
    s_waitcnt lgkmcnt(3)
    v_mfma_f32_32x32x16_bf16 v[52:67], v[84:87], v[68:71], v[52:67]
    ds_read_b128 v[84:87], v11 offset:7680
    buffer_store_dwordx4 v[136:139], v169, s[48:51], s59 offen sc1
    v_perm_b32 v140, v101, v97, s63
    v_exp_f32 v30, v30
    v_exp_f32 v31, v31
    v_exp_f32 v32, v32
    v_exp_f32 v33, v33
    v_exp_f32 v34, v34
    v_exp_f32 v35, v35
    v_cvt_pk_bf16_f32 v72, v28, v29
    v_cvt_pk_bf16_f32 v73, v30, v31
    v_cvt_pk_bf16_f32 v74, v32, v33
    v_cvt_pk_bf16_f32 v75, v34, v35
    s_waitcnt lgkmcnt(3)
    s_nop 0
    v_mfma_f32_32x32x16_bf16 v[52:67], v[88:91], v[72:75], v[52:67]
    ds_read_b128 v[88:91], v11 offset:8320
    v_perm_b32 v141, v109, v105, s63
    s_waitcnt lgkmcnt(2)
    v_mfma_f32_32x32x8_bf16 v[20:35], v[80:81], v[16:17], 0
    v_exp_f32 v36, v36
    v_exp_f32 v37, v37
    v_exp_f32 v38, v38
    v_exp_f32 v39, v39
    v_mfma_f32_32x32x16_bf16 v[20:35], v[76:79], v[12:15], v[20:35]
    ds_read_b64 v[80:81], v10 offset:12800
    ds_read_b128 v[76:79], v9 offset:12800
    v_perm_b32 v142, v117, v113, s63
    v_exp_f32 v40, v40
    v_exp_f32 v41, v41
    v_exp_f32 v42, v42
    v_exp_f32 v43, v43
    v_cvt_pk_bf16_f32 v68, v36, v37
    v_cvt_pk_bf16_f32 v69, v38, v39
    v_cvt_pk_bf16_f32 v70, v40, v41
    v_cvt_pk_bf16_f32 v71, v42, v43
    v_exp_f32 v44, v44
    v_exp_f32 v45, v45
    s_waitcnt lgkmcnt(3)
    v_mfma_f32_32x32x16_bf16 v[52:67], v[84:87], v[68:71], v[52:67]
    ds_read_b128 v[84:87], v11 offset:10240
    v_perm_b32 v143, v125, v121, s63
    v_exp_f32 v46, v46
    v_exp_f32 v47, v47
    v_exp_f32 v48, v48
    v_exp_f32 v49, v49
    v_exp_f32 v50, v50
    v_exp_f32 v51, v51
    v_cvt_pk_bf16_f32 v72, v44, v45
    v_cvt_pk_bf16_f32 v73, v46, v47
    v_cvt_pk_bf16_f32 v74, v48, v49
    v_cvt_pk_bf16_f32 v75, v50, v51
    v_add_u32 v9, 0x2800, v9
    v_add_u32 v10, 0x2800, v10
    s_waitcnt lgkmcnt(3)
    v_mfma_f32_32x32x16_bf16 v[52:67], v[88:91], v[72:75], v[52:67]
    ds_read_b128 v[88:91], v11 offset:10880
    s_add_u32 s67, s59, s61
    buffer_store_dwordx4 v[140:143], v169, s[48:51], s67 offen sc1
    s_add_u32 s59, s59, s60
    v_add_u32 v11, 0x2800, v11
    s_waitcnt lgkmcnt(2)
    v_mfma_f32_32x32x8_bf16 v[36:51], v[80:81], v[16:17], 0
    v_exp_f32 v20, v20
    v_exp_f32 v21, v21
    v_exp_f32 v22, v22
    v_exp_f32 v23, v23
    v_mfma_f32_32x32x16_bf16 v[36:51], v[76:79], v[12:15], v[36:51]
    ds_read_b64 v[80:81], v10 offset:5120
    ds_read_b128 v[76:79], v9 offset:5120
    v_perm_b32 v144, v102, v98, s62
    v_perm_b32 v145, v110, v106, s62
    v_exp_f32 v24, v24
    v_exp_f32 v25, v25
    v_exp_f32 v26, v26
    v_exp_f32 v27, v27
    v_cvt_pk_bf16_f32 v68, v20, v21
    v_cvt_pk_bf16_f32 v69, v22, v23
    v_cvt_pk_bf16_f32 v70, v24, v25
    v_cvt_pk_bf16_f32 v71, v26, v27
    v_exp_f32 v28, v28
    v_exp_f32 v29, v29
    s_waitcnt lgkmcnt(3)
    v_mfma_f32_32x32x16_bf16 v[52:67], v[84:87], v[68:71], v[52:67]
    ds_read_b128 v[84:87], v11 offset:2560
    v_perm_b32 v146, v118, v114, s62
    v_perm_b32 v147, v126, v122, s62
    v_exp_f32 v30, v30
    v_exp_f32 v31, v31
    v_exp_f32 v32, v32
    v_exp_f32 v33, v33
    v_exp_f32 v34, v34
    v_exp_f32 v35, v35
    v_cvt_pk_bf16_f32 v72, v28, v29
    v_cvt_pk_bf16_f32 v73, v30, v31
    v_cvt_pk_bf16_f32 v74, v32, v33
    v_cvt_pk_bf16_f32 v75, v34, v35
    s_waitcnt lgkmcnt(3)
    s_nop 0
    v_mfma_f32_32x32x16_bf16 v[52:67], v[88:91], v[72:75], v[52:67]
    ds_read_b128 v[88:91], v11 offset:3200
    buffer_store_dwordx4 v[144:147], v169, s[48:51], s59 offen sc1
    v_perm_b32 v148, v102, v98, s63
    s_waitcnt lgkmcnt(2)
    v_mfma_f32_32x32x8_bf16 v[20:35], v[80:81], v[16:17], 0
    v_exp_f32 v36, v36
    v_exp_f32 v37, v37
    v_exp_f32 v38, v38
    v_exp_f32 v39, v39
    v_mfma_f32_32x32x16_bf16 v[20:35], v[76:79], v[12:15], v[20:35]
    ds_read_b64 v[80:81], v10 offset:7680
    ds_read_b128 v[76:79], v9 offset:7680
    v_perm_b32 v149, v110, v106, s63
    v_perm_b32 v150, v118, v114, s63
    v_exp_f32 v40, v40
    v_exp_f32 v41, v41
    v_exp_f32 v42, v42
    v_exp_f32 v43, v43
    v_cvt_pk_bf16_f32 v68, v36, v37
    v_cvt_pk_bf16_f32 v69, v38, v39
    v_cvt_pk_bf16_f32 v70, v40, v41
    v_cvt_pk_bf16_f32 v71, v42, v43
    v_exp_f32 v44, v44
    v_exp_f32 v45, v45
    s_waitcnt lgkmcnt(3)
    v_mfma_f32_32x32x16_bf16 v[52:67], v[84:87], v[68:71], v[52:67]
    ds_read_b128 v[84:87], v11 offset:5120
    v_perm_b32 v151, v126, v122, s63
    s_add_u32 s67, s59, s61
    buffer_store_dwordx4 v[148:151], v169, s[48:51], s67 offen sc1
    s_add_u32 s59, s59, s60
    v_exp_f32 v46, v46
    v_exp_f32 v47, v47
    v_exp_f32 v48, v48
    v_exp_f32 v49, v49
    v_exp_f32 v50, v50
    v_exp_f32 v51, v51
    v_cvt_pk_bf16_f32 v72, v44, v45
    v_cvt_pk_bf16_f32 v73, v46, v47
    v_cvt_pk_bf16_f32 v74, v48, v49
    v_cvt_pk_bf16_f32 v75, v50, v51
    s_waitcnt lgkmcnt(3)
    s_nop 0
    v_mfma_f32_32x32x16_bf16 v[52:67], v[88:91], v[72:75], v[52:67]
    ds_read_b128 v[88:91], v11 offset:5760
    v_perm_b32 v152, v103, v99, s62
    v_perm_b32 v153, v111, v107, s62
    s_waitcnt lgkmcnt(2)
    v_mfma_f32_32x32x8_bf16 v[36:51], v[80:81], v[16:17], 0
    v_exp_f32 v20, v20
    v_exp_f32 v21, v21
    v_exp_f32 v22, v22
    v_exp_f32 v23, v23
    v_mfma_f32_32x32x16_bf16 v[36:51], v[76:79], v[12:15], v[36:51]
    ds_read_b64 v[80:81], v10 offset:10240
    ds_read_b128 v[76:79], v9 offset:10240
    v_perm_b32 v154, v119, v115, s62
    v_perm_b32 v155, v127, v123, s62
    v_exp_f32 v24, v24
    v_exp_f32 v25, v25
    v_exp_f32 v26, v26
    v_exp_f32 v27, v27
    v_cvt_pk_bf16_f32 v68, v20, v21
    v_cvt_pk_bf16_f32 v69, v22, v23
    v_cvt_pk_bf16_f32 v70, v24, v25
    v_cvt_pk_bf16_f32 v71, v26, v27
    v_exp_f32 v28, v28
    v_exp_f32 v29, v29
    s_waitcnt lgkmcnt(3)
    v_mfma_f32_32x32x16_bf16 v[52:67], v[84:87], v[68:71], v[52:67]
    ds_read_b128 v[84:87], v11 offset:7680
    buffer_store_dwordx4 v[152:155], v169, s[48:51], s59 offen sc1
    v_perm_b32 v156, v103, v99, s63
    v_exp_f32 v30, v30
    v_exp_f32 v31, v31
    v_exp_f32 v32, v32
    v_exp_f32 v33, v33
    v_exp_f32 v34, v34
    v_exp_f32 v35, v35
    v_cvt_pk_bf16_f32 v72, v28, v29
    v_cvt_pk_bf16_f32 v73, v30, v31
    v_cvt_pk_bf16_f32 v74, v32, v33
    v_cvt_pk_bf16_f32 v75, v34, v35
    s_waitcnt lgkmcnt(3)
    s_nop 0
    v_mfma_f32_32x32x16_bf16 v[52:67], v[88:91], v[72:75], v[52:67]
    ds_read_b128 v[88:91], v11 offset:8320
    v_perm_b32 v157, v111, v107, s63
    v_perm_b32 v158, v119, v115, s63
    s_waitcnt lgkmcnt(2)
    v_mfma_f32_32x32x8_bf16 v[20:35], v[80:81], v[16:17], 0
    v_exp_f32 v36, v36
    v_exp_f32 v37, v37
    v_exp_f32 v38, v38
    v_exp_f32 v39, v39
    v_mfma_f32_32x32x16_bf16 v[20:35], v[76:79], v[12:15], v[20:35]
    ds_read_b64 v[80:81], v10 offset:12800
    ds_read_b128 v[76:79], v9 offset:12800
    v_perm_b32 v159, v127, v123, s63
    v_exp_f32 v40, v40
    v_exp_f32 v41, v41
    v_exp_f32 v42, v42
    v_exp_f32 v43, v43
    v_cvt_pk_bf16_f32 v68, v36, v37
    v_cvt_pk_bf16_f32 v69, v38, v39
    v_cvt_pk_bf16_f32 v70, v40, v41
    v_cvt_pk_bf16_f32 v71, v42, v43
    v_exp_f32 v44, v44
    v_exp_f32 v45, v45
    s_waitcnt lgkmcnt(3)
    v_mfma_f32_32x32x16_bf16 v[52:67], v[84:87], v[68:71], v[52:67]
    ds_read_b128 v[84:87], v11 offset:10240
    s_add_u32 s67, s59, s61
    buffer_store_dwordx4 v[156:159], v169, s[48:51], s67 offen sc1
    v_exp_f32 v46, v46
    v_exp_f32 v47, v47
    v_exp_f32 v48, v48
    v_exp_f32 v49, v49
    v_exp_f32 v50, v50
    v_exp_f32 v51, v51
    v_cvt_pk_bf16_f32 v72, v44, v45
    v_cvt_pk_bf16_f32 v73, v46, v47
    v_cvt_pk_bf16_f32 v74, v48, v49
    v_cvt_pk_bf16_f32 v75, v50, v51
    v_add_u32 v9, 0x2800, v9
    v_add_u32 v10, 0x2800, v10
    s_waitcnt lgkmcnt(3)
    v_mfma_f32_32x32x16_bf16 v[52:67], v[88:91], v[72:75], v[52:67]
    ds_read_b128 v[88:91], v11 offset:10880
    s_cmp_eq_u32 s66, -2
    s_cbranch_scc1 L_pj_e_40
    s_cmp_eq_u32 s66, -1
    s_cbranch_scc1 L_pj_b_39
    v_mfma_f32_16x16x32_bf16 v[96:99], v[172:175], v[128:131], 0
    v_mfma_f32_16x16x32_bf16 v[100:103], v[172:175], v[132:135], 0
    v_mfma_f32_16x16x32_bf16 v[104:107], v[172:175], v[136:139], 0
    v_mfma_f32_16x16x32_bf16 v[108:111], v[172:175], v[140:143], 0
    v_mfma_f32_16x16x32_bf16 v[112:115], v[172:175], v[144:147], 0
    v_mfma_f32_16x16x32_bf16 v[116:119], v[172:175], v[148:151], 0
    v_mfma_f32_16x16x32_bf16 v[120:123], v[172:175], v[152:155], 0
    v_mfma_f32_16x16x32_bf16 v[124:127], v[172:175], v[156:159], 0
    s_nop 4
    v_mov_b32 v97, v112
    v_cndmask_b32 v96, v96, v100, s[8:9]
    v_cndmask_b32 v97, v97, v116, s[8:9]
    v_cndmask_b32 v96, v96, v104, s[10:11]
    v_cndmask_b32 v97, v97, v120, s[10:11]
    v_cndmask_b32 v96, v96, v108, s[12:13]
    v_cndmask_b32 v97, v97, v124, s[12:13]
    s_nop 0
    v_add_f32 v96, v96, v96 row_ror:8 row_mask:0xf bank_mask:0xf
    v_add_f32 v97, v97, v97 row_ror:8 row_mask:0xf bank_mask:0xf
    s_mov_b32 exec_lo, 0x00ff00ff
    s_mov_b32 exec_hi, 0x00ff00ff
    buffer_store_dwordx2 v[96:97], v170, s[52:55], s66 offen sc1
    s_mov_b64 exec, -1
    s_branch L_pj_e_40
L_pj_b_39:
    v_lshl_or_b32 v96, v161, 16, v160
    v_lshl_or_b32 v97, v163, 16, v162
    v_lshl_or_b32 v98, v165, 16, v164
    v_lshl_or_b32 v99, v167, 16, v166
    s_add_u32 s67, s59, 0x1400
    buffer_store_dwordx4 v[96:99], v2, s[48:51], s67 offen sc1
L_pj_e_40:
    v_add_u32 v11, 0x2800, v11
    s_mov_b32 s74, 14
    s_branch L_at_loop
L_at_done:
    s_waitcnt lgkmcnt(0)
    s_nop 4
    v_mov_b32 v92, v62
    v_mov_b32 v93, v62
    s_nop 1
    v_permlane32_swap_b32 v92, v93
    s_cmp_lg_u32 s75, 0
    s_cbranch_scc1 L_at_fin
    v_mov_b32 v3, 0x5f800000
    v_cmp_nlt_f32 vcc, v92, v3
    s_nop 1
    s_cmp_eq_u64 vcc, 0
    s_cbranch_scc1 L_at_fin
    s_mov_b32 s75, 1
    s_mov_b32 s72, 0x63
    s_mov_b32 s73, 0x63
    v_mov_b32 v17, 0
    v_mov_b32 v9, v2
    v_mov_b32 v10, v6
    v_mov_b32 v92, 0xff800000
    s_mov_b32 s74, 0
L_at_max:
    ds_read_b64 v[80:81], v10
    ds_read_b128 v[76:79], v9
    v_add_u32 v9, 0xa00, v9
    v_add_u32 v10, 0xa00, v10
    s_waitcnt lgkmcnt(0)
    v_mfma_f32_32x32x8_bf16 v[20:35], v[80:81], v[16:17], 0
    v_mfma_f32_32x32x16_bf16 v[20:35], v[76:79], v[12:15], v[20:35]
    s_nop 11
    v_max3_f32 v92, v92, v20, v21
    v_max3_f32 v92, v92, v22, v23
    v_max3_f32 v92, v92, v24, v25
    v_max3_f32 v92, v92, v26, v27
    v_max3_f32 v92, v92, v28, v29
    v_max3_f32 v92, v92, v30, v31
    v_max3_f32 v92, v92, v32, v33
    v_max3_f32 v92, v92, v34, v35
    s_add_u32 s74, s74, 1
    s_cmp_lt_u32 s74, 64
    s_cbranch_scc1 L_at_max
    v_mov_b32 v93, v92
    s_nop 1
    v_permlane32_swap_b32 v92, v93
    v_max_f32 v92, v92, v93
    v_mul_f32 v92, -1.0, v92
    v_cvt_pk_bf16_f32 v93, v92, v92
    v_lshlrev_b32 v93, 16, v93
    v_sub_f32 v92, v92, v93
    s_mov_b32 exec_hi, 0
    v_cvt_pk_bf16_f32 v17, v93, v92
    s_mov_b32 exec_hi, -1
    s_branch L_at_run
L_at_fin:
    v_rcp_f32 v92, v92
    v_lshrrev_b32 v3, 4, v8
    v_mul_u32_u24 v9, 0x4800, v3
    v_and_b32 v3, 15, v1
    v_lshl_add_u32 v9, v3, 4, v9
    s_mul_i32 s76, s21, 0x9000
    s_lshr_b32 s23, s20, 2
    s_lshl_b32 s77, s23, 8
    s_and_b32 s23, s20, 3
    s_lshl_b32 s23, s23, 1
    s_add_u32 s77, s77, s23
    s_add_u32 s77, s77, s76
    s_add_u32 s77, s77, 0x4000
    s_lshl_b32 s23, s20, 9
    s_add_u32 s76, s76, s23
    v_lshrrev_b32 v3, 5, v1
    v_lshl_add_u32 v10, v3, 3, v9
    v_mul_f32 v52, v52, v92
    v_mul_f32 v53, v53, v92
    v_mul_f32 v54, v54, v92
    v_mul_f32 v55, v55, v92
    v_cvt_pk_bf16_f32 v20, v52, v53
    v_cvt_pk_bf16_f32 v21, v54, v55
    buffer_store_dwordx2 v[20:21], v10, s[40:43], s76 offen
    v_mul_f32 v56, v56, v92
    v_mul_f32 v57, v57, v92
    v_mul_f32 v58, v58, v92
    v_mul_f32 v59, v59, v92
    v_cvt_pk_bf16_f32 v22, v56, v57
    v_cvt_pk_bf16_f32 v23, v58, v59
    buffer_store_dwordx2 v[22:23], v10, s[40:43], s76 offen offset:256
    v_mul_f32 v60, v60, v92
    v_mul_f32 v61, v61, v92
    v_cvt_pk_bf16_f32 v24, v60, v61
    s_mov_b32 exec_hi, 0
    buffer_store_short v24, v9, s[40:43], s77 offen
    buffer_store_short_d16_hi v24, v9, s[40:43], s77 offen offset:8
L_at_end:
    s_endpgm
.text
.globl attn_out_kernel
.p2align 8
.type attn_out_kernel,@function
attn_out_kernel:
    s_cmp_ge_u32 s2, 0x100
    s_cbranch_scc1 L_wo_end
    s_load_dwordx2 s[4:5], s[0:1], 0
    s_load_dwordx2 s[6:7], s[0:1], 0x48
    s_and_b32 s8, s2, 7
    s_lshr_b32 s9, s2, 3
    s_lshr_b32 s10, s8, 1
    s_lshl_b32 s10, s10, 3
    s_and_b32 s13, s9, 7
    s_add_u32 s10, s10, s13
    s_and_b32 s11, s8, 1
    s_lshl_b32 s11, s11, 2
    s_lshr_b32 s13, s9, 3
    s_add_u32 s11, s11, s13
    v_lshrrev_b32 v2, 6, v0
    v_and_b32 v1, 63, v0
    v_readfirstlane_b32 s12, v2
    v_lshlrev_b32 v5, 4, v1
    s_nop 0
    s_lshl_b32 s20, s12, 10
    s_mul_i32 s14, s11, 0x14400
    s_add_u32 s14, s14, s20
    s_lshl_b32 s21, s10, 6
    s_lshl_b32 s13, s12, 4
    s_add_u32 s21, s21, s13
    s_lshr_b32 s15, s21, 4
    s_mul_i32 s15, s15, 0x4800
    s_waitcnt lgkmcnt(0)
    s_add_u32 s24, s6, 0x3600000
    s_addc_u32 s25, s7, 0
    s_and_b32 s25, s25, 0xffff
    s_mov_b32 s26, 0xa2000
    s_mov_b32 s27, 0x20000
    s_add_u32 s28, s6, 0x800000
    s_addc_u32 s29, s7, 0
    s_and_b32 s29, s29, 0xffff
    s_mov_b32 s30, 0x240000
    s_mov_b32 s31, 0x20000
    s_add_u32 m0, s20, 0
    s_add_u32 s13, s14, 0
    buffer_load_dwordx4 v5, s[24:27], s13 offen lds
    buffer_load_dwordx4 v[32:35], v5, s[28:31], s15 offen
    s_add_u32 m0, s20, 0x1000
    s_add_u32 s13, s14, 0x1000
    buffer_load_dwordx4 v5, s[24:27], s13 offen lds
    buffer_load_dwordx4 v[36:39], v5, s[28:31], s15 offen offset:1024
    s_add_u32 m0, s20, 0x2000
    s_add_u32 s13, s14, 0x2000
    buffer_load_dwordx4 v5, s[24:27], s13 offen lds
    buffer_load_dwordx4 v[40:43], v5, s[28:31], s15 offen offset:2048
    s_add_u32 m0, s20, 0x3000
    s_add_u32 s13, s14, 0x3000
    buffer_load_dwordx4 v5, s[24:27], s13 offen lds
    buffer_load_dwordx4 v[44:47], v5, s[28:31], s15 offen offset:3072
    s_add_u32 m0, s20, 0x4000
    s_add_u32 s13, s14, 0x4000
    buffer_load_dwordx4 v5, s[24:27], s13 offen lds
    s_add_u32 s15, s15, 0x1000
    buffer_load_dwordx4 v[48:51], v5, s[28:31], s15 offen
    s_add_u32 m0, s20, 0x5000
    s_add_u32 s13, s14, 0x5000
    buffer_load_dwordx4 v5, s[24:27], s13 offen lds
    buffer_load_dwordx4 v[52:55], v5, s[28:31], s15 offen offset:1024
    s_add_u32 m0, s20, 0x6000
    s_add_u32 s13, s14, 0x6000
    buffer_load_dwordx4 v5, s[24:27], s13 offen lds
    s_barrier
    s_add_u32 m0, s20, 0x6c00
    s_add_u32 s13, s14, 0x6c00
    buffer_load_dwordx4 v5, s[24:27], s13 offen lds
    buffer_load_dwordx4 v[56:59], v5, s[28:31], s15 offen offset:2048
    s_add_u32 m0, s20, 0x7c00
    s_add_u32 s13, s14, 0x7c00
    buffer_load_dwordx4 v5, s[24:27], s13 offen lds
    buffer_load_dwordx4 v[60:63], v5, s[28:31], s15 offen offset:3072
    s_add_u32 m0, s20, 0x8c00
    s_add_u32 s13, s14, 0x8c00
    buffer_load_dwordx4 v5, s[24:27], s13 offen lds
    s_add_u32 s15, s15, 0x1000
    buffer_load_dwordx4 v[64:67], v5, s[28:31], s15 offen
    s_add_u32 m0, s20, 0x9c00
    s_add_u32 s13, s14, 0x9c00
    buffer_load_dwordx4 v5, s[24:27], s13 offen lds
    buffer_load_dwordx4 v[68:71], v5, s[28:31], s15 offen offset:1024
    s_add_u32 m0, s20, 0xac00
    s_add_u32 s13, s14, 0xac00
    buffer_load_dwordx4 v5, s[24:27], s13 offen lds
    buffer_load_dwordx4 v[72:75], v5, s[28:31], s15 offen offset:2048
    s_add_u32 m0, s20, 0xbc00
    s_add_u32 s13, s14, 0xbc00
    buffer_load_dwordx4 v5, s[24:27], s13 offen lds
    buffer_load_dwordx4 v[76:79], v5, s[28:31], s15 offen offset:3072
    s_add_u32 m0, s20, 0xcc00
    s_add_u32 s13, s14, 0xcc00
    buffer_load_dwordx4 v5, s[24:27], s13 offen lds
    s_add_u32 m0, s20, 0xd800
    s_add_u32 s13, s14, 0xd800
    buffer_load_dwordx4 v5, s[24:27], s13 offen lds
    s_add_u32 s15, s15, 0x1000
    buffer_load_dwordx4 v[80:83], v5, s[28:31], s15 offen
    s_add_u32 m0, s20, 0xe800
    s_add_u32 s13, s14, 0xe800
    buffer_load_dwordx4 v5, s[24:27], s13 offen lds
    buffer_load_dwordx4 v[84:87], v5, s[28:31], s15 offen offset:1024
    s_add_u32 m0, s20, 0xf800
    s_add_u32 s13, s14, 0xf800
    buffer_load_dwordx4 v5, s[24:27], s13 offen lds
    buffer_load_dwordx4 v[88:91], v5, s[28:31], s15 offen offset:2048
    s_add_u32 m0, s20, 0x10800
    s_add_u32 s13, s14, 0x10800
    buffer_load_dwordx4 v5, s[24:27], s13 offen lds
    buffer_load_dwordx4 v[92:95], v5, s[28:31], s15 offen offset:3072
    s_add_u32 m0, s20, 0x11800
    s_add_u32 s13, s14, 0x11800
    buffer_load_dwordx4 v5, s[24:27], s13 offen lds
    s_add_u32 s15, s15, 0x1000
    buffer_load_dwordx4 v[96:99], v5, s[28:31], s15 offen
    s_add_u32 m0, s20, 0x12800
    s_add_u32 s13, s14, 0x12800
    buffer_load_dwordx4 v5, s[24:27], s13 offen lds
    buffer_load_dwordx4 v[100:103], v5, s[28:31], s15 offen offset:1024
    s_add_u32 m0, s20, 0x13800
    s_add_u32 s13, s14, 0x13800
    buffer_load_dwordx4 v5, s[24:27], s13 offen lds
    s_add_u32 s32, s6, 0xa80000
    s_addc_u32 s33, s7, 0
    s_and_b32 s33, s33, 0xffff
    s_mov_b32 s34, 0x240000
    s_mov_b32 s35, 0x20000
    s_mov_b32 s36, s4
    s_and_b32 s37, s5, 0xffff
    s_mov_b32 s38, 0x240000
    s_mov_b32 s39, 0x20000
    s_add_u32 s40, s6, 0xd00000
    s_addc_u32 s41, s7, 0
    s_and_b32 s41, s41, 0xffff
    s_mov_b32 s42, 0x20000
    s_mov_b32 s43, 0x20000
    v_and_b32 v2, 15, v1
    v_add_u32 v2, s21, v2
    v_lshlrev_b32 v196, 3, v2
    v_bfe_u32 v3, v1, 4, 1
    v_lshlrev_b32 v3, 1, v3
    v_lshrrev_b32 v4, 5, v1
    v_add_u32 v3, v3, v4
    v_mul_u32_u24 v198, 0x480, v2
    v_lshl_add_u32 v195, v3, 5, v198
    v_lshrrev_b32 v4, 4, v2
    v_mul_u32_u24 v197, 0x4800, v4
    v_and_b32 v4, 15, v2
    v_lshl_add_u32 v197, v4, 4, v197
    v_lshl_add_u32 v194, v3, 9, v197
    v_lshrrev_b32 v3, 4, v1
    v_lshl_add_u32 v197, v3, 3, v197
    v_lshl_add_u32 v198, v3, 3, v198
    s_mul_i32 s18, s11, 0x90
    s_mul_i32 s16, s11, 0x900
    s_add_u32 s17, s16, 0x800
    s_lshl_b32 s19, s11, 14
    buffer_load_dwordx4 v[104:107], v195, s[36:39], s18 offen
    buffer_load_dwordx4 v[108:111], v195, s[36:39], s18 offen offset:16
    buffer_load_dwordx2 v[112:113], v198, s[36:39], s18 offen offset:128
    s_add_u32 s44, s6, 0xd80000
    s_addc_u32 s45, s7, 0
    s_and_b32 s45, s45, 0xffff
    s_mov_b32 s46, 0x51000
    s_mov_b32 s47, 0x20000
    s_lshl_b32 s22, s12, 8
    s_add_u32 s22, s22, s2
    s_cmp_lt_u32 s22, 0x120
    s_cselect_b32 s13, s22, 0
    v_bfe_u32 v2, v1, 4, 1
    s_and_b32 s14, s13, 3
    s_lshl_b32 s14, s14, 1
    v_add_u32 v2, s14, v2
    v_and_b32 v3, 3, v2
    v_lshlrev_b32 v193, 6, v3
    v_lshrrev_b32 v3, 2, v2
    v_lshl_add_u32 v193, v3, 2, v193
    v_and_b32 v3, 7, v1
    v_lshl_add_u32 v193, v3, 3, v193
    v_bfe_u32 v3, v1, 3, 1
    v_lshl_add_u32 v193, v3, 8, v193
    v_lshrrev_b32 v3, 5, v1
    v_mul_u32_u24 v3, 0x2d000, v3
    v_add_u32 v193, v193, v3
    s_lshr_b32 s13, s13, 2
    s_lshl_b32 s13, s13, 9
    buffer_load_dword v188, v193, s[44:47], s13 offen
    s_add_u32 s13, s13, 0x9000
    buffer_load_dword v189, v193, s[44:47], s13 offen
    s_add_u32 s13, s13, 0x9000
    buffer_load_dword v190, v193, s[44:47], s13 offen
    s_add_u32 s13, s13, 0x9000
    buffer_load_dword v191, v193, s[44:47], s13 offen
    s_add_u32 s13, s13, 0x9000
    buffer_load_dword v192, v193, s[44:47], s13 offen
    v_add_u32 v4, 0xb400, v5
    s_waitcnt vmcnt(34)
    s_barrier
    ds_read_b128 v[116:119], v5
    ds_read_b128 v[120:123], v5 offset:1024
    ds_read_b128 v[124:127], v5 offset:2048
    ds_read_b128 v[128:131], v5 offset:3072
    ds_read_b128 v[148:151], v5 offset:8192
    ds_read_b128 v[132:135], v5 offset:4096
    ds_read_b128 v[136:139], v5 offset:5120
    ds_read_b128 v[140:143], v5 offset:6144
    ds_read_b128 v[144:147], v5 offset:7168
    s_waitcnt lgkmcnt(8)
    v_mfma_f32_16x16x32_bf16 v[8:11], v[116:119], v[32:35], 0
    ds_read_b128 v[152:155], v5 offset:9216
    s_waitcnt lgkmcnt(8)
    v_mfma_f32_16x16x32_bf16 v[12:15], v[120:123], v[32:35], 0
    ds_read_b128 v[156:159], v5 offset:10240
    s_waitcnt lgkmcnt(8)
    v_mfma_f32_16x16x32_bf16 v[16:19], v[124:127], v[32:35], 0
    ds_read_b128 v[160:163], v5 offset:11264
    s_waitcnt lgkmcnt(8)
    v_mfma_f32_16x16x32_bf16 v[20:23], v[128:131], v[32:35], 0
    ds_read_b128 v[164:167], v5 offset:12288
    s_waitcnt lgkmcnt(8)
    v_mfma_f32_16x16x32_bf16 v[24:27], v[148:151], v[32:35], 0
    ds_read_b128 v[184:187], v5 offset:17408
    s_waitcnt lgkmcnt(8)
    v_mfma_f32_16x16x32_bf16 v[8:11], v[132:135], v[36:39], v[8:11]
    ds_read_b128 v[168:171], v5 offset:13312
    s_waitcnt lgkmcnt(8)
    v_mfma_f32_16x16x32_bf16 v[12:15], v[136:139], v[36:39], v[12:15]
    ds_read_b128 v[172:175], v5 offset:14336
    s_waitcnt lgkmcnt(8)
    v_mfma_f32_16x16x32_bf16 v[16:19], v[140:143], v[36:39], v[16:19]
    ds_read_b128 v[176:179], v5 offset:15360
    s_waitcnt lgkmcnt(8)
    v_mfma_f32_16x16x32_bf16 v[20:23], v[144:147], v[36:39], v[20:23]
    ds_read_b128 v[180:183], v5 offset:16384
    v_mfma_f32_16x16x32_bf16 v[28:31], v[148:151], v[36:39], 0
    s_waitcnt lgkmcnt(8)
    v_mfma_f32_16x16x32_bf16 v[8:11], v[152:155], v[40:43], v[8:11]
    ds_read_b128 v[116:119], v5 offset:18432
    s_waitcnt lgkmcnt(8)
    v_mfma_f32_16x16x32_bf16 v[12:15], v[156:159], v[40:43], v[12:15]
    ds_read_b128 v[120:123], v5 offset:19456
    s_waitcnt lgkmcnt(8)
    v_mfma_f32_16x16x32_bf16 v[16:19], v[160:163], v[40:43], v[16:19]
    ds_read_b128 v[124:127], v5 offset:20480
    s_waitcnt lgkmcnt(8)
    v_mfma_f32_16x16x32_bf16 v[20:23], v[164:167], v[40:43], v[20:23]
    ds_read_b128 v[128:131], v5 offset:21504
    s_waitcnt lgkmcnt(8)
    v_mfma_f32_16x16x32_bf16 v[24:27], v[184:187], v[40:43], v[24:27]
    ds_read_b128 v[148:151], v5 offset:26624
    s_waitcnt lgkmcnt(8)
    v_mfma_f32_16x16x32_bf16 v[8:11], v[168:171], v[44:47], v[8:11]
    ds_read_b128 v[132:135], v5 offset:22528
    s_waitcnt lgkmcnt(8)
    v_mfma_f32_16x16x32_bf16 v[12:15], v[172:175], v[44:47], v[12:15]
    ds_read_b128 v[136:139], v5 offset:23552
    s_waitcnt lgkmcnt(8)
    v_mfma_f32_16x16x32_bf16 v[16:19], v[176:179], v[44:47], v[16:19]
    ds_read_b128 v[140:143], v5 offset:24576
    s_waitcnt lgkmcnt(8)
    v_mfma_f32_16x16x32_bf16 v[20:23], v[180:183], v[44:47], v[20:23]
    ds_read_b128 v[144:147], v5 offset:25600
    v_mfma_f32_16x16x32_bf16 v[28:31], v[184:187], v[44:47], v[28:31]
    s_waitcnt lgkmcnt(8)
    v_mfma_f32_16x16x32_bf16 v[8:11], v[116:119], v[48:51], v[8:11]
    s_waitcnt lgkmcnt(7)
    v_mfma_f32_16x16x32_bf16 v[12:15], v[120:123], v[48:51], v[12:15]
    s_waitcnt lgkmcnt(6)
    v_mfma_f32_16x16x32_bf16 v[16:19], v[124:127], v[48:51], v[16:19]
    s_waitcnt lgkmcnt(5)
    v_mfma_f32_16x16x32_bf16 v[20:23], v[128:131], v[48:51], v[20:23]
    s_waitcnt lgkmcnt(4)
    v_mfma_f32_16x16x32_bf16 v[24:27], v[148:151], v[48:51], v[24:27]
    s_waitcnt lgkmcnt(3)
    v_mfma_f32_16x16x32_bf16 v[8:11], v[132:135], v[52:55], v[8:11]
    s_waitcnt lgkmcnt(2)
    v_mfma_f32_16x16x32_bf16 v[12:15], v[136:139], v[52:55], v[12:15]
    s_waitcnt lgkmcnt(1)
    v_mfma_f32_16x16x32_bf16 v[16:19], v[140:143], v[52:55], v[16:19]
    s_waitcnt lgkmcnt(0)
    v_mfma_f32_16x16x32_bf16 v[20:23], v[144:147], v[52:55], v[20:23]
    v_mfma_f32_16x16x32_bf16 v[28:31], v[148:151], v[52:55], v[28:31]
    s_waitcnt vmcnt(21)
    s_barrier
    ds_read_b128 v[152:155], v5 offset:27648
    ds_read_b128 v[156:159], v5 offset:28672
    ds_read_b128 v[160:163], v5 offset:29696
    ds_read_b128 v[164:167], v5 offset:30720
    ds_read_b128 v[184:187], v5 offset:35840
    ds_read_b128 v[168:171], v5 offset:31744
    ds_read_b128 v[172:175], v5 offset:32768
    ds_read_b128 v[176:179], v5 offset:33792
    ds_read_b128 v[180:183], v5 offset:34816
    s_waitcnt lgkmcnt(8)
    v_mfma_f32_16x16x32_bf16 v[8:11], v[152:155], v[56:59], v[8:11]
    ds_read_b128 v[116:119], v5 offset:36864
    s_waitcnt lgkmcnt(8)
    v_mfma_f32_16x16x32_bf16 v[12:15], v[156:159], v[56:59], v[12:15]
    ds_read_b128 v[120:123], v5 offset:37888
    s_waitcnt lgkmcnt(8)
    v_mfma_f32_16x16x32_bf16 v[16:19], v[160:163], v[56:59], v[16:19]
    ds_read_b128 v[124:127], v5 offset:38912
    s_waitcnt lgkmcnt(8)
    v_mfma_f32_16x16x32_bf16 v[20:23], v[164:167], v[56:59], v[20:23]
    ds_read_b128 v[128:131], v5 offset:39936
    s_waitcnt lgkmcnt(8)
    v_mfma_f32_16x16x32_bf16 v[24:27], v[184:187], v[56:59], v[24:27]
    ds_read_b128 v[148:151], v5 offset:45056
    s_waitcnt lgkmcnt(8)
    v_mfma_f32_16x16x32_bf16 v[8:11], v[168:171], v[60:63], v[8:11]
    ds_read_b128 v[132:135], v5 offset:40960
    s_waitcnt lgkmcnt(8)
    v_mfma_f32_16x16x32_bf16 v[12:15], v[172:175], v[60:63], v[12:15]
    ds_read_b128 v[136:139], v5 offset:41984
    s_waitcnt lgkmcnt(8)
    v_mfma_f32_16x16x32_bf16 v[16:19], v[176:179], v[60:63], v[16:19]
    ds_read_b128 v[140:143], v5 offset:43008
    s_waitcnt lgkmcnt(8)
    v_mfma_f32_16x16x32_bf16 v[20:23], v[180:183], v[60:63], v[20:23]
    ds_read_b128 v[144:147], v5 offset:44032
    v_mfma_f32_16x16x32_bf16 v[28:31], v[184:187], v[60:63], v[28:31]
    s_waitcnt lgkmcnt(8)
    v_mfma_f32_16x16x32_bf16 v[8:11], v[116:119], v[64:67], v[8:11]
    ds_read_b128 v[152:155], v4
    s_waitcnt lgkmcnt(8)
    v_mfma_f32_16x16x32_bf16 v[12:15], v[120:123], v[64:67], v[12:15]
    ds_read_b128 v[156:159], v4 offset:1024
    s_waitcnt lgkmcnt(8)
    v_mfma_f32_16x16x32_bf16 v[16:19], v[124:127], v[64:67], v[16:19]
    ds_read_b128 v[160:163], v4 offset:2048
    s_waitcnt lgkmcnt(8)
    v_mfma_f32_16x16x32_bf16 v[20:23], v[128:131], v[64:67], v[20:23]
    ds_read_b128 v[164:167], v4 offset:3072
    s_waitcnt lgkmcnt(8)
    v_mfma_f32_16x16x32_bf16 v[24:27], v[148:151], v[64:67], v[24:27]
    ds_read_b128 v[184:187], v4 offset:8192
    s_waitcnt lgkmcnt(8)
    v_mfma_f32_16x16x32_bf16 v[8:11], v[132:135], v[68:71], v[8:11]
    ds_read_b128 v[168:171], v4 offset:4096
    s_waitcnt lgkmcnt(8)
    v_mfma_f32_16x16x32_bf16 v[12:15], v[136:139], v[68:71], v[12:15]
    ds_read_b128 v[172:175], v4 offset:5120
    s_waitcnt lgkmcnt(8)
    v_mfma_f32_16x16x32_bf16 v[16:19], v[140:143], v[68:71], v[16:19]
    ds_read_b128 v[176:179], v4 offset:6144
    s_waitcnt lgkmcnt(8)
    v_mfma_f32_16x16x32_bf16 v[20:23], v[144:147], v[68:71], v[20:23]
    ds_read_b128 v[180:183], v4 offset:7168
    v_mfma_f32_16x16x32_bf16 v[28:31], v[148:151], v[68:71], v[28:31]
    s_waitcnt lgkmcnt(8)
    v_mfma_f32_16x16x32_bf16 v[8:11], v[152:155], v[72:75], v[8:11]
    s_waitcnt lgkmcnt(7)
    v_mfma_f32_16x16x32_bf16 v[12:15], v[156:159], v[72:75], v[12:15]
    s_waitcnt lgkmcnt(6)
    v_mfma_f32_16x16x32_bf16 v[16:19], v[160:163], v[72:75], v[16:19]
    s_waitcnt lgkmcnt(5)
    v_mfma_f32_16x16x32_bf16 v[20:23], v[164:167], v[72:75], v[20:23]
    s_waitcnt lgkmcnt(4)
    v_mfma_f32_16x16x32_bf16 v[24:27], v[184:187], v[72:75], v[24:27]
    s_waitcnt lgkmcnt(3)
    v_mfma_f32_16x16x32_bf16 v[8:11], v[168:171], v[76:79], v[8:11]
    s_waitcnt lgkmcnt(2)
    v_mfma_f32_16x16x32_bf16 v[12:15], v[172:175], v[76:79], v[12:15]
    s_waitcnt lgkmcnt(1)
    v_mfma_f32_16x16x32_bf16 v[16:19], v[176:179], v[76:79], v[16:19]
    s_waitcnt lgkmcnt(0)
    v_mfma_f32_16x16x32_bf16 v[20:23], v[180:183], v[76:79], v[20:23]
    v_mfma_f32_16x16x32_bf16 v[28:31], v[184:187], v[76:79], v[28:31]
    s_waitcnt vmcnt(8)
    s_barrier
    ds_read_b128 v[116:119], v4 offset:9216
    ds_read_b128 v[120:123], v4 offset:10240
    ds_read_b128 v[124:127], v4 offset:11264
    ds_read_b128 v[128:131], v4 offset:12288
    ds_read_b128 v[148:151], v4 offset:17408
    ds_read_b128 v[132:135], v4 offset:13312
    ds_read_b128 v[136:139], v4 offset:14336
    ds_read_b128 v[140:143], v4 offset:15360
    ds_read_b128 v[144:147], v4 offset:16384
    s_waitcnt lgkmcnt(8)
    v_mfma_f32_16x16x32_bf16 v[8:11], v[116:119], v[80:83], v[8:11]
    ds_read_b128 v[152:155], v4 offset:18432
    s_waitcnt lgkmcnt(8)
    v_mfma_f32_16x16x32_bf16 v[12:15], v[120:123], v[80:83], v[12:15]
    ds_read_b128 v[156:159], v4 offset:19456
    s_waitcnt lgkmcnt(8)
    v_mfma_f32_16x16x32_bf16 v[16:19], v[124:127], v[80:83], v[16:19]
    ds_read_b128 v[160:163], v4 offset:20480
    s_waitcnt lgkmcnt(8)
    v_mfma_f32_16x16x32_bf16 v[20:23], v[128:131], v[80:83], v[20:23]
    ds_read_b128 v[164:167], v4 offset:21504
    s_waitcnt lgkmcnt(8)
    v_mfma_f32_16x16x32_bf16 v[24:27], v[148:151], v[80:83], v[24:27]
    ds_read_b128 v[184:187], v4 offset:26624
    s_waitcnt lgkmcnt(8)
    v_mfma_f32_16x16x32_bf16 v[8:11], v[132:135], v[84:87], v[8:11]
    ds_read_b128 v[168:171], v4 offset:22528
    s_waitcnt lgkmcnt(8)
    v_mfma_f32_16x16x32_bf16 v[12:15], v[136:139], v[84:87], v[12:15]
    ds_read_b128 v[172:175], v4 offset:23552
    s_waitcnt lgkmcnt(8)
    v_mfma_f32_16x16x32_bf16 v[16:19], v[140:143], v[84:87], v[16:19]
    ds_read_b128 v[176:179], v4 offset:24576
    s_waitcnt lgkmcnt(8)
    v_mfma_f32_16x16x32_bf16 v[20:23], v[144:147], v[84:87], v[20:23]
    ds_read_b128 v[180:183], v4 offset:25600
    v_mfma_f32_16x16x32_bf16 v[28:31], v[148:151], v[84:87], v[28:31]
    s_waitcnt lgkmcnt(8)
    v_mfma_f32_16x16x32_bf16 v[8:11], v[152:155], v[88:91], v[8:11]
    ds_read_b128 v[116:119], v4 offset:27648
    s_waitcnt lgkmcnt(8)
    v_mfma_f32_16x16x32_bf16 v[12:15], v[156:159], v[88:91], v[12:15]
    ds_read_b128 v[120:123], v4 offset:28672
    s_waitcnt lgkmcnt(8)
    v_mfma_f32_16x16x32_bf16 v[16:19], v[160:163], v[88:91], v[16:19]
    ds_read_b128 v[124:127], v4 offset:29696
    s_waitcnt lgkmcnt(8)
    v_mfma_f32_16x16x32_bf16 v[20:23], v[164:167], v[88:91], v[20:23]
    ds_read_b128 v[128:131], v4 offset:30720
    s_waitcnt lgkmcnt(8)
    v_mfma_f32_16x16x32_bf16 v[24:27], v[184:187], v[88:91], v[24:27]
    ds_read_b128 v[148:151], v4 offset:35840
    s_waitcnt lgkmcnt(8)
    v_mfma_f32_16x16x32_bf16 v[8:11], v[168:171], v[92:95], v[8:11]
    ds_read_b128 v[132:135], v4 offset:31744
    s_waitcnt lgkmcnt(8)
    v_mfma_f32_16x16x32_bf16 v[12:15], v[172:175], v[92:95], v[12:15]
    ds_read_b128 v[136:139], v4 offset:32768
    s_waitcnt lgkmcnt(8)
    v_mfma_f32_16x16x32_bf16 v[16:19], v[176:179], v[92:95], v[16:19]
    ds_read_b128 v[140:143], v4 offset:33792
    s_waitcnt lgkmcnt(8)
    v_mfma_f32_16x16x32_bf16 v[20:23], v[180:183], v[92:95], v[20:23]
    ds_read_b128 v[144:147], v4 offset:34816
    v_mfma_f32_16x16x32_bf16 v[28:31], v[184:187], v[92:95], v[28:31]
    s_waitcnt lgkmcnt(8)
    v_mfma_f32_16x16x32_bf16 v[8:11], v[116:119], v[96:99], v[8:11]
    s_waitcnt lgkmcnt(7)
    v_mfma_f32_16x16x32_bf16 v[12:15], v[120:123], v[96:99], v[12:15]
    s_waitcnt lgkmcnt(6)
    v_mfma_f32_16x16x32_bf16 v[16:19], v[124:127], v[96:99], v[16:19]
    s_waitcnt lgkmcnt(5)
    v_mfma_f32_16x16x32_bf16 v[20:23], v[128:131], v[96:99], v[20:23]
    s_waitcnt lgkmcnt(4)
    v_mfma_f32_16x16x32_bf16 v[24:27], v[148:151], v[96:99], v[24:27]
    s_waitcnt lgkmcnt(3)
    v_mfma_f32_16x16x32_bf16 v[8:11], v[132:135], v[100:103], v[8:11]
    s_waitcnt lgkmcnt(2)
    v_mfma_f32_16x16x32_bf16 v[12:15], v[136:139], v[100:103], v[12:15]
    s_waitcnt lgkmcnt(1)
    v_mfma_f32_16x16x32_bf16 v[16:19], v[140:143], v[100:103], v[16:19]
    s_waitcnt lgkmcnt(0)
    v_mfma_f32_16x16x32_bf16 v[20:23], v[144:147], v[100:103], v[20:23]
    v_mfma_f32_16x16x32_bf16 v[28:31], v[148:151], v[100:103], v[28:31]
    s_waitcnt vmcnt(0)
    v_permlane32_swap_b32 v8, v10
    v_permlane32_swap_b32 v9, v11
    v_lshlrev_b32 v32, 16, v104
    v_and_b32 v33, 0xffff0000, v104
    v_lshlrev_b32 v34, 16, v108
    v_and_b32 v35, 0xffff0000, v108
    v_add_f32 v8, v8, v32
    v_add_f32 v10, v10, v33
    v_add_f32 v9, v9, v34
    v_add_f32 v11, v11, v35
    v_cvt_pk_bf16_f32 v36, v8, v10
    v_cvt_pk_bf16_f32 v40, v9, v11
    v_permlane32_swap_b32 v12, v14
    v_permlane32_swap_b32 v13, v15
    v_lshlrev_b32 v32, 16, v105
    v_and_b32 v33, 0xffff0000, v105
    v_lshlrev_b32 v34, 16, v109
    v_and_b32 v35, 0xffff0000, v109
    v_add_f32 v12, v12, v32
    v_add_f32 v14, v14, v33
    v_add_f32 v13, v13, v34
    v_add_f32 v15, v15, v35
    v_cvt_pk_bf16_f32 v37, v12, v14
    v_cvt_pk_bf16_f32 v41, v13, v15
    v_permlane32_swap_b32 v16, v18
    v_permlane32_swap_b32 v17, v19
    v_lshlrev_b32 v32, 16, v106
    v_and_b32 v33, 0xffff0000, v106
    v_lshlrev_b32 v34, 16, v110
    v_and_b32 v35, 0xffff0000, v110
    v_add_f32 v16, v16, v32
    v_add_f32 v18, v18, v33
    v_add_f32 v17, v17, v34
    v_add_f32 v19, v19, v35
    v_cvt_pk_bf16_f32 v38, v16, v18
    v_cvt_pk_bf16_f32 v42, v17, v19
    v_permlane32_swap_b32 v20, v22
    v_permlane32_swap_b32 v21, v23
    v_lshlrev_b32 v32, 16, v107
    v_and_b32 v33, 0xffff0000, v107
    v_lshlrev_b32 v34, 16, v111
    v_and_b32 v35, 0xffff0000, v111
    v_add_f32 v20, v20, v32
    v_add_f32 v22, v22, v33
    v_add_f32 v21, v21, v34
    v_add_f32 v23, v23, v35
    v_cvt_pk_bf16_f32 v39, v20, v22
    v_cvt_pk_bf16_f32 v43, v21, v23
    buffer_store_dwordx4 v[36:39], v194, s[32:35], s16 offen sc1
    buffer_store_dwordx4 v[40:43], v194, s[32:35], s16 offen offset:256 sc1
    v_permlane32_swap_b32 v28, v52
    v_permlane32_swap_b32 v29, v53
    v_permlane32_swap_b32 v30, v54
    v_permlane32_swap_b32 v31, v55
    v_lshlrev_b32 v32, 16, v112
    v_and_b32 v33, 0xffff0000, v112
    v_lshlrev_b32 v34, 16, v113
    v_and_b32 v35, 0xffff0000, v113
    v_add_f32 v24, v24, v52
    v_add_f32 v24, v24, v32
    v_add_f32 v25, v25, v53
    v_add_f32 v25, v25, v33
    v_add_f32 v26, v26, v54
    v_add_f32 v26, v26, v34
    v_add_f32 v27, v27, v55
    v_add_f32 v27, v27, v35
    v_cvt_pk_bf16_f32 v48, v24, v25
    v_cvt_pk_bf16_f32 v49, v26, v27
    v_lshlrev_b32 v32, 16, v36
    v_and_b32 v33, 0xffff0000, v36
    v_mov_b32 v44, v32
    v_mul_f32 v45, v32, v32
    v_add_f32 v44, v44, v33
    v_fmac_f32 v45, v33, v33
    v_lshlrev_b32 v32, 16, v37
    v_and_b32 v33, 0xffff0000, v37
    v_add_f32 v44, v44, v32
    v_fmac_f32 v45, v32, v32
    v_add_f32 v44, v44, v33
    v_fmac_f32 v45, v33, v33
    v_lshlrev_b32 v32, 16, v38
    v_and_b32 v33, 0xffff0000, v38
    v_add_f32 v44, v44, v32
    v_fmac_f32 v45, v32, v32
    v_add_f32 v44, v44, v33
    v_fmac_f32 v45, v33, v33
    v_lshlrev_b32 v32, 16, v39
    v_and_b32 v33, 0xffff0000, v39
    v_add_f32 v44, v44, v32
    v_fmac_f32 v45, v32, v32
    v_add_f32 v44, v44, v33
    v_fmac_f32 v45, v33, v33
    v_lshlrev_b32 v32, 16, v40
    v_and_b32 v33, 0xffff0000, v40
    v_add_f32 v44, v44, v32
    v_fmac_f32 v45, v32, v32
    v_add_f32 v44, v44, v33
    v_fmac_f32 v45, v33, v33
    v_lshlrev_b32 v32, 16, v41
    v_and_b32 v33, 0xffff0000, v41
    v_add_f32 v44, v44, v32
    v_fmac_f32 v45, v32, v32
    v_add_f32 v44, v44, v33
    v_fmac_f32 v45, v33, v33
    v_lshlrev_b32 v32, 16, v42
    v_and_b32 v33, 0xffff0000, v42
    v_add_f32 v44, v44, v32
    v_fmac_f32 v45, v32, v32
    v_add_f32 v44, v44, v33
    v_fmac_f32 v45, v33, v33
    v_lshlrev_b32 v32, 16, v43
    v_and_b32 v33, 0xffff0000, v43
    v_add_f32 v44, v44, v32
    v_fmac_f32 v45, v32, v32
    v_add_f32 v44, v44, v33
    v_fmac_f32 v45, v33, v33
    s_mov_b32 exec_hi, 0
    buffer_store_dwordx2 v[48:49], v197, s[32:35], s17 offen sc1
    v_lshlrev_b32 v32, 16, v48
    v_and_b32 v33, 0xffff0000, v48
    v_add_f32 v44, v44, v32
    v_fmac_f32 v45, v32, v32
    v_add_f32 v44, v44, v33
    v_fmac_f32 v45, v33, v33
    v_lshlrev_b32 v32, 16, v49
    v_and_b32 v33, 0xffff0000, v49
    v_add_f32 v44, v44, v32
    v_fmac_f32 v45, v32, v32
    v_add_f32 v44, v44, v33
    v_fmac_f32 v45, v33, v33
    s_mov_b32 exec_hi, -1
    v_mov_b32 v46, v44
    v_mov_b32 v47, v45
    s_nop 0
    v_permlane32_swap_b32 v44, v46
    v_permlane32_swap_b32 v45, v47
    v_add_f32 v44, v44, v46
    v_add_f32 v45, v45, v47
    v_mov_b32 v46, v44
    v_mov_b32 v47, v45
    s_nop 0
    v_permlane16_swap_b32 v44, v46
    v_permlane16_swap_b32 v45, v47
    v_add_f32 v44, v44, v46
    v_add_f32 v45, v45, v47
    s_mov_b64 exec, 0xffff
    buffer_store_dwordx2 v[44:45], v196, s[40:43], s19 offen
    s_mov_b64 exec, -1
    s_cmp_ge_u32 s22, 0x120
    s_cbranch_scc1 L_wo_fin
    s_add_u32 s44, s6, 0xd40000
    s_addc_u32 s45, s7, 0
    s_and_b32 s45, s45, 0xffff
    s_mov_b32 s46, 0x24000
    s_mov_b32 s47, 0x20000
    v_add_f32 v188, v188, v189
    v_add_f32 v190, v190, v191
    v_add_f32 v188, v188, v192
    v_add_f32 v188, v188, v190
    v_cvt_pk_bf16_f32 v56, v188, v188
    v_lshlrev_b32 v189, 16, v56
    v_sub_f32 v189, v188, v189
    v_cvt_pk_bf16_f32 v57, v189, v189
    v_lshlrev_b32 v193, 3, v1
    s_lshl_b32 s13, s22, 9
    buffer_store_dwordx2 v[56:57], v193, s[44:47], s13 offen
L_wo_fin:
L_wo_end:
    s_endpgm
.text
.globl ffn_kernel
.p2align 8
.type ffn_kernel,@function
ffn_kernel:
    s_cmp_ge_u32 s2, 0x100
    s_cbranch_scc1 L_ff_end
    s_load_dwordx2 s[4:5], s[0:1], 0x48
    s_load_dwordx2 s[6:7], s[0:1], 56
    s_and_b32 s8, s2, 7
    s_lshr_b32 s9, s2, 3
    s_and_b32 s10, s8, 1
    s_lshl_b32 s10, s10, 2
    s_and_b32 s13, s9, 3
    s_add_u32 s10, s10, s13
    s_lshr_b32 s11, s8, 1
    s_lshr_b32 s9, s9, 2
    v_lshrrev_b32 v247, 6, v0
    v_and_b32 v249, 63, v0
    v_readfirstlane_b32 s12, v247
    v_lshlrev_b32 v1, 4, v249
    s_lshl_b32 s14, s10, 3
    s_add_u32 s14, s14, s12
    s_lshl_b32 s17, s12, 10
    s_lshl_b32 s18, s12, 9
    s_add_u32 s18, s18, 0x8000
    s_mul_i32 s27, s11, 0x48
    s_lshl_b32 s13, s9, 2
    s_add_u32 s25, s27, s13
    s_mul_i32 s19, s25, 0x9000
    s_add_u32 s22, s19, s18
    s_add_u32 s19, s19, s17
    s_mul_i32 s15, s14, 0x9000
    s_waitcnt lgkmcnt(0)
    s_add_u32 s32, s4, 0x2400000
    s_addc_u32 s33, s5, 0
    s_and_b32 s33, s33, 0xffff
    s_mov_b32 s34, 0xa20000
    s_mov_b32 s35, 0x20000
    s_add_u32 s36, s4, 0xa80000
    s_addc_u32 s37, s5, 0
    s_and_b32 s37, s37, 0xffff
    s_mov_b32 s38, 0x240000
    s_mov_b32 s39, 0x20000
    s_add_u32 m0, s17, 0
    s_add_u32 s13, s19, 0
    buffer_load_dwordx4 v1, s[32:35], s13 offen lds
    s_add_u32 s13, s15, 0
    buffer_load_dwordx4 v[66:69], v1, s[36:39], s13 offen
    s_add_u32 m0, s17, 0x9000
    s_add_u32 s13, s19, 0x9000
    buffer_load_dwordx4 v1, s[32:35], s13 offen lds
    s_add_u32 s13, s15, 0x4800
    buffer_load_dwordx4 v[70:73], v1, s[36:39], s13 offen
    s_add_u32 m0, s17, 0x12000
    s_add_u32 s13, s19, 0x12000
    buffer_load_dwordx4 v1, s[32:35], s13 offen lds
    s_add_u32 m0, s17, 0x1b000
    s_add_u32 s13, s19, 0x1b000
    buffer_load_dwordx4 v1, s[32:35], s13 offen lds
    s_barrier
    s_add_u32 s13, s15, 0
    buffer_load_dwordx4 v[74:77], v1, s[36:39], s13 offen offset:1024
    s_add_u32 s13, s15, 0x4800
    buffer_load_dwordx4 v[78:81], v1, s[36:39], s13 offen offset:1024
    s_add_u32 s13, s15, 0
    buffer_load_dwordx4 v[82:85], v1, s[36:39], s13 offen offset:2048
    s_add_u32 s13, s15, 0x4800
    buffer_load_dwordx4 v[86:89], v1, s[36:39], s13 offen offset:2048
    v_add_u32 v252, 0x10000, v1
    v_add_u32 v253, 0x20000, v1
    v_and_b32 v247, 31, v249
    v_lshlrev_b32 v246, 3, v247
    v_lshrrev_b32 v247, 5, v249
    v_lshl_add_u32 v246, v247, 16, v246
    v_mul_u32_u24 v254, 0x24000, v247
    v_and_b32 v247, 31, v249
    v_lshl_add_u32 v254, v247, 4, v254
    v_bfe_u32 v247, v249, 3, 2
    v_lshlrev_b32 v255, 7, v247
    v_and_b32 v247, 7, v249
    v_lshl_add_u32 v255, v247, 3, v255
    s_mul_i32 s13, s9, 3
    s_add_u32 s26, s27, s13
    s_add_u32 s26, s26, 32
    s_lshl_b32 s13, s9, 1
    s_add_u32 s27, s27, s13
    s_add_u32 s27, s27, 56
    s_mul_i32 s52, s14, 0x48000
    s_lshl_b32 s25, s25, 9
    s_add_u32 s28, s52, s25
    s_mul_i32 s20, s26, 0x9000
    s_add_u32 s23, s20, s18
    s_add_u32 s20, s20, s17
    s_lshl_b32 s26, s26, 9
    s_add_u32 s29, s52, s26
    s_mul_i32 s21, s27, 0x9000
    s_add_u32 s24, s21, s18
    s_add_u32 s21, s21, s17
    s_lshl_b32 s27, s27, 9
    s_add_u32 s30, s52, s27
    s_lshl_b32 s16, s14, 8
    s_add_u32 s40, s4, 0xd40000
    s_addc_u32 s41, s5, 0
    s_and_b32 s41, s41, 0xffff
    s_mov_b32 s42, 0x24000
    s_mov_b32 s43, 0x20000
    s_add_u32 s44, s4, 0xd00000
    s_addc_u32 s45, s5, 0
    s_and_b32 s45, s45, 0xffff
    s_mov_b32 s46, 0x20000
    s_mov_b32 s47, 0x20000
    s_add_u32 s48, s4, 0x1000000
    s_addc_u32 s49, s5, 0
    s_and_b32 s49, s49, 0xffff
    s_mov_b32 s50, 0x1200000
    s_mov_b32 s51, 0x20000
    s_add_u32 m0, s17, 0x2000
    s_add_u32 s13, s19, 0x2000
    buffer_load_dwordx4 v1, s[32:35], s13 offen lds
    s_waitcnt vmcnt(5)
    s_barrier
    ds_read_b128 v[210:213], v1
    ds_read_b128 v[214:217], v1 offset:36864
    ds_read_b128 v[218:221], v252 offset:8192
    s_waitcnt lgkmcnt(2)
    v_mfma_f32_16x16x32_bf16 v[2:5], v[210:213], v[66:69], 0
    ds_read_b128 v[222:225], v252 offset:45056
    s_add_u32 s13, s15, 0
    buffer_load_dwordx4 v[90:93], v1, s[36:39], s13 offen offset:3072
    v_mfma_f32_16x16x32_bf16 v[6:9], v[210:213], v[70:73], 0
    s_waitcnt lgkmcnt(2)
    v_mfma_f32_16x16x32_bf16 v[18:21], v[214:217], v[66:69], 0
    ds_read_b128 v[210:213], v1 offset:1024
    s_add_u32 s13, s15, 0x4800
    buffer_load_dwordx4 v[94:97], v1, s[36:39], s13 offen offset:3072
    v_mfma_f32_16x16x32_bf16 v[22:25], v[214:217], v[70:73], 0
    s_waitcnt lgkmcnt(2)
    v_mfma_f32_16x16x32_bf16 v[34:37], v[218:221], v[66:69], 0
    ds_read_b128 v[214:217], v1 offset:37888
    s_add_u32 m0, s17, 0xb000
    s_add_u32 s13, s19, 0xb000
    buffer_load_dwordx4 v1, s[32:35], s13 offen lds
    v_mfma_f32_16x16x32_bf16 v[38:41], v[218:221], v[70:73], 0
    s_waitcnt lgkmcnt(2)
    v_mfma_f32_16x16x32_bf16 v[50:53], v[222:225], v[66:69], 0
    ds_read_b128 v[218:221], v252 offset:9216
    s_add_u32 m0, s17, 0x14000
    s_add_u32 s13, s19, 0x14000
    buffer_load_dwordx4 v1, s[32:35], s13 offen lds
    v_mfma_f32_16x16x32_bf16 v[54:57], v[222:225], v[70:73], 0
    s_waitcnt lgkmcnt(2)
    v_mfma_f32_16x16x32_bf16 v[10:13], v[210:213], v[66:69], 0
    ds_read_b128 v[222:225], v252 offset:46080
    buffer_load_dwordx2 v[226:227], v246, s[44:47], s16 offen
    v_mfma_f32_16x16x32_bf16 v[14:17], v[210:213], v[70:73], 0
    s_waitcnt lgkmcnt(2)
    v_mfma_f32_16x16x32_bf16 v[26:29], v[214:217], v[66:69], 0
    ds_read_b128 v[210:213], v1 offset:2048
    s_add_u32 s16, s16, 0x4000
    buffer_load_dwordx2 v[228:229], v246, s[44:47], s16 offen
    v_mfma_f32_16x16x32_bf16 v[30:33], v[214:217], v[70:73], 0
    s_waitcnt lgkmcnt(2)
    v_mfma_f32_16x16x32_bf16 v[42:45], v[218:221], v[66:69], 0
    ds_read_b128 v[214:217], v1 offset:38912
    s_add_u32 s16, s16, 0x4000
    buffer_load_dwordx2 v[230:231], v246, s[44:47], s16 offen
    v_mfma_f32_16x16x32_bf16 v[46:49], v[218:221], v[70:73], 0
    s_waitcnt lgkmcnt(2)
    v_mfma_f32_16x16x32_bf16 v[58:61], v[222:225], v[66:69], 0
    ds_read_b128 v[218:221], v252 offset:10240
    s_add_u32 s16, s16, 0x4000
    buffer_load_dwordx2 v[232:233], v246, s[44:47], s16 offen
    v_mfma_f32_16x16x32_bf16 v[62:65], v[222:225], v[70:73], 0
    s_waitcnt vmcnt(12) lgkmcnt(2)
    v_mfma_f32_16x16x32_bf16 v[2:5], v[210:213], v[74:77], v[2:5]
    ds_read_b128 v[222:225], v252 offset:47104
    s_add_u32 m0, s17, 0x1d000
    s_add_u32 s13, s19, 0x1d000
    buffer_load_dwordx4 v1, s[32:35], s13 offen lds
    s_waitcnt vmcnt(12)
    v_mfma_f32_16x16x32_bf16 v[6:9], v[210:213], v[78:81], v[6:9]
    s_waitcnt lgkmcnt(2)
    v_mfma_f32_16x16x32_bf16 v[18:21], v[214:217], v[74:77], v[18:21]
    ds_read_b128 v[210:213], v1 offset:3072
    s_add_u32 s13, s15, 0x1000
    buffer_load_dwordx4 v[98:101], v1, s[36:39], s13 offen
    v_mfma_f32_16x16x32_bf16 v[22:25], v[214:217], v[78:81], v[22:25]
    s_waitcnt lgkmcnt(2)
    v_mfma_f32_16x16x32_bf16 v[34:37], v[218:221], v[74:77], v[34:37]
    ds_read_b128 v[214:217], v1 offset:39936
    s_add_u32 s13, s15, 0x5800
    buffer_load_dwordx4 v[102:105], v1, s[36:39], s13 offen
    v_mfma_f32_16x16x32_bf16 v[38:41], v[218:221], v[78:81], v[38:41]
    s_waitcnt lgkmcnt(2)
    v_mfma_f32_16x16x32_bf16 v[50:53], v[222:225], v[74:77], v[50:53]
    ds_read_b128 v[218:221], v252 offset:11264
    v_mfma_f32_16x16x32_bf16 v[54:57], v[222:225], v[78:81], v[54:57]
    s_waitcnt lgkmcnt(2)
    v_mfma_f32_16x16x32_bf16 v[10:13], v[210:213], v[74:77], v[10:13]
    ds_read_b128 v[222:225], v252 offset:48128
    v_mfma_f32_16x16x32_bf16 v[14:17], v[210:213], v[78:81], v[14:17]
    s_waitcnt lgkmcnt(2)
    v_mfma_f32_16x16x32_bf16 v[26:29], v[214:217], v[74:77], v[26:29]
    ds_read_b128 v[210:213], v1 offset:4096
    v_mfma_f32_16x16x32_bf16 v[30:33], v[214:217], v[78:81], v[30:33]
    s_waitcnt lgkmcnt(2)
    v_mfma_f32_16x16x32_bf16 v[42:45], v[218:221], v[74:77], v[42:45]
    ds_read_b128 v[214:217], v1 offset:40960
    s_waitcnt vmcnt(3)
    v_mfma_f32_16x16x32_bf16 v[46:49], v[218:221], v[78:81], v[46:49]
    s_waitcnt lgkmcnt(2)
    v_mfma_f32_16x16x32_bf16 v[58:61], v[222:225], v[74:77], v[58:61]
    ds_read_b128 v[218:221], v252 offset:12288
    v_add_f32 v226, v226, v230
    v_mfma_f32_16x16x32_bf16 v[62:65], v[222:225], v[78:81], v[62:65]
    s_waitcnt lgkmcnt(2)
    v_mfma_f32_16x16x32_bf16 v[2:5], v[210:213], v[82:85], v[2:5]
    ds_read_b128 v[222:225], v252 offset:49152
    s_add_u32 s13, s15, 0x1000
    buffer_load_dwordx4 v[106:109], v1, s[36:39], s13 offen offset:1024
    v_add_f32 v227, v227, v231
    v_mfma_f32_16x16x32_bf16 v[6:9], v[210:213], v[86:89], v[6:9]
    s_waitcnt lgkmcnt(2)
    v_mfma_f32_16x16x32_bf16 v[18:21], v[214:217], v[82:85], v[18:21]
    ds_read_b128 v[210:213], v1 offset:5120
    s_add_u32 s13, s15, 0x5800
    buffer_load_dwordx4 v[110:113], v1, s[36:39], s13 offen offset:1024
    v_add_f32 v228, v228, v232
    v_mfma_f32_16x16x32_bf16 v[22:25], v[214:217], v[86:89], v[22:25]
    s_waitcnt lgkmcnt(2)
    v_mfma_f32_16x16x32_bf16 v[34:37], v[218:221], v[82:85], v[34:37]
    ds_read_b128 v[214:217], v1 offset:41984
    v_add_f32 v229, v229, v233
    v_mfma_f32_16x16x32_bf16 v[38:41], v[218:221], v[86:89], v[38:41]
    s_waitcnt lgkmcnt(2)
    v_mfma_f32_16x16x32_bf16 v[50:53], v[222:225], v[82:85], v[50:53]
    ds_read_b128 v[218:221], v252 offset:13312
    v_add_f32 v226, v226, v228
    v_mfma_f32_16x16x32_bf16 v[54:57], v[222:225], v[86:89], v[54:57]
    s_waitcnt lgkmcnt(2)
    v_mfma_f32_16x16x32_bf16 v[10:13], v[210:213], v[82:85], v[10:13]
    ds_read_b128 v[222:225], v252 offset:50176
    v_add_f32 v227, v227, v229
    v_mfma_f32_16x16x32_bf16 v[14:17], v[210:213], v[86:89], v[14:17]
    s_waitcnt lgkmcnt(2)
    v_mfma_f32_16x16x32_bf16 v[26:29], v[214:217], v[82:85], v[26:29]
    ds_read_b128 v[210:213], v1 offset:6144
    v_mov_b32 v228, v226
    v_mfma_f32_16x16x32_bf16 v[30:33], v[214:217], v[86:89], v[30:33]
    s_waitcnt lgkmcnt(2)
    v_mfma_f32_16x16x32_bf16 v[42:45], v[218:221], v[82:85], v[42:45]
    ds_read_b128 v[214:217], v1 offset:43008
    v_mov_b32 v229, v227
    v_mfma_f32_16x16x32_bf16 v[46:49], v[218:221], v[86:89], v[46:49]
    s_waitcnt lgkmcnt(2)
    v_mfma_f32_16x16x32_bf16 v[58:61], v[222:225], v[82:85], v[58:61]
    ds_read_b128 v[218:221], v252 offset:14336
    v_permlane32_swap_b32 v226, v228
    v_mfma_f32_16x16x32_bf16 v[62:65], v[222:225], v[86:89], v[62:65]
    s_waitcnt lgkmcnt(2)
    v_mfma_f32_16x16x32_bf16 v[2:5], v[210:213], v[90:93], v[2:5]
    ds_read_b128 v[222:225], v252 offset:51200
    s_add_u32 s13, s15, 0x1000
    buffer_load_dwordx4 v[114:117], v1, s[36:39], s13 offen offset:2048
    v_permlane32_swap_b32 v227, v229
    v_mfma_f32_16x16x32_bf16 v[6:9], v[210:213], v[94:97], v[6:9]
    s_waitcnt lgkmcnt(2)
    v_mfma_f32_16x16x32_bf16 v[18:21], v[214:217], v[90:93], v[18:21]
    ds_read_b128 v[210:213], v1 offset:7168
    s_add_u32 s13, s15, 0x5800
    buffer_load_dwordx4 v[118:121], v1, s[36:39], s13 offen offset:2048
    v_add_f32 v226, v226, v228
    v_mfma_f32_16x16x32_bf16 v[22:25], v[214:217], v[94:97], v[22:25]
    s_waitcnt lgkmcnt(2)
    v_mfma_f32_16x16x32_bf16 v[34:37], v[218:221], v[90:93], v[34:37]
    ds_read_b128 v[214:217], v1 offset:44032
    v_add_f32 v227, v227, v229
    v_mfma_f32_16x16x32_bf16 v[38:41], v[218:221], v[94:97], v[38:41]
    s_waitcnt lgkmcnt(2)
    v_mfma_f32_16x16x32_bf16 v[50:53], v[222:225], v[90:93], v[50:53]
    ds_read_b128 v[218:221], v252 offset:15360
    v_mul_f32 v226, 0xbae38e39, v226
    v_mfma_f32_16x16x32_bf16 v[54:57], v[222:225], v[94:97], v[54:57]
    s_waitcnt vmcnt(6)
    s_barrier
    s_waitcnt lgkmcnt(2)
    v_mfma_f32_16x16x32_bf16 v[10:13], v[210:213], v[90:93], v[10:13]
    ds_read_b128 v[222:225], v252 offset:52224
    v_mul_f32 v227, 0x3ae38e39, v227
    v_mfma_f32_16x16x32_bf16 v[14:17], v[210:213], v[94:97], v[14:17]
    s_waitcnt lgkmcnt(2)
    v_mfma_f32_16x16x32_bf16 v[26:29], v[214:217], v[90:93], v[26:29]
    ds_read_b128 v[210:213], v1 offset:8192
    v_fma_f32 v227, -v226, v226, v227
    v_mfma_f32_16x16x32_bf16 v[30:33], v[214:217], v[94:97], v[30:33]
    s_waitcnt lgkmcnt(2)
    v_mfma_f32_16x16x32_bf16 v[42:45], v[218:221], v[90:93], v[42:45]
    ds_read_b128 v[214:217], v1 offset:45056
    s_add_u32 m0, s17, 0x4000
    s_add_u32 s13, s19, 0x4000
    buffer_load_dwordx4 v1, s[32:35], s13 offen lds
    v_max_f32 v227, 0, v227
    v_mfma_f32_16x16x32_bf16 v[46:49], v[218:221], v[94:97], v[46:49]
    s_waitcnt lgkmcnt(2)
    v_mfma_f32_16x16x32_bf16 v[58:61], v[222:225], v[90:93], v[58:61]
    ds_read_b128 v[218:221], v252 offset:16384
    v_add_f32 v250, 0x3727c5ac, v227
    v_mfma_f32_16x16x32_bf16 v[62:65], v[222:225], v[94:97], v[62:65]
    s_waitcnt vmcnt(6) lgkmcnt(2)
    v_mfma_f32_16x16x32_bf16 v[2:5], v[210:213], v[98:101], v[2:5]
    ds_read_b128 v[222:225], v252 offset:53248
    s_add_u32 s13, s15, 0x1000
    buffer_load_dwordx4 v[122:125], v1, s[36:39], s13 offen offset:3072
    v_rsq_f32 v228, v250
    buffer_load_dwordx2 v[234:235], v255, s[40:43], s25 offen
    buffer_load_dwordx2 v[236:237], v255, s[40:43], s25 offen offset:64
    s_waitcnt vmcnt(8)
    v_mfma_f32_16x16x32_bf16 v[6:9], v[210:213], v[102:105], v[6:9]
    s_waitcnt lgkmcnt(2)
    v_mfma_f32_16x16x32_bf16 v[18:21], v[214:217], v[98:101], v[18:21]
    ds_read_b128 v[210:213], v1 offset:9216
    s_add_u32 s13, s15, 0x5800
    buffer_load_dwordx4 v[126:129], v1, s[36:39], s13 offen offset:3072
    v_cvt_pk_bf16_f32 v229, v226, v226
    v_mfma_f32_16x16x32_bf16 v[22:25], v[214:217], v[102:105], v[22:25]
    s_waitcnt lgkmcnt(2)
    v_mfma_f32_16x16x32_bf16 v[34:37], v[218:221], v[98:101], v[34:37]
    ds_read_b128 v[214:217], v1 offset:46080
    s_add_u32 m0, s17, 0xd000
    s_add_u32 s13, s19, 0xd000
    buffer_load_dwordx4 v1, s[32:35], s13 offen lds
    v_lshlrev_b32 v229, 16, v229
    buffer_load_dwordx2 v[238:239], v255, s[40:43], s25 offen offset:512
    buffer_load_dwordx2 v[240:241], v255, s[40:43], s25 offen offset:576
    v_mfma_f32_16x16x32_bf16 v[38:41], v[218:221], v[102:105], v[38:41]
    s_waitcnt lgkmcnt(2)
    v_mfma_f32_16x16x32_bf16 v[50:53], v[222:225], v[98:101], v[50:53]
    ds_read_b128 v[218:221], v252 offset:17408
    s_add_u32 m0, s17, 0x16000
    s_add_u32 s13, s19, 0x16000
    buffer_load_dwordx4 v1, s[32:35], s13 offen lds
    v_sub_f32 v230, v226, v229
    v_mfma_f32_16x16x32_bf16 v[54:57], v[222:225], v[102:105], v[54:57]
    s_waitcnt lgkmcnt(2)
    v_mfma_f32_16x16x32_bf16 v[10:13], v[210:213], v[98:101], v[10:13]
    ds_read_b128 v[222:225], v252 offset:54272
    s_add_u32 m0, s17, 0x1f000
    s_add_u32 s13, s19, 0x1f000
    buffer_load_dwordx4 v1, s[32:35], s13 offen lds
    v_cvt_pk_bf16_f32 v242, v229, v230
    v_mfma_f32_16x16x32_bf16 v[14:17], v[210:213], v[102:105], v[14:17]
    s_waitcnt lgkmcnt(2)
    v_mfma_f32_16x16x32_bf16 v[26:29], v[214:217], v[98:101], v[26:29]
    ds_read_b128 v[210:213], v1 offset:10240
    v_mul_f32 v246, 0xc0135761, v228
    v_mfma_f32_16x16x32_bf16 v[30:33], v[214:217], v[102:105], v[30:33]
    s_waitcnt lgkmcnt(2)
    v_mfma_f32_16x16x32_bf16 v[42:45], v[218:221], v[98:101], v[42:45]
    ds_read_b128 v[214:217], v1 offset:47104
    v_mul_f32 v248, v228, v228
    v_mfma_f32_16x16x32_bf16 v[46:49], v[218:221], v[102:105], v[46:49]
    s_waitcnt lgkmcnt(2)
    v_mfma_f32_16x16x32_bf16 v[58:61], v[222:225], v[98:101], v[58:61]
    ds_read_b128 v[218:221], v252 offset:18432
    v_mul_f32 v248, v248, v228
    v_mfma_f32_16x16x32_bf16 v[62:65], v[222:225], v[102:105], v[62:65]
    s_waitcnt vmcnt(13) lgkmcnt(2)
    v_mfma_f32_16x16x32_bf16 v[2:5], v[210:213], v[106:109], v[2:5]
    ds_read_b128 v[222:225], v252 offset:55296
    s_add_u32 s13, s15, 0x2000
    buffer_load_dwordx4 v[130:133], v1, s[36:39], s13 offen
    v_mul_f32 v248, 0xbdd2d3e8, v248
    s_waitcnt vmcnt(13)
    v_mfma_f32_16x16x32_bf16 v[6:9], v[210:213], v[110:113], v[6:9]
    s_waitcnt lgkmcnt(2)
    v_mfma_f32_16x16x32_bf16 v[18:21], v[214:217], v[106:109], v[18:21]
    ds_read_b128 v[210:213], v1 offset:11264
    s_add_u32 s13, s15, 0x6800
    buffer_load_dwordx4 v[134:137], v1, s[36:39], s13 offen
    v_mov_b32 v251, v250
    v_mfma_f32_16x16x32_bf16 v[22:25], v[214:217], v[110:113], v[22:25]
    s_waitcnt lgkmcnt(2)
    v_mfma_f32_16x16x32_bf16 v[34:37], v[218:221], v[106:109], v[34:37]
    ds_read_b128 v[214:217], v1 offset:48128
    v_mov_b32 v244, v242
    v_mfma_f32_16x16x32_bf16 v[38:41], v[218:221], v[110:113], v[38:41]
    s_waitcnt lgkmcnt(2)
    v_mfma_f32_16x16x32_bf16 v[50:53], v[222:225], v[106:109], v[50:53]
    ds_read_b128 v[218:221], v252 offset:19456
    v_mov_b32 v247, v246
    v_mfma_f32_16x16x32_bf16 v[54:57], v[222:225], v[110:113], v[54:57]
    s_waitcnt lgkmcnt(2)
    v_mfma_f32_16x16x32_bf16 v[10:13], v[210:213], v[106:109], v[10:13]
    ds_read_b128 v[222:225], v252 offset:56320
    v_mov_b32 v249, v248
    v_mfma_f32_16x16x32_bf16 v[14:17], v[210:213], v[110:113], v[14:17]
    s_waitcnt lgkmcnt(2)
    v_mfma_f32_16x16x32_bf16 v[26:29], v[214:217], v[106:109], v[26:29]
    ds_read_b128 v[210:213], v1 offset:12288
    v_permlane16_swap_b32 v250, v251
    v_mfma_f32_16x16x32_bf16 v[30:33], v[214:217], v[110:113], v[30:33]
    s_waitcnt lgkmcnt(2)
    v_mfma_f32_16x16x32_bf16 v[42:45], v[218:221], v[106:109], v[42:45]
    ds_read_b128 v[214:217], v1 offset:49152
    v_permlane16_swap_b32 v242, v244
    v_mfma_f32_16x16x32_bf16 v[46:49], v[218:221], v[110:113], v[46:49]
    s_waitcnt lgkmcnt(2)
    v_mfma_f32_16x16x32_bf16 v[58:61], v[222:225], v[106:109], v[58:61]
    ds_read_b128 v[218:221], v252 offset:20480
    v_permlane16_swap_b32 v246, v247
    v_mfma_f32_16x16x32_bf16 v[62:65], v[222:225], v[110:113], v[62:65]
    s_waitcnt vmcnt(13) lgkmcnt(2)
    v_mfma_f32_16x16x32_bf16 v[2:5], v[210:213], v[114:117], v[2:5]
    ds_read_b128 v[222:225], v252 offset:57344
    s_add_u32 s13, s15, 0x2000
    buffer_load_dwordx4 v[138:141], v1, s[36:39], s13 offen offset:1024
    v_permlane16_swap_b32 v248, v249
    s_waitcnt vmcnt(13)
    v_mfma_f32_16x16x32_bf16 v[6:9], v[210:213], v[118:121], v[6:9]
    s_waitcnt lgkmcnt(2)
    v_mfma_f32_16x16x32_bf16 v[18:21], v[214:217], v[114:117], v[18:21]
    ds_read_b128 v[210:213], v1 offset:13312
    s_add_u32 s13, s15, 0x6800
    buffer_load_dwordx4 v[142:145], v1, s[36:39], s13 offen offset:1024
    s_mov_b32 exec_lo, 0
    v_mov_b32 v242, 0
    v_mov_b32 v244, 0
    s_mov_b32 exec_lo, -1
    v_mfma_f32_16x16x32_bf16 v[22:25], v[214:217], v[118:121], v[22:25]
    s_waitcnt lgkmcnt(2)
    v_mfma_f32_16x16x32_bf16 v[34:37], v[218:221], v[114:117], v[34:37]
    ds_read_b128 v[214:217], v1 offset:50176
    v_mov_b32 v243, v242
    v_mfma_f32_16x16x32_bf16 v[38:41], v[218:221], v[118:121], v[38:41]
    s_waitcnt lgkmcnt(2)
    v_mfma_f32_16x16x32_bf16 v[50:53], v[222:225], v[114:117], v[50:53]
    ds_read_b128 v[218:221], v252 offset:21504
    v_mov_b32 v245, v244
    v_mfma_f32_16x16x32_bf16 v[54:57], v[222:225], v[118:121], v[54:57]
    s_waitcnt lgkmcnt(2)
    v_mfma_f32_16x16x32_bf16 v[10:13], v[210:213], v[114:117], v[10:13]
    ds_read_b128 v[222:225], v252 offset:58368
    v_mfma_f32_16x16x32_bf16 v[14:17], v[210:213], v[118:121], v[14:17]
    s_waitcnt lgkmcnt(2)
    v_mfma_f32_16x16x32_bf16 v[26:29], v[214:217], v[114:117], v[26:29]
    ds_read_b128 v[210:213], v1 offset:14336
    v_mfma_f32_16x16x32_bf16 v[30:33], v[214:217], v[118:121], v[30:33]
    s_waitcnt lgkmcnt(2)
    v_mfma_f32_16x16x32_bf16 v[42:45], v[218:221], v[114:117], v[42:45]
    ds_read_b128 v[214:217], v1 offset:51200
    s_waitcnt vmcnt(10)
    v_mfma_f32_16x16x16_bf16 v[2:5], v[234:235], v[242:243], v[2:5]
    v_mfma_f32_16x16x16_bf16 v[6:9], v[234:235], v[244:245], v[6:9]
    v_mfma_f32_16x16x16_bf16 v[10:13], v[236:237], v[242:243], v[10:13]
    v_mfma_f32_16x16x16_bf16 v[14:17], v[236:237], v[244:245], v[14:17]
    v_mfma_f32_16x16x32_bf16 v[46:49], v[218:221], v[118:121], v[46:49]
    s_waitcnt lgkmcnt(2)
    v_mfma_f32_16x16x32_bf16 v[58:61], v[222:225], v[114:117], v[58:61]
    ds_read_b128 v[218:221], v252 offset:22528
    v_mfma_f32_16x16x32_bf16 v[62:65], v[222:225], v[118:121], v[62:65]
    s_waitcnt lgkmcnt(2)
    v_mfma_f32_16x16x32_bf16 v[2:5], v[210:213], v[122:125], v[2:5]
    ds_read_b128 v[222:225], v252 offset:59392
    s_add_u32 s13, s15, 0x2000
    buffer_load_dwordx4 v[146:149], v1, s[36:39], s13 offen offset:2048
    s_waitcnt vmcnt(10)
    v_mfma_f32_16x16x32_bf16 v[6:9], v[210:213], v[126:129], v[6:9]
    s_waitcnt lgkmcnt(2)
    v_mfma_f32_16x16x32_bf16 v[18:21], v[214:217], v[122:125], v[18:21]
    ds_read_b128 v[210:213], v1 offset:15360
    s_add_u32 s13, s15, 0x6800
    buffer_load_dwordx4 v[150:153], v1, s[36:39], s13 offen offset:2048
    v_mfma_f32_16x16x32_bf16 v[22:25], v[214:217], v[126:129], v[22:25]
    s_waitcnt lgkmcnt(2)
    v_mfma_f32_16x16x32_bf16 v[34:37], v[218:221], v[122:125], v[34:37]
    ds_read_b128 v[214:217], v1 offset:52224
    v_mfma_f32_16x16x32_bf16 v[38:41], v[218:221], v[126:129], v[38:41]
    s_waitcnt lgkmcnt(2)
    v_mfma_f32_16x16x32_bf16 v[50:53], v[222:225], v[122:125], v[50:53]
    ds_read_b128 v[218:221], v252 offset:23552
    s_waitcnt vmcnt(8)
    v_mfma_f32_16x16x16_bf16 v[18:21], v[238:239], v[242:243], v[18:21]
    v_mfma_f32_16x16x16_bf16 v[22:25], v[238:239], v[244:245], v[22:25]
    v_mfma_f32_16x16x16_bf16 v[26:29], v[240:241], v[242:243], v[26:29]
    v_mfma_f32_16x16x16_bf16 v[30:33], v[240:241], v[244:245], v[30:33]
    v_mfma_f32_16x16x32_bf16 v[54:57], v[222:225], v[126:129], v[54:57]
    s_waitcnt vmcnt(6)
    s_barrier
    s_waitcnt lgkmcnt(2)
    v_mfma_f32_16x16x32_bf16 v[10:13], v[210:213], v[122:125], v[10:13]
    ds_read_b128 v[222:225], v252 offset:60416
    buffer_load_dwordx2 v[234:235], v255, s[40:43], s25 offen offset:1024
    buffer_load_dwordx2 v[236:237], v255, s[40:43], s25 offen offset:1088
    v_mfma_f32_16x16x32_bf16 v[14:17], v[210:213], v[126:129], v[14:17]
    s_waitcnt lgkmcnt(2)
    v_mfma_f32_16x16x32_bf16 v[26:29], v[214:217], v[122:125], v[26:29]
    ds_read_b128 v[210:213], v1 offset:16384
    v_mfma_f32_16x16x32_bf16 v[30:33], v[214:217], v[126:129], v[30:33]
    s_waitcnt lgkmcnt(2)
    v_mfma_f32_16x16x32_bf16 v[42:45], v[218:221], v[122:125], v[42:45]
    ds_read_b128 v[214:217], v1 offset:53248
    s_add_u32 m0, s17, 0x6000
    s_add_u32 s13, s19, 0x6000
    buffer_load_dwordx4 v1, s[32:35], s13 offen lds
    buffer_load_dwordx2 v[238:239], v255, s[40:43], s25 offen offset:1536
    buffer_load_dwordx2 v[240:241], v255, s[40:43], s25 offen offset:1600
    s_add_u32 m0, s17, 0
    s_add_u32 s13, s20, 0
    buffer_load_dwordx4 v1, s[32:35], s13 offen lds
    v_mfma_f32_16x16x32_bf16 v[46:49], v[218:221], v[126:129], v[46:49]
    s_waitcnt lgkmcnt(2)
    v_mfma_f32_16x16x32_bf16 v[58:61], v[222:225], v[122:125], v[58:61]
    ds_read_b128 v[218:221], v252 offset:24576
    v_mfma_f32_16x16x32_bf16 v[62:65], v[222:225], v[126:129], v[62:65]
    s_waitcnt vmcnt(11) lgkmcnt(2)
    v_mfma_f32_16x16x32_bf16 v[2:5], v[210:213], v[130:133], v[2:5]
    ds_read_b128 v[222:225], v252 offset:61440
    s_add_u32 s13, s15, 0x2000
    buffer_load_dwordx4 v[154:157], v1, s[36:39], s13 offen offset:3072
    s_waitcnt vmcnt(11)
    v_mfma_f32_16x16x32_bf16 v[6:9], v[210:213], v[134:137], v[6:9]
    s_waitcnt lgkmcnt(2)
    v_mfma_f32_16x16x32_bf16 v[18:21], v[214:217], v[130:133], v[18:21]
    ds_read_b128 v[210:213], v1 offset:17408
    s_add_u32 s13, s15, 0x6800
    buffer_load_dwordx4 v[158:161], v1, s[36:39], s13 offen offset:3072
    v_mfma_f32_16x16x32_bf16 v[22:25], v[214:217], v[134:137], v[22:25]
    s_waitcnt lgkmcnt(2)
    v_mfma_f32_16x16x32_bf16 v[34:37], v[218:221], v[130:133], v[34:37]
    ds_read_b128 v[214:217], v1 offset:54272
    s_add_u32 m0, s17, 0xf000
    s_add_u32 s13, s19, 0xf000
    buffer_load_dwordx4 v1, s[32:35], s13 offen lds
    v_mfma_f32_16x16x32_bf16 v[38:41], v[218:221], v[134:137], v[38:41]
    s_waitcnt lgkmcnt(2)
    v_mfma_f32_16x16x32_bf16 v[50:53], v[222:225], v[130:133], v[50:53]
    ds_read_b128 v[218:221], v252 offset:25600
    s_add_u32 m0, s17, 0x18000
    s_add_u32 s13, s19, 0x18000
    buffer_load_dwordx4 v1, s[32:35], s13 offen lds
    v_mfma_f32_16x16x32_bf16 v[54:57], v[222:225], v[134:137], v[54:57]
    s_waitcnt lgkmcnt(2)
    v_mfma_f32_16x16x32_bf16 v[10:13], v[210:213], v[130:133], v[10:13]
    ds_read_b128 v[222:225], v252 offset:62464
    s_add_u32 m0, s17, 0x21000
    s_add_u32 s13, s19, 0x21000
    buffer_load_dwordx4 v1, s[32:35], s13 offen lds
    v_mfma_f32_16x16x32_bf16 v[14:17], v[210:213], v[134:137], v[14:17]
    s_waitcnt lgkmcnt(2)
    v_mfma_f32_16x16x32_bf16 v[26:29], v[214:217], v[130:133], v[26:29]
    ds_read_b128 v[210:213], v1 offset:18432
    v_mfma_f32_16x16x32_bf16 v[30:33], v[214:217], v[134:137], v[30:33]
    s_waitcnt lgkmcnt(2)
    v_mfma_f32_16x16x32_bf16 v[42:45], v[218:221], v[130:133], v[42:45]
    ds_read_b128 v[214:217], v1 offset:55296
    v_mfma_f32_16x16x32_bf16 v[46:49], v[218:221], v[134:137], v[46:49]
    s_waitcnt lgkmcnt(2)
    v_mfma_f32_16x16x32_bf16 v[58:61], v[222:225], v[130:133], v[58:61]
    ds_read_b128 v[218:221], v252 offset:26624
    v_mfma_f32_16x16x32_bf16 v[62:65], v[222:225], v[134:137], v[62:65]
    s_waitcnt vmcnt(14) lgkmcnt(2)
    v_mfma_f32_16x16x32_bf16 v[2:5], v[210:213], v[138:141], v[2:5]
    ds_read_b128 v[222:225], v252 offset:63488
    s_add_u32 s13, s15, 0x3000
    buffer_load_dwordx4 v[162:165], v1, s[36:39], s13 offen
    s_waitcnt vmcnt(14)
    v_mfma_f32_16x16x32_bf16 v[6:9], v[210:213], v[142:145], v[6:9]
    s_waitcnt lgkmcnt(2)
    v_mfma_f32_16x16x32_bf16 v[18:21], v[214:217], v[138:141], v[18:21]
    ds_read_b128 v[210:213], v1 offset:19456
    s_add_u32 s13, s15, 0x7800
    buffer_load_dwordx4 v[166:169], v1, s[36:39], s13 offen
    v_mfma_f32_16x16x32_bf16 v[22:25], v[214:217], v[142:145], v[22:25]
    s_waitcnt lgkmcnt(2)
    v_mfma_f32_16x16x32_bf16 v[34:37], v[218:221], v[138:141], v[34:37]
    ds_read_b128 v[214:217], v1 offset:56320
    v_mfma_f32_16x16x32_bf16 v[38:41], v[218:221], v[142:145], v[38:41]
    s_waitcnt lgkmcnt(2)
    v_mfma_f32_16x16x32_bf16 v[50:53], v[222:225], v[138:141], v[50:53]
    ds_read_b128 v[218:221], v252 offset:27648
    v_mfma_f32_16x16x32_bf16 v[54:57], v[222:225], v[142:145], v[54:57]
    s_waitcnt lgkmcnt(2)
    v_mfma_f32_16x16x32_bf16 v[10:13], v[210:213], v[138:141], v[10:13]
    ds_read_b128 v[222:225], v252 offset:64512
    v_mfma_f32_16x16x32_bf16 v[14:17], v[210:213], v[142:145], v[14:17]
    s_waitcnt lgkmcnt(2)
    v_mfma_f32_16x16x32_bf16 v[26:29], v[214:217], v[138:141], v[26:29]
    ds_read_b128 v[210:213], v1 offset:20480
    v_mfma_f32_16x16x32_bf16 v[30:33], v[214:217], v[142:145], v[30:33]
    s_waitcnt lgkmcnt(2)
    v_mfma_f32_16x16x32_bf16 v[42:45], v[218:221], v[138:141], v[42:45]
    ds_read_b128 v[214:217], v1 offset:57344
    v_mfma_f32_16x16x32_bf16 v[46:49], v[218:221], v[142:145], v[46:49]
    s_waitcnt lgkmcnt(2)
    v_mfma_f32_16x16x32_bf16 v[58:61], v[222:225], v[138:141], v[58:61]
    ds_read_b128 v[218:221], v252 offset:28672
    v_mfma_f32_16x16x32_bf16 v[62:65], v[222:225], v[142:145], v[62:65]
    s_waitcnt vmcnt(14) lgkmcnt(2)
    v_mfma_f32_16x16x32_bf16 v[2:5], v[210:213], v[146:149], v[2:5]
    ds_read_b128 v[222:225], v253
    s_add_u32 s13, s15, 0x3000
    buffer_load_dwordx4 v[170:173], v1, s[36:39], s13 offen offset:1024
    s_waitcnt vmcnt(14)
    v_mfma_f32_16x16x32_bf16 v[6:9], v[210:213], v[150:153], v[6:9]
    s_waitcnt lgkmcnt(2)
    v_mfma_f32_16x16x32_bf16 v[18:21], v[214:217], v[146:149], v[18:21]
    ds_read_b128 v[210:213], v1 offset:21504
    s_add_u32 s13, s15, 0x7800
    buffer_load_dwordx4 v[174:177], v1, s[36:39], s13 offen offset:1024
    v_mfma_f32_16x16x32_bf16 v[22:25], v[214:217], v[150:153], v[22:25]
    s_waitcnt lgkmcnt(2)
    v_mfma_f32_16x16x32_bf16 v[34:37], v[218:221], v[146:149], v[34:37]
    ds_read_b128 v[214:217], v1 offset:58368
    v_mfma_f32_16x16x32_bf16 v[38:41], v[218:221], v[150:153], v[38:41]
    s_waitcnt lgkmcnt(2)
    v_mfma_f32_16x16x32_bf16 v[50:53], v[222:225], v[146:149], v[50:53]
    ds_read_b128 v[218:221], v252 offset:29696
    v_mfma_f32_16x16x32_bf16 v[54:57], v[222:225], v[150:153], v[54:57]
    s_waitcnt lgkmcnt(2)
    v_mfma_f32_16x16x32_bf16 v[10:13], v[210:213], v[146:149], v[10:13]
    ds_read_b128 v[222:225], v253 offset:1024
    s_waitcnt vmcnt(13)
    v_mfma_f32_16x16x16_bf16 v[34:37], v[234:235], v[242:243], v[34:37]
    v_mfma_f32_16x16x16_bf16 v[38:41], v[234:235], v[244:245], v[38:41]
    v_mfma_f32_16x16x16_bf16 v[42:45], v[236:237], v[242:243], v[42:45]
    v_mfma_f32_16x16x16_bf16 v[46:49], v[236:237], v[244:245], v[46:49]
    v_mfma_f32_16x16x32_bf16 v[14:17], v[210:213], v[150:153], v[14:17]
    s_waitcnt lgkmcnt(2)
    v_mfma_f32_16x16x32_bf16 v[26:29], v[214:217], v[146:149], v[26:29]
    ds_read_b128 v[210:213], v1 offset:22528
    v_mfma_f32_16x16x32_bf16 v[30:33], v[214:217], v[150:153], v[30:33]
    s_waitcnt lgkmcnt(2)
    v_mfma_f32_16x16x32_bf16 v[42:45], v[218:221], v[146:149], v[42:45]
    ds_read_b128 v[214:217], v1 offset:59392
    v_mfma_f32_16x16x32_bf16 v[46:49], v[218:221], v[150:153], v[46:49]
    s_waitcnt lgkmcnt(2)
    v_mfma_f32_16x16x32_bf16 v[58:61], v[222:225], v[146:149], v[58:61]
    ds_read_b128 v[218:221], v252 offset:30720
    v_mfma_f32_16x16x32_bf16 v[62:65], v[222:225], v[150:153], v[62:65]
    s_waitcnt vmcnt(8) lgkmcnt(2)
    v_mfma_f32_16x16x32_bf16 v[2:5], v[210:213], v[154:157], v[2:5]
    ds_read_b128 v[222:225], v253 offset:2048
    s_add_u32 s13, s15, 0x3000
    buffer_load_dwordx4 v[178:181], v1, s[36:39], s13 offen offset:2048
    s_waitcnt vmcnt(8)
    v_mfma_f32_16x16x32_bf16 v[6:9], v[210:213], v[158:161], v[6:9]
    s_waitcnt lgkmcnt(2)
    v_mfma_f32_16x16x32_bf16 v[18:21], v[214:217], v[154:157], v[18:21]
    ds_read_b128 v[210:213], v1 offset:23552
    s_add_u32 s13, s15, 0x7800
    buffer_load_dwordx4 v[182:185], v1, s[36:39], s13 offen offset:2048
    v_mfma_f32_16x16x16_bf16 v[50:53], v[238:239], v[242:243], v[50:53]
    v_mfma_f32_16x16x16_bf16 v[54:57], v[238:239], v[244:245], v[54:57]
    v_mfma_f32_16x16x16_bf16 v[58:61], v[240:241], v[242:243], v[58:61]
    v_mfma_f32_16x16x16_bf16 v[62:65], v[240:241], v[244:245], v[62:65]
    v_mfma_f32_16x16x32_bf16 v[22:25], v[214:217], v[158:161], v[22:25]
    s_waitcnt lgkmcnt(2)
    v_mfma_f32_16x16x32_bf16 v[34:37], v[218:221], v[154:157], v[34:37]
    ds_read_b128 v[214:217], v1 offset:60416
    s_add_u32 m0, s18, 0
    s_add_u32 s13, s22, 0
    s_mov_b32 exec_hi, 0
    buffer_load_dwordx4 v1, s[32:35], s13 offen lds
    s_mov_b32 exec_hi, -1
    v_mfma_f32_16x16x32_bf16 v[38:41], v[218:221], v[158:161], v[38:41]
    s_waitcnt lgkmcnt(2)
    v_mfma_f32_16x16x32_bf16 v[50:53], v[222:225], v[154:157], v[50:53]
    ds_read_b128 v[218:221], v252 offset:31744
    s_add_u32 m0, s18, 0x9000
    s_add_u32 s13, s22, 0x9000
    s_mov_b32 exec_hi, 0
    buffer_load_dwordx4 v1, s[32:35], s13 offen lds
    s_mov_b32 exec_hi, -1
    v_mfma_f32_16x16x32_bf16 v[54:57], v[222:225], v[158:161], v[54:57]
    s_waitcnt vmcnt(8)
    s_barrier
    s_waitcnt lgkmcnt(2)
    v_mfma_f32_16x16x32_bf16 v[10:13], v[210:213], v[154:157], v[10:13]
    ds_read_b128 v[222:225], v253 offset:3072
    s_add_u32 m0, s18, 0x12000
    s_add_u32 s13, s22, 0x12000
    s_mov_b32 exec_hi, 0
    buffer_load_dwordx4 v1, s[32:35], s13 offen lds
    s_mov_b32 exec_hi, -1
    v_mfma_f32_16x16x32_bf16 v[14:17], v[210:213], v[158:161], v[14:17]
    s_waitcnt lgkmcnt(2)
    v_mfma_f32_16x16x32_bf16 v[26:29], v[214:217], v[154:157], v[26:29]
    ds_read_b128 v[210:213], v1 offset:24576
    v_mfma_f32_16x16x32_bf16 v[30:33], v[214:217], v[158:161], v[30:33]
    s_waitcnt lgkmcnt(2)
    v_mfma_f32_16x16x32_bf16 v[42:45], v[218:221], v[154:157], v[42:45]
    ds_read_b128 v[214:217], v1 offset:61440
    s_add_u32 m0, s18, 0x1b000
    s_add_u32 s13, s22, 0x1b000
    s_mov_b32 exec_hi, 0
    buffer_load_dwordx4 v1, s[32:35], s13 offen lds
    s_mov_b32 exec_hi, -1
    s_add_u32 m0, s17, 0x2000
    s_add_u32 s13, s20, 0x2000
    buffer_load_dwordx4 v1, s[32:35], s13 offen lds
    v_mfma_f32_16x16x32_bf16 v[46:49], v[218:221], v[158:161], v[46:49]
    s_waitcnt lgkmcnt(2)
    v_mfma_f32_16x16x32_bf16 v[58:61], v[222:225], v[154:157], v[58:61]
    ds_read_b128 v[218:221], v252 offset:32768
    v_mfma_f32_16x16x32_bf16 v[62:65], v[222:225], v[158:161], v[62:65]
    s_waitcnt vmcnt(10) lgkmcnt(2)
    v_mfma_f32_16x16x32_bf16 v[2:5], v[210:213], v[162:165], v[2:5]
    ds_read_b128 v[222:225], v253 offset:4096
    s_add_u32 s13, s15, 0x3000
    buffer_load_dwordx4 v[186:189], v1, s[36:39], s13 offen offset:3072
    s_waitcnt vmcnt(10)
    v_mfma_f32_16x16x32_bf16 v[6:9], v[210:213], v[166:169], v[6:9]
    s_waitcnt lgkmcnt(2)
    v_mfma_f32_16x16x32_bf16 v[18:21], v[214:217], v[162:165], v[18:21]
    ds_read_b128 v[210:213], v1 offset:25600
    s_add_u32 s13, s15, 0x7800
    buffer_load_dwordx4 v[190:193], v1, s[36:39], s13 offen offset:3072
    v_mfma_f32_16x16x32_bf16 v[22:25], v[214:217], v[166:169], v[22:25]
    s_waitcnt lgkmcnt(2)
    v_mfma_f32_16x16x32_bf16 v[34:37], v[218:221], v[162:165], v[34:37]
    ds_read_b128 v[214:217], v1 offset:62464
    s_add_u32 s13, s15, 0x4000
    buffer_load_dwordx4 v[194:197], v1, s[36:39], s13 offen
    v_mfma_f32_16x16x32_bf16 v[38:41], v[218:221], v[166:169], v[38:41]
    s_waitcnt lgkmcnt(2)
    v_mfma_f32_16x16x32_bf16 v[50:53], v[222:225], v[162:165], v[50:53]
    ds_read_b128 v[218:221], v252 offset:33792
    s_add_u32 s13, s15, 0x8800
    buffer_load_dwordx4 v[198:201], v1, s[36:39], s13 offen
    v_mfma_f32_16x16x32_bf16 v[54:57], v[222:225], v[166:169], v[54:57]
    s_waitcnt lgkmcnt(2)
    v_mfma_f32_16x16x32_bf16 v[10:13], v[210:213], v[162:165], v[10:13]
    ds_read_b128 v[222:225], v253 offset:5120
    s_add_u32 s13, s15, 0x4000
    buffer_load_dwordx4 v[202:205], v1, s[36:39], s13 offen offset:1024
    v_mfma_f32_16x16x32_bf16 v[14:17], v[210:213], v[166:169], v[14:17]
    s_waitcnt lgkmcnt(2)
    v_mfma_f32_16x16x32_bf16 v[26:29], v[214:217], v[162:165], v[26:29]
    ds_read_b128 v[210:213], v1 offset:26624
    s_add_u32 s13, s15, 0x8800
    buffer_load_dwordx4 v[206:209], v1, s[36:39], s13 offen offset:1024
    v_mfma_f32_16x16x32_bf16 v[30:33], v[214:217], v[166:169], v[30:33]
    s_waitcnt lgkmcnt(2)
    v_mfma_f32_16x16x32_bf16 v[42:45], v[218:221], v[162:165], v[42:45]
    ds_read_b128 v[214:217], v1 offset:63488
    v_mfma_f32_16x16x32_bf16 v[46:49], v[218:221], v[166:169], v[46:49]
    s_waitcnt lgkmcnt(2)
    v_mfma_f32_16x16x32_bf16 v[58:61], v[222:225], v[162:165], v[58:61]
    ds_read_b128 v[218:221], v252 offset:34816
    v_mfma_f32_16x16x32_bf16 v[62:65], v[222:225], v[166:169], v[62:65]
    s_waitcnt vmcnt(14) lgkmcnt(2)
    v_mfma_f32_16x16x32_bf16 v[2:5], v[210:213], v[170:173], v[2:5]
    ds_read_b128 v[222:225], v253 offset:6144
    s_waitcnt vmcnt(13)
    v_mfma_f32_16x16x32_bf16 v[6:9], v[210:213], v[174:177], v[6:9]
    s_waitcnt lgkmcnt(2)
    v_mfma_f32_16x16x32_bf16 v[18:21], v[214:217], v[170:173], v[18:21]
    ds_read_b128 v[210:213], v1 offset:27648
    v_mfma_f32_16x16x32_bf16 v[22:25], v[214:217], v[174:177], v[22:25]
    s_waitcnt lgkmcnt(2)
    v_mfma_f32_16x16x32_bf16 v[34:37], v[218:221], v[170:173], v[34:37]
    ds_read_b128 v[214:217], v1 offset:64512
    v_mfma_f32_16x16x32_bf16 v[38:41], v[218:221], v[174:177], v[38:41]
    s_waitcnt lgkmcnt(2)
    v_mfma_f32_16x16x32_bf16 v[50:53], v[222:225], v[170:173], v[50:53]
    ds_read_b128 v[218:221], v252 offset:35840
    v_mfma_f32_16x16x32_bf16 v[54:57], v[222:225], v[174:177], v[54:57]
    s_waitcnt lgkmcnt(2)
    v_mfma_f32_16x16x32_bf16 v[10:13], v[210:213], v[170:173], v[10:13]
    ds_read_b128 v[222:225], v253 offset:7168
    v_mfma_f32_16x16x32_bf16 v[14:17], v[210:213], v[174:177], v[14:17]
    s_waitcnt lgkmcnt(2)
    v_mfma_f32_16x16x32_bf16 v[26:29], v[214:217], v[170:173], v[26:29]
    ds_read_b128 v[210:213], v1 offset:28672
    v_mfma_f32_16x16x32_bf16 v[30:33], v[214:217], v[174:177], v[30:33]
    s_waitcnt lgkmcnt(2)
    v_mfma_f32_16x16x32_bf16 v[42:45], v[218:221], v[170:173], v[42:45]
    ds_read_b128 v[214:217], v252
    v_mfma_f32_16x16x32_bf16 v[46:49], v[218:221], v[174:177], v[46:49]
    s_waitcnt lgkmcnt(2)
    v_mfma_f32_16x16x32_bf16 v[58:61], v[222:225], v[170:173], v[58:61]
    ds_read_b128 v[218:221], v252 offset:36864
    v_mfma_f32_16x16x32_bf16 v[62:65], v[222:225], v[174:177], v[62:65]
    s_waitcnt vmcnt(12) lgkmcnt(2)
    v_mfma_f32_16x16x32_bf16 v[2:5], v[210:213], v[178:181], v[2:5]
    ds_read_b128 v[222:225], v253 offset:8192
    s_waitcnt vmcnt(11)
    v_mfma_f32_16x16x32_bf16 v[6:9], v[210:213], v[182:185], v[6:9]
    s_waitcnt lgkmcnt(2)
    v_mfma_f32_16x16x32_bf16 v[18:21], v[214:217], v[178:181], v[18:21]
    ds_read_b128 v[210:213], v1 offset:29696
    v_mfma_f32_16x16x32_bf16 v[22:25], v[214:217], v[182:185], v[22:25]
    s_waitcnt lgkmcnt(2)
    v_mfma_f32_16x16x32_bf16 v[34:37], v[218:221], v[178:181], v[34:37]
    ds_read_b128 v[214:217], v252 offset:1024
    v_mfma_f32_16x16x32_bf16 v[38:41], v[218:221], v[182:185], v[38:41]
    s_waitcnt lgkmcnt(2)
    v_mfma_f32_16x16x32_bf16 v[50:53], v[222:225], v[178:181], v[50:53]
    ds_read_b128 v[218:221], v252 offset:37888
    v_mfma_f32_16x16x32_bf16 v[54:57], v[222:225], v[182:185], v[54:57]
    s_waitcnt lgkmcnt(2)
    v_mfma_f32_16x16x32_bf16 v[10:13], v[210:213], v[178:181], v[10:13]
    ds_read_b128 v[222:225], v253 offset:9216
    v_mfma_f32_16x16x32_bf16 v[14:17], v[210:213], v[182:185], v[14:17]
    s_waitcnt lgkmcnt(2)
    v_mfma_f32_16x16x32_bf16 v[26:29], v[214:217], v[178:181], v[26:29]
    ds_read_b128 v[210:213], v1 offset:30720
    v_mfma_f32_16x16x32_bf16 v[30:33], v[214:217], v[182:185], v[30:33]
    s_waitcnt vmcnt(7)
    s_barrier
    s_waitcnt lgkmcnt(2)
    v_mfma_f32_16x16x32_bf16 v[42:45], v[218:221], v[178:181], v[42:45]
    ds_read_b128 v[214:217], v1 offset:31744
    v_mfma_f32_16x16x32_bf16 v[46:49], v[218:221], v[182:185], v[46:49]
    s_waitcnt lgkmcnt(2)
    v_mfma_f32_16x16x32_bf16 v[58:61], v[222:225], v[178:181], v[58:61]
    ds_read_b128 v[218:221], v1 offset:32768
    s_add_u32 m0, s17, 0x4000
    s_add_u32 s13, s20, 0x4000
    buffer_load_dwordx4 v1, s[32:35], s13 offen lds
    v_mfma_f32_16x16x32_bf16 v[62:65], v[222:225], v[182:185], v[62:65]
    s_waitcnt vmcnt(6) lgkmcnt(2)
    v_mfma_f32_16x16x32_bf16 v[2:5], v[210:213], v[186:189], v[2:5]
    ds_read_b128 v[222:225], v1 offset:33792
    s_waitcnt vmcnt(5)
    v_mfma_f32_16x16x32_bf16 v[6:9], v[210:213], v[190:193], v[6:9]
    s_waitcnt lgkmcnt(2)
    v_mfma_f32_16x16x32_bf16 v[10:13], v[214:217], v[186:189], v[10:13]
    ds_read_b128 v[210:213], v1 offset:34816
    v_mfma_f32_16x16x32_bf16 v[14:17], v[214:217], v[190:193], v[14:17]
    s_waitcnt vmcnt(4) lgkmcnt(2)
    v_mfma_f32_16x16x32_bf16 v[2:5], v[218:221], v[194:197], v[2:5]
    ds_read_b128 v[214:217], v1 offset:35840
    s_waitcnt vmcnt(3)
    v_mfma_f32_16x16x32_bf16 v[6:9], v[218:221], v[198:201], v[6:9]
    s_waitcnt lgkmcnt(2)
    v_mfma_f32_16x16x32_bf16 v[10:13], v[222:225], v[194:197], v[10:13]
    ds_read_b128 v[218:221], v252 offset:2048
    v_mfma_f32_16x16x32_bf16 v[14:17], v[222:225], v[198:201], v[14:17]
    s_waitcnt vmcnt(2) lgkmcnt(2)
    v_mfma_f32_16x16x32_bf16 v[2:5], v[210:213], v[202:205], v[2:5]
    ds_read_b128 v[222:225], v252 offset:3072
    buffer_load_dwordx2 v[234:235], v255, s[40:43], s26 offen
    buffer_load_dwordx2 v[236:237], v255, s[40:43], s26 offen offset:64
    s_waitcnt vmcnt(3)
    v_mfma_f32_16x16x32_bf16 v[6:9], v[210:213], v[206:209], v[6:9]
    s_waitcnt lgkmcnt(2)
    v_mfma_f32_16x16x32_bf16 v[10:13], v[214:217], v[202:205], v[10:13]
    ds_read_b128 v[210:213], v252 offset:4096
    v_mfma_f32_16x16x32_bf16 v[14:17], v[214:217], v[206:209], v[14:17]
    s_waitcnt lgkmcnt(2)
    v_mfma_f32_16x16x32_bf16 v[18:21], v[218:221], v[186:189], v[18:21]
    ds_read_b128 v[214:217], v252 offset:5120
    v_mfma_f32_16x16x32_bf16 v[22:25], v[218:221], v[190:193], v[22:25]
    s_waitcnt lgkmcnt(2)
    v_mfma_f32_16x16x32_bf16 v[26:29], v[222:225], v[186:189], v[26:29]
    ds_read_b128 v[218:221], v252 offset:6144
    v_mul_f32 v230, v2, v2
    v_mul_f32 v231, v3, v3
    v_mfma_f32_16x16x32_bf16 v[30:33], v[222:225], v[190:193], v[30:33]
    v_mul_f32 v232, v4, v4
    v_mul_f32 v233, v5, v5
    v_fma_f32 v230, v230, v248, v246
    s_barrier
    s_waitcnt lgkmcnt(2)
    v_mfma_f32_16x16x32_bf16 v[18:21], v[210:213], v[194:197], v[18:21]
    ds_read_b128 v[222:225], v252 offset:7168
    s_add_u32 m0, s17, 0x6000
    s_add_u32 s13, s20, 0x6000
    buffer_load_dwordx4 v1, s[32:35], s13 offen lds
    v_mfma_f32_16x16x32_bf16 v[22:25], v[210:213], v[198:201], v[22:25]
    v_fma_f32 v231, v231, v248, v246
    v_fma_f32 v232, v232, v248, v246
    v_fma_f32 v233, v233, v248, v246
    v_mul_f32 v230, v230, v2
    v_mul_f32 v231, v231, v3
    s_waitcnt lgkmcnt(2)
    v_mfma_f32_16x16x32_bf16 v[26:29], v[214:217], v[194:197], v[26:29]
    ds_read_b128 v[210:213], v252 offset:38912
    v_mul_f32 v232, v232, v4
    v_mul_f32 v233, v233, v5
    v_mfma_f32_16x16x32_bf16 v[30:33], v[214:217], v[198:201], v[30:33]
    v_exp_f32 v230, v230
    v_mul_f32 v2, v2, v10
    v_exp_f32 v231, v231
    s_waitcnt lgkmcnt(2)
    v_mfma_f32_16x16x32_bf16 v[18:21], v[218:221], v[202:205], v[18:21]
    ds_read_b128 v[214:217], v252 offset:39936
    s_add_u32 m0, s18, 0
    s_add_u32 s13, s23, 0
    s_mov_b32 exec_hi, 0
    buffer_load_dwordx4 v1, s[32:35], s13 offen lds
    s_mov_b32 exec_hi, -1
    v_mfma_f32_16x16x32_bf16 v[22:25], v[218:221], v[206:209], v[22:25]
    v_mul_f32 v3, v3, v11
    v_exp_f32 v232, v232
    v_mul_f32 v4, v4, v12
    v_exp_f32 v233, v233
    v_mul_f32 v5, v5, v13
    s_waitcnt lgkmcnt(2)
    v_mfma_f32_16x16x32_bf16 v[26:29], v[222:225], v[202:205], v[26:29]
    ds_read_b128 v[218:221], v252 offset:40960
    v_fma_f32 v230, v230, v250, v250
    v_fma_f32 v231, v231, v250, v250
    v_mfma_f32_16x16x32_bf16 v[30:33], v[222:225], v[206:209], v[30:33]
    v_fma_f32 v232, v232, v250, v250
    v_fma_f32 v233, v233, v250, v250
    v_rcp_f32 v230, v230
    s_waitcnt lgkmcnt(2)
    v_mfma_f32_16x16x32_bf16 v[34:37], v[210:213], v[186:189], v[34:37]
    ds_read_b128 v[222:225], v252 offset:41984
    s_add_u32 m0, s17, 0x9000
    s_add_u32 s13, s20, 0x9000
    buffer_load_dwordx4 v1, s[32:35], s13 offen lds
    v_mfma_f32_16x16x32_bf16 v[38:41], v[210:213], v[190:193], v[38:41]
    v_rcp_f32 v231, v231
    v_rcp_f32 v232, v232
    v_rcp_f32 v233, v233
    v_mul_f32 v2, v2, v230
    v_mul_f32 v3, v3, v231
    s_waitcnt lgkmcnt(2)
    v_mfma_f32_16x16x32_bf16 v[42:45], v[214:217], v[186:189], v[42:45]
    ds_read_b128 v[210:213], v252 offset:43008
    v_mul_f32 v4, v4, v232
    v_mul_f32 v5, v5, v233
    v_mfma_f32_16x16x32_bf16 v[46:49], v[214:217], v[190:193], v[46:49]
    v_cvt_pk_bf16_f32 v226, v2, v3
    v_cvt_pk_bf16_f32 v227, v4, v5
    v_mul_f32 v230, v6, v6
    s_waitcnt lgkmcnt(2)
    v_mfma_f32_16x16x32_bf16 v[34:37], v[218:221], v[194:197], v[34:37]
    ds_read_b128 v[214:217], v252 offset:44032
    s_add_u32 m0, s17, 0xb000
    s_add_u32 s13, s20, 0xb000
    buffer_load_dwordx4 v1, s[32:35], s13 offen lds
    v_mfma_f32_16x16x32_bf16 v[38:41], v[218:221], v[198:201], v[38:41]
    v_mul_f32 v231, v7, v7
    v_mul_f32 v232, v8, v8
    v_mul_f32 v233, v9, v9
    v_fma_f32 v230, v230, v249, v247
    s_waitcnt lgkmcnt(2)
    v_mfma_f32_16x16x32_bf16 v[42:45], v[222:225], v[194:197], v[42:45]
    ds_read_b128 v[218:221], v253 offset:10240
    v_fma_f32 v231, v231, v249, v247
    v_fma_f32 v232, v232, v249, v247
    v_mfma_f32_16x16x32_bf16 v[46:49], v[222:225], v[198:201], v[46:49]
    v_fma_f32 v233, v233, v249, v247
    v_mul_f32 v230, v230, v6
    s_waitcnt lgkmcnt(2)
    v_mfma_f32_16x16x32_bf16 v[34:37], v[210:213], v[202:205], v[34:37]
    ds_read_b128 v[222:225], v253 offset:11264
    s_add_u32 m0, s17, 0xd000
    s_add_u32 s13, s20, 0xd000
    buffer_load_dwordx4 v1, s[32:35], s13 offen lds
    v_mfma_f32_16x16x32_bf16 v[38:41], v[210:213], v[206:209], v[38:41]
    v_mul_f32 v231, v231, v7
    v_mul_f32 v232, v232, v8
    v_mul_f32 v233, v233, v9
    v_exp_f32 v230, v230
    s_waitcnt lgkmcnt(2)
    v_mfma_f32_16x16x32_bf16 v[42:45], v[214:217], v[202:205], v[42:45]
    ds_read_b128 v[210:213], v253 offset:12288
    v_mul_f32 v6, v6, v14
    v_exp_f32 v231, v231
    v_mfma_f32_16x16x32_bf16 v[46:49], v[214:217], v[206:209], v[46:49]
    v_mul_f32 v7, v7, v15
    v_exp_f32 v232, v232
    s_waitcnt lgkmcnt(2)
    v_mfma_f32_16x16x32_bf16 v[50:53], v[218:221], v[186:189], v[50:53]
    ds_read_b128 v[214:217], v253 offset:13312
    v_mul_f32 v8, v8, v16
    v_exp_f32 v233, v233
    v_mfma_f32_16x16x32_bf16 v[54:57], v[218:221], v[190:193], v[54:57]
    v_mul_f32 v9, v9, v17
    v_fma_f32 v230, v230, v251, v251
    s_waitcnt lgkmcnt(2)
    v_mfma_f32_16x16x32_bf16 v[58:61], v[222:225], v[186:189], v[58:61]
    ds_read_b128 v[218:221], v253 offset:14336
    v_fma_f32 v231, v231, v251, v251
    v_fma_f32 v232, v232, v251, v251
    v_mfma_f32_16x16x32_bf16 v[62:65], v[222:225], v[190:193], v[62:65]
    v_fma_f32 v233, v233, v251, v251
    v_rcp_f32 v230, v230
    s_waitcnt vmcnt(7)
    s_barrier
    s_waitcnt lgkmcnt(2)
    v_mfma_f32_16x16x32_bf16 v[50:53], v[210:213], v[194:197], v[50:53]
    ds_read_b128 v[222:225], v253 offset:15360
    s_add_u32 m0, s17, 0xf000
    s_add_u32 s13, s20, 0xf000
    buffer_load_dwordx4 v1, s[32:35], s13 offen lds
    v_mfma_f32_16x16x32_bf16 v[54:57], v[210:213], v[198:201], v[54:57]
    v_rcp_f32 v231, v231
    v_rcp_f32 v232, v232
    v_rcp_f32 v233, v233
    v_mul_f32 v6, v6, v230
    s_waitcnt lgkmcnt(2)
    v_mfma_f32_16x16x32_bf16 v[58:61], v[214:217], v[194:197], v[58:61]
    ds_read_b128 v[210:213], v1
    v_mul_f32 v7, v7, v231
    v_mul_f32 v8, v8, v232
    v_mfma_f32_16x16x32_bf16 v[62:65], v[214:217], v[198:201], v[62:65]
    v_mul_f32 v9, v9, v233
    v_cvt_pk_bf16_f32 v228, v6, v7
    s_waitcnt lgkmcnt(2)
    v_mfma_f32_16x16x32_bf16 v[50:53], v[218:221], v[202:205], v[50:53]
    ds_read_b128 v[214:217], v1 offset:1024
    v_cvt_pk_bf16_f32 v229, v8, v9
    v_permlane32_swap_b32 v226, v228
    v_mfma_f32_16x16x32_bf16 v[54:57], v[218:221], v[206:209], v[54:57]
    v_permlane32_swap_b32 v227, v229
    buffer_store_dwordx4 v[226:229], v254, s[48:51], s28 offen sc1
    s_waitcnt lgkmcnt(2)
    v_mfma_f32_16x16x32_bf16 v[58:61], v[222:225], v[202:205], v[58:61]
    ds_read_b128 v[218:221], v1 offset:2048
    s_add_u32 m0, s18, 0x9000
    s_add_u32 s13, s23, 0x9000
    s_mov_b32 exec_hi, 0
    buffer_load_dwordx4 v1, s[32:35], s13 offen lds
    s_mov_b32 exec_hi, -1
    v_mfma_f32_16x16x32_bf16 v[62:65], v[222:225], v[206:209], v[62:65]
    v_mul_f32 v230, v18, v18
    v_mul_f32 v231, v19, v19
    v_mul_f32 v232, v20, v20
    v_mul_f32 v233, v21, v21
    s_waitcnt vmcnt(8)
    v_mfma_f32_16x16x16_bf16 v[2:5], v[234:235], v[242:243], 0
    v_mfma_f32_16x16x16_bf16 v[6:9], v[234:235], v[244:245], 0
    v_mfma_f32_16x16x16_bf16 v[10:13], v[236:237], v[242:243], 0
    v_mfma_f32_16x16x16_bf16 v[14:17], v[236:237], v[244:245], 0
    s_waitcnt lgkmcnt(2)
    v_mfma_f32_16x16x32_bf16 v[2:5], v[210:213], v[66:69], v[2:5]
    ds_read_b128 v[222:225], v1 offset:3072
    v_fma_f32 v230, v230, v248, v246
    v_mfma_f32_16x16x32_bf16 v[6:9], v[210:213], v[70:73], v[6:9]
    v_fma_f32 v231, v231, v248, v246
    v_fma_f32 v232, v232, v248, v246
    s_waitcnt lgkmcnt(2)
    v_mfma_f32_16x16x32_bf16 v[10:13], v[214:217], v[66:69], v[10:13]
    ds_read_b128 v[210:213], v1 offset:4096
    v_fma_f32 v233, v233, v248, v246
    v_mul_f32 v230, v230, v18
    v_mfma_f32_16x16x32_bf16 v[14:17], v[214:217], v[70:73], v[14:17]
    v_mul_f32 v231, v231, v19
    v_mul_f32 v232, v232, v20
    s_waitcnt lgkmcnt(2)
    v_mfma_f32_16x16x32_bf16 v[2:5], v[218:221], v[74:77], v[2:5]
    ds_read_b128 v[214:217], v1 offset:5120
    s_add_u32 m0, s17, 0x12000
    s_add_u32 s13, s20, 0x12000
    buffer_load_dwordx4 v1, s[32:35], s13 offen lds
    v_mfma_f32_16x16x32_bf16 v[6:9], v[218:221], v[78:81], v[6:9]
    v_mul_f32 v233, v233, v21
    v_exp_f32 v230, v230
    v_mul_f32 v18, v18, v26
    v_exp_f32 v231, v231
    s_waitcnt lgkmcnt(2)
    v_mfma_f32_16x16x32_bf16 v[10:13], v[222:225], v[74:77], v[10:13]
    ds_read_b128 v[218:221], v1 offset:6144
    v_mul_f32 v19, v19, v27
    v_exp_f32 v232, v232
    v_mfma_f32_16x16x32_bf16 v[14:17], v[222:225], v[78:81], v[14:17]
    v_mul_f32 v20, v20, v28
    v_exp_f32 v233, v233
    s_waitcnt lgkmcnt(2)
    v_mfma_f32_16x16x32_bf16 v[2:5], v[210:213], v[82:85], v[2:5]
    ds_read_b128 v[222:225], v1 offset:7168
    v_mul_f32 v21, v21, v29
    v_fma_f32 v230, v230, v250, v250
    v_mfma_f32_16x16x32_bf16 v[6:9], v[210:213], v[86:89], v[6:9]
    v_fma_f32 v231, v231, v250, v250
    v_fma_f32 v232, v232, v250, v250
    s_waitcnt lgkmcnt(2)
    v_mfma_f32_16x16x32_bf16 v[10:13], v[214:217], v[82:85], v[10:13]
    ds_read_b128 v[210:213], v1 offset:8192
    s_add_u32 m0, s17, 0x14000
    s_add_u32 s13, s20, 0x14000
    buffer_load_dwordx4 v1, s[32:35], s13 offen lds
    v_mfma_f32_16x16x32_bf16 v[14:17], v[214:217], v[86:89], v[14:17]
    v_fma_f32 v233, v233, v250, v250
    v_rcp_f32 v230, v230
    v_rcp_f32 v231, v231
    v_rcp_f32 v232, v232
    s_waitcnt lgkmcnt(2)
    v_mfma_f32_16x16x32_bf16 v[2:5], v[218:221], v[90:93], v[2:5]
    ds_read_b128 v[214:217], v1 offset:9216
    v_rcp_f32 v233, v233
    v_mul_f32 v18, v18, v230
    v_mfma_f32_16x16x32_bf16 v[6:9], v[218:221], v[94:97], v[6:9]
    v_mul_f32 v19, v19, v231
    v_mul_f32 v20, v20, v232
    s_waitcnt lgkmcnt(2)
    v_mfma_f32_16x16x32_bf16 v[10:13], v[222:225], v[90:93], v[10:13]
    ds_read_b128 v[218:221], v1 offset:10240
    v_mul_f32 v21, v21, v233
    v_cvt_pk_bf16_f32 v226, v18, v19
    v_mfma_f32_16x16x32_bf16 v[14:17], v[222:225], v[94:97], v[14:17]
    v_cvt_pk_bf16_f32 v227, v20, v21
    v_mul_f32 v230, v22, v22
    s_waitcnt lgkmcnt(2)
    v_mfma_f32_16x16x32_bf16 v[2:5], v[210:213], v[98:101], v[2:5]
    ds_read_b128 v[222:225], v1 offset:11264
    s_add_u32 m0, s17, 0x16000
    s_add_u32 s13, s20, 0x16000
    buffer_load_dwordx4 v1, s[32:35], s13 offen lds
    v_mfma_f32_16x16x32_bf16 v[6:9], v[210:213], v[102:105], v[6:9]
    v_mul_f32 v231, v23, v23
    v_mul_f32 v232, v24, v24
    v_mul_f32 v233, v25, v25
    v_fma_f32 v230, v230, v249, v247
    s_waitcnt lgkmcnt(2)
    v_mfma_f32_16x16x32_bf16 v[10:13], v[214:217], v[98:101], v[10:13]
    ds_read_b128 v[210:213], v1 offset:12288
    v_fma_f32 v231, v231, v249, v247
    v_fma_f32 v232, v232, v249, v247
    v_mfma_f32_16x16x32_bf16 v[14:17], v[214:217], v[102:105], v[14:17]
    v_fma_f32 v233, v233, v249, v247
    v_mul_f32 v230, v230, v22
    s_waitcnt lgkmcnt(2)
    v_mfma_f32_16x16x32_bf16 v[2:5], v[218:221], v[106:109], v[2:5]
    ds_read_b128 v[214:217], v1 offset:13312
    v_mul_f32 v231, v231, v23
    v_mul_f32 v232, v232, v24
    v_mfma_f32_16x16x32_bf16 v[6:9], v[218:221], v[110:113], v[6:9]
    v_mul_f32 v233, v233, v25
    v_exp_f32 v230, v230
    s_waitcnt lgkmcnt(2)
    v_mfma_f32_16x16x32_bf16 v[10:13], v[222:225], v[106:109], v[10:13]
    ds_read_b128 v[218:221], v1 offset:14336
    s_add_u32 m0, s17, 0x18000
    s_add_u32 s13, s20, 0x18000
    buffer_load_dwordx4 v1, s[32:35], s13 offen lds
    v_mfma_f32_16x16x32_bf16 v[14:17], v[222:225], v[110:113], v[14:17]
    v_mul_f32 v22, v22, v30
    v_exp_f32 v231, v231
    v_mul_f32 v23, v23, v31
    v_exp_f32 v232, v232
    s_waitcnt lgkmcnt(2)
    v_mfma_f32_16x16x32_bf16 v[2:5], v[210:213], v[114:117], v[2:5]
    ds_read_b128 v[222:225], v1 offset:15360
    v_mul_f32 v24, v24, v32
    v_exp_f32 v233, v233
    v_mfma_f32_16x16x32_bf16 v[6:9], v[210:213], v[118:121], v[6:9]
    v_mul_f32 v25, v25, v33
    v_fma_f32 v230, v230, v251, v251
    s_waitcnt lgkmcnt(2)
    v_mfma_f32_16x16x32_bf16 v[10:13], v[214:217], v[114:117], v[10:13]
    ds_read_b128 v[210:213], v1 offset:16384
    v_fma_f32 v231, v231, v251, v251
    v_fma_f32 v232, v232, v251, v251
    v_mfma_f32_16x16x32_bf16 v[14:17], v[214:217], v[118:121], v[14:17]
    v_fma_f32 v233, v233, v251, v251
    v_rcp_f32 v230, v230
    s_waitcnt lgkmcnt(2)
    v_mfma_f32_16x16x32_bf16 v[2:5], v[218:221], v[122:125], v[2:5]
    ds_read_b128 v[214:217], v1 offset:17408
    s_add_u32 m0, s18, 0x12000
    s_add_u32 s13, s23, 0x12000
    s_mov_b32 exec_hi, 0
    buffer_load_dwordx4 v1, s[32:35], s13 offen lds
    s_mov_b32 exec_hi, -1
    v_mfma_f32_16x16x32_bf16 v[6:9], v[218:221], v[126:129], v[6:9]
    v_rcp_f32 v231, v231
    v_rcp_f32 v232, v232
    v_rcp_f32 v233, v233
    v_mul_f32 v22, v22, v230
    s_waitcnt lgkmcnt(2)
    v_mfma_f32_16x16x32_bf16 v[10:13], v[222:225], v[122:125], v[10:13]
    ds_read_b128 v[218:221], v1 offset:18432
    v_mul_f32 v23, v23, v231
    v_mul_f32 v24, v24, v232
    v_mfma_f32_16x16x32_bf16 v[14:17], v[222:225], v[126:129], v[14:17]
    v_mul_f32 v25, v25, v233
    v_cvt_pk_bf16_f32 v228, v22, v23
    s_waitcnt lgkmcnt(2)
    v_mfma_f32_16x16x32_bf16 v[2:5], v[210:213], v[130:133], v[2:5]
    ds_read_b128 v[222:225], v1 offset:19456
    buffer_load_dwordx2 v[238:239], v255, s[40:43], s26 offen offset:512
    buffer_load_dwordx2 v[240:241], v255, s[40:43], s26 offen offset:576
    v_mfma_f32_16x16x32_bf16 v[6:9], v[210:213], v[134:137], v[6:9]
    v_cvt_pk_bf16_f32 v229, v24, v25
    v_permlane32_swap_b32 v226, v228
    s_nop 0
    v_permlane32_swap_b32 v227, v229
    buffer_store_dwordx4 v[226:229], v254, s[48:51], s28 offen offset:512 sc1
    s_waitcnt lgkmcnt(2)
    v_mfma_f32_16x16x32_bf16 v[10:13], v[214:217], v[130:133], v[10:13]
    ds_read_b128 v[210:213], v1 offset:20480
    v_mul_f32 v230, v34, v34
    v_mul_f32 v231, v35, v35
    v_mfma_f32_16x16x32_bf16 v[14:17], v[214:217], v[134:137], v[14:17]
    v_mul_f32 v232, v36, v36
    v_mul_f32 v233, v37, v37
    s_waitcnt lgkmcnt(2)
    v_mfma_f32_16x16x32_bf16 v[2:5], v[218:221], v[138:141], v[2:5]
    ds_read_b128 v[214:217], v1 offset:21504
    v_fma_f32 v230, v230, v248, v246
    v_fma_f32 v231, v231, v248, v246
    v_mfma_f32_16x16x32_bf16 v[6:9], v[218:221], v[142:145], v[6:9]
    v_fma_f32 v232, v232, v248, v246
    v_fma_f32 v233, v233, v248, v246
    s_waitcnt lgkmcnt(2)
    v_mfma_f32_16x16x32_bf16 v[10:13], v[222:225], v[138:141], v[10:13]
    ds_read_b128 v[218:221], v1 offset:22528
    v_mul_f32 v230, v230, v34
    v_mul_f32 v231, v231, v35
    v_mfma_f32_16x16x32_bf16 v[14:17], v[222:225], v[142:145], v[14:17]
    v_mul_f32 v232, v232, v36
    v_mul_f32 v233, v233, v37
    s_waitcnt lgkmcnt(2)
    v_mfma_f32_16x16x32_bf16 v[2:5], v[210:213], v[146:149], v[2:5]
    ds_read_b128 v[222:225], v1 offset:23552
    v_exp_f32 v230, v230
    v_mul_f32 v34, v34, v42
    v_mfma_f32_16x16x32_bf16 v[6:9], v[210:213], v[150:153], v[6:9]
    v_exp_f32 v231, v231
    v_mul_f32 v35, v35, v43
    s_waitcnt vmcnt(11)
    s_barrier
    s_waitcnt lgkmcnt(2)
    v_mfma_f32_16x16x32_bf16 v[10:13], v[214:217], v[146:149], v[10:13]
    ds_read_b128 v[210:213], v1 offset:24576
    s_add_u32 m0, s17, 0x1b000
    s_add_u32 s13, s21, 0
    buffer_load_dwordx4 v1, s[32:35], s13 offen lds
    v_mfma_f32_16x16x32_bf16 v[14:17], v[214:217], v[150:153], v[14:17]
    v_exp_f32 v232, v232
    v_mul_f32 v36, v36, v44
    v_exp_f32 v233, v233
    v_mul_f32 v37, v37, v45
    s_waitcnt lgkmcnt(2)
    v_mfma_f32_16x16x32_bf16 v[2:5], v[218:221], v[154:157], v[2:5]
    ds_read_b128 v[214:217], v1 offset:25600
    v_fma_f32 v230, v230, v250, v250
    v_fma_f32 v231, v231, v250, v250
    v_mfma_f32_16x16x32_bf16 v[6:9], v[218:221], v[158:161], v[6:9]
    v_fma_f32 v232, v232, v250, v250
    v_fma_f32 v233, v233, v250, v250
    s_waitcnt lgkmcnt(2)
    v_mfma_f32_16x16x32_bf16 v[10:13], v[222:225], v[154:157], v[10:13]
    ds_read_b128 v[218:221], v1 offset:26624
    v_rcp_f32 v230, v230
    v_rcp_f32 v231, v231
    v_mfma_f32_16x16x32_bf16 v[14:17], v[222:225], v[158:161], v[14:17]
    v_rcp_f32 v232, v232
    v_rcp_f32 v233, v233
    s_waitcnt lgkmcnt(2)
    v_mfma_f32_16x16x32_bf16 v[2:5], v[210:213], v[162:165], v[2:5]
    ds_read_b128 v[222:225], v1 offset:27648
    s_add_u32 m0, s17, 0x1d000
    s_add_u32 s13, s21, 0x2000
    buffer_load_dwordx4 v1, s[32:35], s13 offen lds
    v_mfma_f32_16x16x32_bf16 v[6:9], v[210:213], v[166:169], v[6:9]
    v_mul_f32 v34, v34, v230
    v_mul_f32 v35, v35, v231
    v_mul_f32 v36, v36, v232
    s_waitcnt lgkmcnt(2)
    v_mfma_f32_16x16x32_bf16 v[10:13], v[214:217], v[162:165], v[10:13]
    ds_read_b128 v[210:213], v1 offset:28672
    v_mul_f32 v37, v37, v233
    v_mfma_f32_16x16x32_bf16 v[14:17], v[214:217], v[166:169], v[14:17]
    v_cvt_pk_bf16_f32 v226, v34, v35
    v_cvt_pk_bf16_f32 v227, v36, v37
    s_waitcnt lgkmcnt(2)
    v_mfma_f32_16x16x32_bf16 v[2:5], v[218:221], v[170:173], v[2:5]
    ds_read_b128 v[214:217], v1 offset:29696
    v_mul_f32 v230, v38, v38
    v_mfma_f32_16x16x32_bf16 v[6:9], v[218:221], v[174:177], v[6:9]
    v_mul_f32 v231, v39, v39
    v_mul_f32 v232, v40, v40
    s_waitcnt lgkmcnt(2)
    v_mfma_f32_16x16x32_bf16 v[10:13], v[222:225], v[170:173], v[10:13]
    ds_read_b128 v[218:221], v1 offset:30720
    s_add_u32 m0, s17, 0x1f000
    s_add_u32 s13, s21, 0x4000
    buffer_load_dwordx4 v1, s[32:35], s13 offen lds
    v_mfma_f32_16x16x32_bf16 v[14:17], v[222:225], v[174:177], v[14:17]
    v_mul_f32 v233, v41, v41
    v_fma_f32 v230, v230, v249, v247
    v_fma_f32 v231, v231, v249, v247
    s_waitcnt lgkmcnt(2)
    v_mfma_f32_16x16x32_bf16 v[2:5], v[210:213], v[178:181], v[2:5]
    ds_read_b128 v[222:225], v1 offset:31744
    v_fma_f32 v232, v232, v249, v247
    v_mfma_f32_16x16x32_bf16 v[6:9], v[210:213], v[182:185], v[6:9]
    v_fma_f32 v233, v233, v249, v247
    v_mul_f32 v230, v230, v38
    s_waitcnt lgkmcnt(2)
    v_mfma_f32_16x16x32_bf16 v[10:13], v[214:217], v[178:181], v[10:13]
    ds_read_b128 v[210:213], v1 offset:32768
    v_mul_f32 v231, v231, v39
    v_mfma_f32_16x16x32_bf16 v[14:17], v[214:217], v[182:185], v[14:17]
    v_mul_f32 v232, v232, v40
    v_mul_f32 v233, v233, v41
    s_waitcnt lgkmcnt(2)
    v_mfma_f32_16x16x32_bf16 v[2:5], v[218:221], v[186:189], v[2:5]
    ds_read_b128 v[214:217], v1 offset:33792
    s_add_u32 m0, s17, 0x21000
    s_add_u32 s13, s21, 0x6000
    buffer_load_dwordx4 v1, s[32:35], s13 offen lds
    v_mfma_f32_16x16x32_bf16 v[6:9], v[218:221], v[190:193], v[6:9]
    v_exp_f32 v230, v230
    v_mul_f32 v38, v38, v46
    v_exp_f32 v231, v231
    s_waitcnt lgkmcnt(2)
    v_mfma_f32_16x16x32_bf16 v[10:13], v[222:225], v[186:189], v[10:13]
    ds_read_b128 v[218:221], v1 offset:34816
    v_mul_f32 v39, v39, v47
    v_mfma_f32_16x16x32_bf16 v[14:17], v[222:225], v[190:193], v[14:17]
    v_exp_f32 v232, v232
    v_mul_f32 v40, v40, v48
    s_waitcnt lgkmcnt(2)
    v_mfma_f32_16x16x32_bf16 v[2:5], v[210:213], v[194:197], v[2:5]
    ds_read_b128 v[222:225], v1 offset:35840
    v_exp_f32 v233, v233
    v_mfma_f32_16x16x32_bf16 v[6:9], v[210:213], v[198:201], v[6:9]
    v_mul_f32 v41, v41, v49
    v_fma_f32 v230, v230, v251, v251
    s_waitcnt lgkmcnt(2)
    v_mfma_f32_16x16x32_bf16 v[10:13], v[214:217], v[194:197], v[10:13]
    ds_read_b128 v[210:213], v1 offset:36864
    s_add_u32 m0, s18, 0x1b000
    s_add_u32 s13, s24, 0
    s_mov_b32 exec_hi, 0
    buffer_load_dwordx4 v1, s[32:35], s13 offen lds
    s_mov_b32 exec_hi, -1
    v_mfma_f32_16x16x32_bf16 v[14:17], v[214:217], v[198:201], v[14:17]
    v_fma_f32 v231, v231, v251, v251
    v_fma_f32 v232, v232, v251, v251
    v_fma_f32 v233, v233, v251, v251
    s_waitcnt lgkmcnt(2)
    v_mfma_f32_16x16x32_bf16 v[2:5], v[218:221], v[202:205], v[2:5]
    ds_read_b128 v[214:217], v1 offset:37888
    v_rcp_f32 v230, v230
    v_mfma_f32_16x16x32_bf16 v[6:9], v[218:221], v[206:209], v[6:9]
    v_rcp_f32 v231, v231
    v_rcp_f32 v232, v232
    s_waitcnt lgkmcnt(2)
    v_mfma_f32_16x16x32_bf16 v[10:13], v[222:225], v[202:205], v[10:13]
    ds_read_b128 v[218:221], v1 offset:38912
    v_rcp_f32 v233, v233
    v_mfma_f32_16x16x32_bf16 v[14:17], v[222:225], v[206:209], v[14:17]
    v_mul_f32 v38, v38, v230
    v_mul_f32 v39, v39, v231
    s_waitcnt vmcnt(6)
    v_mfma_f32_16x16x16_bf16 v[18:21], v[238:239], v[242:243], 0
    v_mfma_f32_16x16x16_bf16 v[22:25], v[238:239], v[244:245], 0
    v_mfma_f32_16x16x16_bf16 v[26:29], v[240:241], v[242:243], 0
    v_mfma_f32_16x16x16_bf16 v[30:33], v[240:241], v[244:245], 0
    s_waitcnt lgkmcnt(2)
    v_mfma_f32_16x16x32_bf16 v[18:21], v[210:213], v[66:69], v[18:21]
    ds_read_b128 v[222:225], v1 offset:39936
    v_mul_f32 v40, v40, v232
    v_mfma_f32_16x16x32_bf16 v[22:25], v[210:213], v[70:73], v[22:25]
    v_mul_f32 v41, v41, v233
    v_cvt_pk_bf16_f32 v228, v38, v39
    s_waitcnt lgkmcnt(2)
    v_mfma_f32_16x16x32_bf16 v[26:29], v[214:217], v[66:69], v[26:29]
    ds_read_b128 v[210:213], v1 offset:40960
    v_cvt_pk_bf16_f32 v229, v40, v41
    v_mfma_f32_16x16x32_bf16 v[30:33], v[214:217], v[70:73], v[30:33]
    v_permlane32_swap_b32 v226, v228
    v_permlane32_swap_b32 v227, v229
    s_waitcnt lgkmcnt(2)
    v_mfma_f32_16x16x32_bf16 v[18:21], v[218:221], v[74:77], v[18:21]
    ds_read_b128 v[214:217], v1 offset:41984
    s_lshr_b32 s68, s9, 1
    s_lshl_b32 s69, s68, 2
    s_add_u32 s69, s69, s11
    s_mul_i32 s69, s69, 0x51000
    s_add_u32 s70, s69, s17
    s_add_u32 s71, s69, s18
    v_mfma_f32_16x16x32_bf16 v[22:25], v[218:221], v[78:81], v[22:25]
    buffer_store_dwordx4 v[226:229], v254, s[48:51], s28 offen offset:1024 sc1
    v_mul_f32 v230, v50, v50
    v_mul_f32 v231, v51, v51
    s_waitcnt lgkmcnt(2)
    v_mfma_f32_16x16x32_bf16 v[26:29], v[222:225], v[74:77], v[26:29]
    ds_read_b128 v[218:221], v1 offset:43008
    s_add_u32 s56, s4, 0x3000000
    s_addc_u32 s57, s5, 0
    s_and_b32 s57, s57, 0xffff
    s_mov_b32 s58, 0x510000
    s_mov_b32 s59, 0x20000
    v_mfma_f32_16x16x32_bf16 v[30:33], v[222:225], v[78:81], v[30:33]
    v_mul_f32 v232, v52, v52
    v_mul_f32 v233, v53, v53
    v_fma_f32 v230, v230, v248, v246
    s_waitcnt lgkmcnt(2)
    v_mfma_f32_16x16x32_bf16 v[18:21], v[210:213], v[82:85], v[18:21]
    ds_read_b128 v[222:225], v1 offset:44032
    s_add_u32 s64, s4, 0x4000000
    s_addc_u32 s65, s5, 0
    s_and_b32 s65, s65, 0xffff
    s_mov_b32 s66, 0x800000
    s_mov_b32 s67, 0x20000
    v_mfma_f32_16x16x32_bf16 v[22:25], v[210:213], v[86:89], v[22:25]
    v_fma_f32 v231, v231, v248, v246
    v_fma_f32 v232, v232, v248, v246
    v_fma_f32 v233, v233, v248, v246
    s_waitcnt lgkmcnt(2)
    v_mfma_f32_16x16x32_bf16 v[26:29], v[214:217], v[82:85], v[26:29]
    ds_read_b128 v[210:213], v1 offset:45056
    s_mov_b32 s60, s6
    s_and_b32 s61, s7, 0xffff
    s_mov_b32 s62, 0x240000
    s_mov_b32 s63, 0x20000
    v_mfma_f32_16x16x32_bf16 v[30:33], v[214:217], v[86:89], v[30:33]
    v_mul_f32 v230, v230, v50
    v_mul_f32 v231, v231, v51
    v_mul_f32 v232, v232, v52
    s_waitcnt lgkmcnt(2)
    v_mfma_f32_16x16x32_bf16 v[18:21], v[218:221], v[90:93], v[18:21]
    ds_read_b128 v[214:217], v1 offset:46080
    s_and_b32 s8, s12, 3
    s_lshr_b32 s13, s14, 2
    s_lshl_b32 s81, s13, 4
    s_add_u32 s81, s81, s8
    s_lshl_b32 s81, s81, 15
    s_lshl_b32 s13, s11, 13
    s_add_u32 s75, s81, s13
    s_add_u32 s75, s75, 0x1c00
    v_mfma_f32_16x16x32_bf16 v[22:25], v[218:221], v[94:97], v[22:25]
    v_mul_f32 v233, v233, v53
    v_exp_f32 v230, v230
    v_mul_f32 v50, v50, v58
    s_waitcnt lgkmcnt(2)
    v_mfma_f32_16x16x32_bf16 v[26:29], v[222:225], v[90:93], v[26:29]
    ds_read_b128 v[218:221], v1 offset:47104
    s_lshl_b32 s13, s68, 17
    s_add_u32 s81, s81, s13
    s_lshr_b32 s13, s12, 2
    s_and_b32 s76, s9, 1
    s_cmp_eq_u32 s13, s76
    s_cselect_b32 s76, 1, 0
    s_mov_b32 s85, 0
    v_mfma_f32_16x16x32_bf16 v[30:33], v[222:225], v[94:97], v[30:33]
    v_exp_f32 v231, v231
    v_mul_f32 v51, v51, v59
    v_exp_f32 v232, v232
    s_waitcnt lgkmcnt(2)
    v_mfma_f32_16x16x32_bf16 v[18:21], v[210:213], v[98:101], v[18:21]
    ds_read_b128 v[222:225], v1 offset:48128
    s_xor_b32 s13, s11, 0
    s_lshl_b32 s13, s13, 13
    s_add_u32 s87, s81, s13
    v_mfma_f32_16x16x32_bf16 v[22:25], v[210:213], v[102:105], v[22:25]
    v_mul_f32 v52, v52, v60
    v_exp_f32 v233, v233
    v_mul_f32 v53, v53, v61
    s_waitcnt lgkmcnt(2)
    v_mfma_f32_16x16x32_bf16 v[26:29], v[214:217], v[98:101], v[26:29]
    ds_read_b128 v[210:213], v1 offset:49152
    s_xor_b32 s13, s11, 1
    s_lshl_b32 s13, s13, 13
    s_add_u32 s88, s81, s13
    v_mfma_f32_16x16x32_bf16 v[30:33], v[214:217], v[102:105], v[30:33]
    v_fma_f32 v230, v230, v250, v250
    v_fma_f32 v231, v231, v250, v250
    v_fma_f32 v232, v232, v250, v250
    s_waitcnt lgkmcnt(2)
    v_mfma_f32_16x16x32_bf16 v[18:21], v[218:221], v[106:109], v[18:21]
    ds_read_b128 v[214:217], v1 offset:50176
    s_xor_b32 s13, s11, 2
    s_lshl_b32 s13, s13, 13
    s_add_u32 s89, s81, s13
    v_mfma_f32_16x16x32_bf16 v[22:25], v[218:221], v[110:113], v[22:25]
    v_fma_f32 v233, v233, v250, v250
    v_rcp_f32 v230, v230
    v_rcp_f32 v231, v231
    s_waitcnt lgkmcnt(2)
    v_mfma_f32_16x16x32_bf16 v[26:29], v[222:225], v[106:109], v[26:29]
    ds_read_b128 v[218:221], v1 offset:51200
    s_xor_b32 s13, s11, 3
    s_lshl_b32 s13, s13, 13
    s_add_u32 s90, s81, s13
    v_mfma_f32_16x16x32_bf16 v[30:33], v[222:225], v[110:113], v[30:33]
    v_rcp_f32 v232, v232
    v_rcp_f32 v233, v233
    v_mul_f32 v50, v50, v230
    s_waitcnt lgkmcnt(2)
    v_mfma_f32_16x16x32_bf16 v[18:21], v[210:213], v[114:117], v[18:21]
    ds_read_b128 v[222:225], v1 offset:52224
    s_and_b32 s72, s11, 1
    s_lshr_b32 s73, s11, 1
    s_mul_i32 s13, s11, 0x9000
    s_add_u32 s74, s52, s13
    s_mov_b32 s83, 0x3f80
    s_mov_b32 s84, 0x3f800000
    v_mfma_f32_16x16x32_bf16 v[22:25], v[210:213], v[118:121], v[22:25]
    v_mul_f32 v51, v51, v231
    v_mul_f32 v52, v52, v232
    v_mul_f32 v53, v53, v233
    s_waitcnt lgkmcnt(2)
    v_mfma_f32_16x16x32_bf16 v[26:29], v[214:217], v[114:117], v[26:29]
    ds_read_b128 v[210:213], v1 offset:53248
    s_lshl_b32 s86, s14, 1
    s_add_u32 s86, s86, s72
    s_mul_i32 s78, s86, 0x4800
    s_lshl_b32 s13, s68, 1
    s_add_u32 s13, s13, s73
    s_lshl_b32 s79, s13, 7
    s_lshl_b32 s13, s13, 11
    s_add_u32 s77, s78, s13
    v_mfma_f32_16x16x32_bf16 v[30:33], v[214:217], v[118:121], v[30:33]
    v_cvt_pk_bf16_f32 v226, v50, v51
    v_cvt_pk_bf16_f32 v227, v52, v53
    v_mul_f32 v230, v54, v54
    s_waitcnt lgkmcnt(2)
    v_mfma_f32_16x16x32_bf16 v[18:21], v[218:221], v[122:125], v[18:21]
    ds_read_b128 v[214:217], v1 offset:54272
    s_lshl_b32 s13, s73, 8
    s_add_u32 s78, s78, s13
    s_lshl_b32 s13, s68, 2
    s_add_u32 s78, s78, s13
    s_add_u32 s78, s78, 0x4000
    s_lshl_b32 s80, s73, 4
    s_add_u32 s80, s80, s13
    s_add_u32 s80, s80, 0x400
    v_mfma_f32_16x16x32_bf16 v[22:25], v[218:221], v[126:129], v[22:25]
    v_mul_f32 v231, v55, v55
    v_mul_f32 v232, v56, v56
    v_mul_f32 v233, v57, v57
    s_waitcnt lgkmcnt(2)
    v_mfma_f32_16x16x32_bf16 v[26:29], v[222:225], v[122:125], v[26:29]
    ds_read_b128 v[218:221], v1 offset:55296
    s_mul_i32 s13, s86, 0x4800
    s_add_u32 s79, s79, s13
    s_add_u32 s80, s80, s13
    v_mfma_f32_16x16x32_bf16 v[30:33], v[222:225], v[126:129], v[30:33]
    v_fma_f32 v230, v230, v249, v247
    v_fma_f32 v231, v231, v249, v247
    v_fma_f32 v232, v232, v249, v247
    s_waitcnt lgkmcnt(2)
    v_mfma_f32_16x16x32_bf16 v[18:21], v[210:213], v[130:133], v[18:21]
    ds_read_b128 v[222:225], v1 offset:56320
    buffer_load_dwordx2 v[234:235], v255, s[40:43], s26 offen offset:1024
    buffer_load_dwordx2 v[236:237], v255, s[40:43], s26 offen offset:1088
    v_mfma_f32_16x16x32_bf16 v[22:25], v[210:213], v[134:137], v[22:25]
    v_fma_f32 v233, v233, v249, v247
    v_mul_f32 v230, v230, v54
    v_mul_f32 v231, v231, v55
    s_waitcnt lgkmcnt(2)
    v_mfma_f32_16x16x32_bf16 v[26:29], v[214:217], v[130:133], v[26:29]
    ds_read_b128 v[210:213], v1 offset:57344
    v_mul_f32 v232, v232, v56
    v_mfma_f32_16x16x32_bf16 v[30:33], v[214:217], v[134:137], v[30:33]
    v_mul_f32 v233, v233, v57
    v_exp_f32 v230, v230
    s_waitcnt lgkmcnt(2)
    v_mfma_f32_16x16x32_bf16 v[18:21], v[218:221], v[138:141], v[18:21]
    ds_read_b128 v[214:217], v1 offset:58368
    v_mul_f32 v54, v54, v62
    v_mfma_f32_16x16x32_bf16 v[22:25], v[218:221], v[142:145], v[22:25]
    v_exp_f32 v231, v231
    v_mul_f32 v55, v55, v63
    s_waitcnt lgkmcnt(2)
    v_mfma_f32_16x16x32_bf16 v[26:29], v[222:225], v[138:141], v[26:29]
    ds_read_b128 v[218:221], v1 offset:59392
    v_exp_f32 v232, v232
    v_mfma_f32_16x16x32_bf16 v[30:33], v[222:225], v[142:145], v[30:33]
    v_mul_f32 v56, v56, v64
    v_exp_f32 v233, v233
    s_waitcnt lgkmcnt(2)
    v_mfma_f32_16x16x32_bf16 v[18:21], v[210:213], v[146:149], v[18:21]
    ds_read_b128 v[222:225], v1 offset:60416
    v_mul_f32 v57, v57, v65
    v_mfma_f32_16x16x32_bf16 v[22:25], v[210:213], v[150:153], v[22:25]
    v_fma_f32 v230, v230, v251, v251
    v_fma_f32 v231, v231, v251, v251
    s_barrier
    s_waitcnt lgkmcnt(2)
    v_mfma_f32_16x16x32_bf16 v[26:29], v[214:217], v[146:149], v[26:29]
    ds_read_b128 v[210:213], v1 offset:61440
    s_add_u32 m0, s17, 0
    s_add_u32 s13, s21, 0x9000
    buffer_load_dwordx4 v1, s[32:35], s13 offen lds
    v_mfma_f32_16x16x32_bf16 v[30:33], v[214:217], v[150:153], v[30:33]
    v_fma_f32 v232, v232, v251, v251
    v_fma_f32 v233, v233, v251, v251
    v_rcp_f32 v230, v230
    s_waitcnt lgkmcnt(2)
    v_mfma_f32_16x16x32_bf16 v[18:21], v[218:221], v[154:157], v[18:21]
    ds_read_b128 v[214:217], v1 offset:62464
    v_rcp_f32 v231, v231
    v_mfma_f32_16x16x32_bf16 v[22:25], v[218:221], v[158:161], v[22:25]
    v_rcp_f32 v232, v232
    v_rcp_f32 v233, v233
    s_waitcnt lgkmcnt(2)
    v_mfma_f32_16x16x32_bf16 v[26:29], v[222:225], v[154:157], v[26:29]
    ds_read_b128 v[218:221], v1 offset:63488
    v_mul_f32 v54, v54, v230
    v_mfma_f32_16x16x32_bf16 v[30:33], v[222:225], v[158:161], v[30:33]
    v_mul_f32 v55, v55, v231
    v_mul_f32 v56, v56, v232
    s_waitcnt lgkmcnt(2)
    v_mfma_f32_16x16x32_bf16 v[18:21], v[210:213], v[162:165], v[18:21]
    ds_read_b128 v[222:225], v1 offset:64512
    s_add_u32 m0, s17, 0x2000
    s_add_u32 s13, s21, 0xb000
    buffer_load_dwordx4 v1, s[32:35], s13 offen lds
    v_mfma_f32_16x16x32_bf16 v[22:25], v[210:213], v[166:169], v[22:25]
    v_mul_f32 v57, v57, v233
    v_cvt_pk_bf16_f32 v228, v54, v55
    v_cvt_pk_bf16_f32 v229, v56, v57
    s_waitcnt lgkmcnt(2)
    v_mfma_f32_16x16x32_bf16 v[26:29], v[214:217], v[162:165], v[26:29]
    ds_read_b128 v[210:213], v252
    v_permlane32_swap_b32 v226, v228
    v_mfma_f32_16x16x32_bf16 v[30:33], v[214:217], v[166:169], v[30:33]
    v_permlane32_swap_b32 v227, v229
    buffer_store_dwordx4 v[226:229], v254, s[48:51], s28 offen offset:1536 sc1
    s_waitcnt lgkmcnt(2)
    v_mfma_f32_16x16x32_bf16 v[18:21], v[218:221], v[170:173], v[18:21]
    ds_read_b128 v[214:217], v252 offset:1024
    v_mul_f32 v230, v2, v2
    v_mfma_f32_16x16x32_bf16 v[22:25], v[218:221], v[174:177], v[22:25]
    v_mul_f32 v231, v3, v3
    v_mul_f32 v232, v4, v4
    s_waitcnt lgkmcnt(2)
    v_mfma_f32_16x16x32_bf16 v[26:29], v[222:225], v[170:173], v[26:29]
    ds_read_b128 v[218:221], v252 offset:2048
    s_add_u32 m0, s17, 0x4000
    s_add_u32 s13, s21, 0xd000
    buffer_load_dwordx4 v1, s[32:35], s13 offen lds
    v_mfma_f32_16x16x32_bf16 v[30:33], v[222:225], v[174:177], v[30:33]
    v_mul_f32 v233, v5, v5
    v_fma_f32 v230, v230, v248, v246
    v_fma_f32 v231, v231, v248, v246
    s_waitcnt lgkmcnt(2)
    v_mfma_f32_16x16x32_bf16 v[18:21], v[210:213], v[178:181], v[18:21]
    ds_read_b128 v[222:225], v252 offset:3072
    v_fma_f32 v232, v232, v248, v246
    v_mfma_f32_16x16x32_bf16 v[22:25], v[210:213], v[182:185], v[22:25]
    v_fma_f32 v233, v233, v248, v246
    v_mul_f32 v230, v230, v2
    s_waitcnt lgkmcnt(2)
    v_mfma_f32_16x16x32_bf16 v[26:29], v[214:217], v[178:181], v[26:29]
    ds_read_b128 v[210:213], v252 offset:4096
    v_mul_f32 v231, v231, v3
    v_mfma_f32_16x16x32_bf16 v[30:33], v[214:217], v[182:185], v[30:33]
    v_mul_f32 v232, v232, v4
    v_mul_f32 v233, v233, v5
    s_waitcnt lgkmcnt(2)
    v_mfma_f32_16x16x32_bf16 v[18:21], v[218:221], v[186:189], v[18:21]
    ds_read_b128 v[214:217], v252 offset:5120
    s_add_u32 m0, s17, 0x6000
    s_add_u32 s13, s21, 0xf000
    buffer_load_dwordx4 v1, s[32:35], s13 offen lds
    v_mfma_f32_16x16x32_bf16 v[22:25], v[218:221], v[190:193], v[22:25]
    v_exp_f32 v230, v230
    v_mul_f32 v2, v2, v10
    v_exp_f32 v231, v231
    s_waitcnt lgkmcnt(2)
    v_mfma_f32_16x16x32_bf16 v[26:29], v[222:225], v[186:189], v[26:29]
    ds_read_b128 v[218:221], v252 offset:6144
    v_mul_f32 v3, v3, v11
    v_mfma_f32_16x16x32_bf16 v[30:33], v[222:225], v[190:193], v[30:33]
    v_exp_f32 v232, v232
    v_mul_f32 v4, v4, v12
    s_waitcnt lgkmcnt(2)
    v_mfma_f32_16x16x32_bf16 v[18:21], v[210:213], v[194:197], v[18:21]
    ds_read_b128 v[222:225], v252 offset:7168
    v_exp_f32 v233, v233
    v_mfma_f32_16x16x32_bf16 v[22:25], v[210:213], v[198:201], v[22:25]
    v_mul_f32 v5, v5, v13
    v_fma_f32 v230, v230, v250, v250
    s_waitcnt lgkmcnt(2)
    v_mfma_f32_16x16x32_bf16 v[26:29], v[214:217], v[194:197], v[26:29]
    ds_read_b128 v[210:213], v252 offset:8192
    s_add_u32 m0, s18, 0
    s_add_u32 s13, s24, 0x9000
    s_mov_b32 exec_hi, 0
    buffer_load_dwordx4 v1, s[32:35], s13 offen lds
    s_mov_b32 exec_hi, -1
    v_mfma_f32_16x16x32_bf16 v[30:33], v[214:217], v[198:201], v[30:33]
    v_fma_f32 v231, v231, v250, v250
    v_fma_f32 v232, v232, v250, v250
    v_fma_f32 v233, v233, v250, v250
    s_waitcnt lgkmcnt(2)
    v_mfma_f32_16x16x32_bf16 v[18:21], v[218:221], v[202:205], v[18:21]
    ds_read_b128 v[214:217], v252 offset:9216
    v_rcp_f32 v230, v230
    v_mfma_f32_16x16x32_bf16 v[22:25], v[218:221], v[206:209], v[22:25]
    v_rcp_f32 v231, v231
    v_rcp_f32 v232, v232
    s_waitcnt lgkmcnt(2)
    v_mfma_f32_16x16x32_bf16 v[26:29], v[222:225], v[202:205], v[26:29]
    ds_read_b128 v[218:221], v252 offset:10240
    v_rcp_f32 v233, v233
    v_mfma_f32_16x16x32_bf16 v[30:33], v[222:225], v[206:209], v[30:33]
    v_mul_f32 v2, v2, v230
    v_mul_f32 v3, v3, v231
    s_waitcnt vmcnt(6)
    v_mfma_f32_16x16x16_bf16 v[34:37], v[234:235], v[242:243], 0
    v_mfma_f32_16x16x16_bf16 v[38:41], v[234:235], v[244:245], 0
    v_mfma_f32_16x16x16_bf16 v[42:45], v[236:237], v[242:243], 0
    v_mfma_f32_16x16x16_bf16 v[46:49], v[236:237], v[244:245], 0
    s_waitcnt lgkmcnt(2)
    v_mfma_f32_16x16x32_bf16 v[34:37], v[210:213], v[66:69], v[34:37]
    ds_read_b128 v[222:225], v252 offset:11264
    v_mul_f32 v4, v4, v232
    v_mfma_f32_16x16x32_bf16 v[38:41], v[210:213], v[70:73], v[38:41]
    v_mul_f32 v5, v5, v233
    v_cvt_pk_bf16_f32 v226, v2, v3
    s_waitcnt lgkmcnt(2)
    v_mfma_f32_16x16x32_bf16 v[42:45], v[214:217], v[66:69], v[42:45]
    ds_read_b128 v[210:213], v252 offset:12288
    v_cvt_pk_bf16_f32 v227, v4, v5
    v_mfma_f32_16x16x32_bf16 v[46:49], v[214:217], v[70:73], v[46:49]
    v_mul_f32 v230, v6, v6
    v_mul_f32 v231, v7, v7
    s_waitcnt lgkmcnt(2)
    v_mfma_f32_16x16x32_bf16 v[34:37], v[218:221], v[74:77], v[34:37]
    ds_read_b128 v[214:217], v252 offset:13312
    v_mul_f32 v232, v8, v8
    v_mfma_f32_16x16x32_bf16 v[38:41], v[218:221], v[78:81], v[38:41]
    v_mul_f32 v233, v9, v9
    v_fma_f32 v230, v230, v249, v247
    s_waitcnt lgkmcnt(2)
    v_mfma_f32_16x16x32_bf16 v[42:45], v[222:225], v[74:77], v[42:45]
    ds_read_b128 v[218:221], v252 offset:14336
    v_fma_f32 v231, v231, v249, v247
    v_mfma_f32_16x16x32_bf16 v[46:49], v[222:225], v[78:81], v[46:49]
    v_fma_f32 v232, v232, v249, v247
    v_fma_f32 v233, v233, v249, v247
    s_waitcnt lgkmcnt(2)
    v_mfma_f32_16x16x32_bf16 v[34:37], v[210:213], v[82:85], v[34:37]
    ds_read_b128 v[222:225], v252 offset:15360
    v_mul_f32 v230, v230, v6
    v_mfma_f32_16x16x32_bf16 v[38:41], v[210:213], v[86:89], v[38:41]
    v_mul_f32 v231, v231, v7
    v_mul_f32 v232, v232, v8
    s_waitcnt lgkmcnt(2)
    v_mfma_f32_16x16x32_bf16 v[42:45], v[214:217], v[82:85], v[42:45]
    ds_read_b128 v[210:213], v252 offset:16384
    v_mul_f32 v233, v233, v9
    v_mfma_f32_16x16x32_bf16 v[46:49], v[214:217], v[86:89], v[46:49]
    v_exp_f32 v230, v230
    v_mul_f32 v6, v6, v14
    s_waitcnt lgkmcnt(2)
    v_mfma_f32_16x16x32_bf16 v[34:37], v[218:221], v[90:93], v[34:37]
    ds_read_b128 v[214:217], v252 offset:17408
    v_exp_f32 v231, v231
    v_mfma_f32_16x16x32_bf16 v[38:41], v[218:221], v[94:97], v[38:41]
    v_mul_f32 v7, v7, v15
    v_exp_f32 v232, v232
    s_waitcnt lgkmcnt(2)
    v_mfma_f32_16x16x32_bf16 v[42:45], v[222:225], v[90:93], v[42:45]
    ds_read_b128 v[218:221], v252 offset:18432
    v_mul_f32 v8, v8, v16
    v_mfma_f32_16x16x32_bf16 v[46:49], v[222:225], v[94:97], v[46:49]
    v_exp_f32 v233, v233
    v_mul_f32 v9, v9, v17
    s_waitcnt lgkmcnt(2)
    v_mfma_f32_16x16x32_bf16 v[34:37], v[210:213], v[98:101], v[34:37]
    ds_read_b128 v[222:225], v252 offset:19456
    v_fma_f32 v230, v230, v251, v251
    v_mfma_f32_16x16x32_bf16 v[38:41], v[210:213], v[102:105], v[38:41]
    v_fma_f32 v231, v231, v251, v251
    v_fma_f32 v232, v232, v251, v251
    s_waitcnt lgkmcnt(2)
    v_mfma_f32_16x16x32_bf16 v[42:45], v[214:217], v[98:101], v[42:45]
    ds_read_b128 v[210:213], v252 offset:20480
    v_fma_f32 v233, v233, v251, v251
    v_mfma_f32_16x16x32_bf16 v[46:49], v[214:217], v[102:105], v[46:49]
    v_rcp_f32 v230, v230
    v_rcp_f32 v231, v231
    s_waitcnt lgkmcnt(2)
    v_mfma_f32_16x16x32_bf16 v[34:37], v[218:221], v[106:109], v[34:37]
    ds_read_b128 v[214:217], v252 offset:21504
    v_rcp_f32 v232, v232
    v_mfma_f32_16x16x32_bf16 v[38:41], v[218:221], v[110:113], v[38:41]
    v_rcp_f32 v233, v233
    v_mul_f32 v6, v6, v230
    s_waitcnt lgkmcnt(2)
    v_mfma_f32_16x16x32_bf16 v[42:45], v[222:225], v[106:109], v[42:45]
    ds_read_b128 v[218:221], v252 offset:22528
    v_mul_f32 v7, v7, v231
    v_mfma_f32_16x16x32_bf16 v[46:49], v[222:225], v[110:113], v[46:49]
    v_mul_f32 v8, v8, v232
    v_mul_f32 v9, v9, v233
    s_waitcnt lgkmcnt(2)
    v_mfma_f32_16x16x32_bf16 v[34:37], v[210:213], v[114:117], v[34:37]
    ds_read_b128 v[222:225], v252 offset:23552
    v_cvt_pk_bf16_f32 v228, v6, v7
    v_mfma_f32_16x16x32_bf16 v[38:41], v[210:213], v[118:121], v[38:41]
    v_cvt_pk_bf16_f32 v229, v8, v9
    v_permlane32_swap_b32 v226, v228
    s_waitcnt lgkmcnt(2)
    v_mfma_f32_16x16x32_bf16 v[42:45], v[214:217], v[114:117], v[42:45]
    ds_read_b128 v[210:213], v252 offset:24576
    v_permlane32_swap_b32 v227, v229
    v_mfma_f32_16x16x32_bf16 v[46:49], v[214:217], v[118:121], v[46:49]
    buffer_store_dwordx4 v[226:229], v254, s[48:51], s29 offen sc1
    v_mul_f32 v230, v18, v18
    s_waitcnt lgkmcnt(2)
    v_mfma_f32_16x16x32_bf16 v[34:37], v[218:221], v[122:125], v[34:37]
    ds_read_b128 v[214:217], v252 offset:25600
    v_mul_f32 v231, v19, v19
    v_mfma_f32_16x16x32_bf16 v[38:41], v[218:221], v[126:129], v[38:41]
    v_mul_f32 v232, v20, v20
    v_mul_f32 v233, v21, v21
    s_waitcnt lgkmcnt(2)
    v_mfma_f32_16x16x32_bf16 v[42:45], v[222:225], v[122:125], v[42:45]
    ds_read_b128 v[218:221], v252 offset:26624
    v_fma_f32 v230, v230, v248, v246
    v_mfma_f32_16x16x32_bf16 v[46:49], v[222:225], v[126:129], v[46:49]
    v_fma_f32 v231, v231, v248, v246
    v_fma_f32 v232, v232, v248, v246
    s_waitcnt lgkmcnt(2)
    v_mfma_f32_16x16x32_bf16 v[34:37], v[210:213], v[130:133], v[34:37]
    ds_read_b128 v[222:225], v252 offset:27648
    buffer_load_dwordx2 v[238:239], v255, s[40:43], s27 offen
    buffer_load_dwordx2 v[240:241], v255, s[40:43], s27 offen offset:64
    v_mfma_f32_16x16x32_bf16 v[38:41], v[210:213], v[134:137], v[38:41]
    v_fma_f32 v233, v233, v248, v246
    v_mul_f32 v230, v230, v18
    v_mul_f32 v231, v231, v19
    s_waitcnt lgkmcnt(2)
    v_mfma_f32_16x16x32_bf16 v[42:45], v[214:217], v[130:133], v[42:45]
    ds_read_b128 v[210:213], v252 offset:28672
    v_mul_f32 v232, v232, v20
    v_mfma_f32_16x16x32_bf16 v[46:49], v[214:217], v[134:137], v[46:49]
    v_mul_f32 v233, v233, v21
    v_exp_f32 v230, v230
    s_waitcnt lgkmcnt(2)
    v_mfma_f32_16x16x32_bf16 v[34:37], v[218:221], v[138:141], v[34:37]
    ds_read_b128 v[214:217], v252 offset:29696
    v_mul_f32 v18, v18, v26
    v_mfma_f32_16x16x32_bf16 v[38:41], v[218:221], v[142:145], v[38:41]
    v_exp_f32 v231, v231
    v_mul_f32 v19, v19, v27
    s_waitcnt lgkmcnt(2)
    v_mfma_f32_16x16x32_bf16 v[42:45], v[222:225], v[138:141], v[42:45]
    ds_read_b128 v[218:221], v252 offset:30720
    v_exp_f32 v232, v232
    v_mfma_f32_16x16x32_bf16 v[46:49], v[222:225], v[142:145], v[46:49]
    v_mul_f32 v20, v20, v28
    v_exp_f32 v233, v233
    s_waitcnt lgkmcnt(2)
    v_mfma_f32_16x16x32_bf16 v[34:37], v[210:213], v[146:149], v[34:37]
    ds_read_b128 v[222:225], v252 offset:31744
    v_mul_f32 v21, v21, v29
    v_mfma_f32_16x16x32_bf16 v[38:41], v[210:213], v[150:153], v[38:41]
    v_fma_f32 v230, v230, v250, v250
    v_fma_f32 v231, v231, v250, v250
    s_barrier
    s_waitcnt lgkmcnt(2)
    v_mfma_f32_16x16x32_bf16 v[42:45], v[214:217], v[146:149], v[42:45]
    ds_read_b128 v[210:213], v252 offset:32768
    s_add_u32 m0, s17, 0x9000
    s_add_u32 s13, s70, 0
    buffer_load_dwordx4 v1, s[56:59], s13 offen lds
    v_mfma_f32_16x16x32_bf16 v[46:49], v[214:217], v[150:153], v[46:49]
    v_fma_f32 v232, v232, v250, v250
    v_fma_f32 v233, v233, v250, v250
    v_rcp_f32 v230, v230
    s_waitcnt lgkmcnt(2)
    v_mfma_f32_16x16x32_bf16 v[34:37], v[218:221], v[154:157], v[34:37]
    ds_read_b128 v[214:217], v252 offset:33792
    v_rcp_f32 v231, v231
    v_mfma_f32_16x16x32_bf16 v[38:41], v[218:221], v[158:161], v[38:41]
    v_rcp_f32 v232, v232
    v_rcp_f32 v233, v233
    s_waitcnt lgkmcnt(2)
    v_mfma_f32_16x16x32_bf16 v[42:45], v[222:225], v[154:157], v[42:45]
    ds_read_b128 v[218:221], v252 offset:34816
    v_mul_f32 v18, v18, v230
    v_mfma_f32_16x16x32_bf16 v[46:49], v[222:225], v[158:161], v[46:49]
    v_mul_f32 v19, v19, v231
    v_mul_f32 v20, v20, v232
    s_waitcnt lgkmcnt(2)
    v_mfma_f32_16x16x32_bf16 v[34:37], v[210:213], v[162:165], v[34:37]
    ds_read_b128 v[222:225], v252 offset:35840
    s_add_u32 m0, s17, 0xb000
    s_add_u32 s13, s70, 0x2000
    buffer_load_dwordx4 v1, s[56:59], s13 offen lds
    v_mfma_f32_16x16x32_bf16 v[38:41], v[210:213], v[166:169], v[38:41]
    v_mul_f32 v21, v21, v233
    v_cvt_pk_bf16_f32 v226, v18, v19
    v_cvt_pk_bf16_f32 v227, v20, v21
    s_waitcnt lgkmcnt(2)
    v_mfma_f32_16x16x32_bf16 v[42:45], v[214:217], v[162:165], v[42:45]
    ds_read_b128 v[210:213], v252 offset:36864
    v_mul_f32 v230, v22, v22
    v_mfma_f32_16x16x32_bf16 v[46:49], v[214:217], v[166:169], v[46:49]
    v_mul_f32 v231, v23, v23
    v_mul_f32 v232, v24, v24
    s_waitcnt lgkmcnt(2)
    v_mfma_f32_16x16x32_bf16 v[34:37], v[218:221], v[170:173], v[34:37]
    ds_read_b128 v[214:217], v252 offset:37888
    v_mul_f32 v233, v25, v25
    v_mfma_f32_16x16x32_bf16 v[38:41], v[218:221], v[174:177], v[38:41]
    v_fma_f32 v230, v230, v249, v247
    v_fma_f32 v231, v231, v249, v247
    s_waitcnt lgkmcnt(2)
    v_mfma_f32_16x16x32_bf16 v[42:45], v[222:225], v[170:173], v[42:45]
    ds_read_b128 v[218:221], v252 offset:38912
    s_add_u32 m0, s17, 0xd000
    s_add_u32 s13, s70, 0x4000
    buffer_load_dwordx4 v1, s[56:59], s13 offen lds
    v_mfma_f32_16x16x32_bf16 v[46:49], v[222:225], v[174:177], v[46:49]
    v_fma_f32 v232, v232, v249, v247
    v_fma_f32 v233, v233, v249, v247
    v_mul_f32 v230, v230, v22
    s_waitcnt lgkmcnt(2)
    v_mfma_f32_16x16x32_bf16 v[34:37], v[210:213], v[178:181], v[34:37]
    ds_read_b128 v[222:225], v252 offset:39936
    s_waitcnt vmcnt(9)
    s_lshl_b32 s13, s9, 2
    s_add_u32 s13, s13, s75
    s_mov_b64 exec, 1
    buffer_store_dword v1, v1, s[64:67], s13 offen sc1
    s_mov_b64 exec, -1
    v_mfma_f32_16x16x32_bf16 v[38:41], v[210:213], v[182:185], v[38:41]
    v_mul_f32 v231, v231, v23
    v_mul_f32 v232, v232, v24
    s_waitcnt lgkmcnt(2)
    v_mfma_f32_16x16x32_bf16 v[42:45], v[214:217], v[178:181], v[42:45]
    ds_read_b128 v[210:213], v252 offset:40960
    v_mul_f32 v233, v233, v25
    v_mfma_f32_16x16x32_bf16 v[46:49], v[214:217], v[182:185], v[46:49]
    v_exp_f32 v230, v230
    s_waitcnt lgkmcnt(2)
    v_mfma_f32_16x16x32_bf16 v[34:37], v[218:221], v[186:189], v[34:37]
    ds_read_b128 v[214:217], v252 offset:41984
    s_add_u32 m0, s17, 0xf000
    s_add_u32 s13, s70, 0x6000
    buffer_load_dwordx4 v1, s[56:59], s13 offen lds
    v_mfma_f32_16x16x32_bf16 v[38:41], v[218:221], v[190:193], v[38:41]
    v_mul_f32 v22, v22, v30
    v_exp_f32 v231, v231
    s_waitcnt lgkmcnt(2)
    v_mfma_f32_16x16x32_bf16 v[42:45], v[222:225], v[186:189], v[42:45]
    ds_read_b128 v[218:221], v252 offset:43008
    v_mul_f32 v23, v23, v31
    v_mfma_f32_16x16x32_bf16 v[46:49], v[222:225], v[190:193], v[46:49]
    v_exp_f32 v232, v232
    s_waitcnt lgkmcnt(2)
    v_mfma_f32_16x16x32_bf16 v[34:37], v[210:213], v[194:197], v[34:37]
    ds_read_b128 v[222:225], v252 offset:44032
    v_mul_f32 v24, v24, v32
    v_mfma_f32_16x16x32_bf16 v[38:41], v[210:213], v[198:201], v[38:41]
    v_exp_f32 v233, v233
    s_waitcnt lgkmcnt(2)
    v_mfma_f32_16x16x32_bf16 v[42:45], v[214:217], v[194:197], v[42:45]
    ds_read_b128 v[210:213], v252 offset:45056
    s_add_u32 m0, s18, 0x9000
    s_add_u32 s13, s71, 0
    s_mov_b32 exec_hi, 0
    buffer_load_dwordx4 v1, s[56:59], s13 offen lds
    s_mov_b32 exec_hi, -1
    v_mfma_f32_16x16x32_bf16 v[46:49], v[214:217], v[198:201], v[46:49]
    v_mul_f32 v25, v25, v33
    v_fma_f32 v230, v230, v251, v251
    s_waitcnt lgkmcnt(2)
    v_mfma_f32_16x16x32_bf16 v[34:37], v[218:221], v[202:205], v[34:37]
    ds_read_b128 v[214:217], v252 offset:46080
    v_fma_f32 v231, v231, v251, v251
    v_mfma_f32_16x16x32_bf16 v[38:41], v[218:221], v[206:209], v[38:41]
    v_fma_f32 v232, v232, v251, v251
    s_waitcnt lgkmcnt(2)
    v_mfma_f32_16x16x32_bf16 v[42:45], v[222:225], v[202:205], v[42:45]
    ds_read_b128 v[218:221], v252 offset:47104
    v_fma_f32 v233, v233, v251, v251
    v_mfma_f32_16x16x32_bf16 v[46:49], v[222:225], v[206:209], v[46:49]
    v_rcp_f32 v230, v230
    s_waitcnt vmcnt(6)
    v_mfma_f32_16x16x16_bf16 v[50:53], v[238:239], v[242:243], 0
    v_mfma_f32_16x16x16_bf16 v[54:57], v[238:239], v[244:245], 0
    v_mfma_f32_16x16x16_bf16 v[58:61], v[240:241], v[242:243], 0
    v_mfma_f32_16x16x16_bf16 v[62:65], v[240:241], v[244:245], 0
    s_waitcnt lgkmcnt(2)
    v_mfma_f32_16x16x32_bf16 v[50:53], v[210:213], v[66:69], v[50:53]
    ds_read_b128 v[222:225], v252 offset:48128
    v_rcp_f32 v231, v231
    v_mfma_f32_16x16x32_bf16 v[54:57], v[210:213], v[70:73], v[54:57]
    v_rcp_f32 v232, v232
    s_waitcnt lgkmcnt(2)
    v_mfma_f32_16x16x32_bf16 v[58:61], v[214:217], v[66:69], v[58:61]
    ds_read_b128 v[210:213], v252 offset:49152
    v_rcp_f32 v233, v233
    v_mfma_f32_16x16x32_bf16 v[62:65], v[214:217], v[70:73], v[62:65]
    v_mul_f32 v22, v22, v230
    v_mul_f32 v23, v23, v231
    s_waitcnt lgkmcnt(2)
    v_mfma_f32_16x16x32_bf16 v[50:53], v[218:221], v[74:77], v[50:53]
    ds_read_b128 v[214:217], v252 offset:50176
    v_mul_f32 v24, v24, v232
    v_mfma_f32_16x16x32_bf16 v[54:57], v[218:221], v[78:81], v[54:57]
    v_mul_f32 v25, v25, v233
    v_cvt_pk_bf16_f32 v228, v22, v23
    s_waitcnt lgkmcnt(2)
    v_mfma_f32_16x16x32_bf16 v[58:61], v[222:225], v[74:77], v[58:61]
    ds_read_b128 v[218:221], v252 offset:51200
    s_lshr_b32 s13, s2, 3
    s_and_b32 s13, s13, 7
    s_lshl_b32 s13, s13, 3
    s_add_u32 s13, s13, s12
    s_min_u32 s13, s13, 27
    s_lshl_b32 s13, s13, 13
    s_add_u32 s13, s13, s69
    s_add_u32 s13, s13, 0x19000
    v_lshlrev_b32 v240, 3, v1
    buffer_load_dword v241, v240, s[56:59], s13 offen
    v_mfma_f32_16x16x32_bf16 v[62:65], v[222:225], v[78:81], v[62:65]
    v_cvt_pk_bf16_f32 v229, v24, v25
    v_permlane32_swap_b32 v226, v228
    s_nop 0
    v_permlane32_swap_b32 v227, v229
    s_waitcnt lgkmcnt(2)
    v_mfma_f32_16x16x32_bf16 v[50:53], v[210:213], v[82:85], v[50:53]
    ds_read_b128 v[222:225], v252 offset:52224
    v_lshrrev_b32 v238, 2, v1
    v_and_b32 v238, 28, v238
    v_mfma_f32_16x16x32_bf16 v[54:57], v[210:213], v[86:89], v[54:57]
    buffer_store_dwordx4 v[226:229], v254, s[48:51], s29 offen offset:512 sc1
    v_mul_f32 v230, v34, v34
    v_mul_f32 v231, v35, v35
    s_waitcnt lgkmcnt(2)
    v_mfma_f32_16x16x32_bf16 v[58:61], v[214:217], v[82:85], v[58:61]
    ds_read_b128 v[210:213], v252 offset:53248
    v_mul_f32 v232, v36, v36
    v_mfma_f32_16x16x32_bf16 v[62:65], v[214:217], v[86:89], v[62:65]
    v_mul_f32 v233, v37, v37
    v_fma_f32 v230, v230, v248, v246
    s_waitcnt lgkmcnt(2)
    v_mfma_f32_16x16x32_bf16 v[50:53], v[218:221], v[90:93], v[50:53]
    ds_read_b128 v[214:217], v252 offset:54272
    v_fma_f32 v231, v231, v248, v246
    v_mfma_f32_16x16x32_bf16 v[54:57], v[218:221], v[94:97], v[54:57]
    v_fma_f32 v232, v232, v248, v246
    v_fma_f32 v233, v233, v248, v246
    s_waitcnt lgkmcnt(2)
    v_mfma_f32_16x16x32_bf16 v[58:61], v[222:225], v[90:93], v[58:61]
    ds_read_b128 v[218:221], v252 offset:55296
    v_mul_f32 v230, v230, v34
    v_mfma_f32_16x16x32_bf16 v[62:65], v[222:225], v[94:97], v[62:65]
    v_mul_f32 v231, v231, v35
    v_mul_f32 v232, v232, v36
    s_waitcnt lgkmcnt(2)
    v_mfma_f32_16x16x32_bf16 v[50:53], v[210:213], v[98:101], v[50:53]
    ds_read_b128 v[222:225], v252 offset:56320
    v_mul_f32 v233, v233, v37
    v_mfma_f32_16x16x32_bf16 v[54:57], v[210:213], v[102:105], v[54:57]
    v_exp_f32 v230, v230
    v_mul_f32 v34, v34, v42
    s_waitcnt lgkmcnt(2)
    v_mfma_f32_16x16x32_bf16 v[58:61], v[214:217], v[98:101], v[58:61]
    ds_read_b128 v[210:213], v252 offset:57344
    v_exp_f32 v231, v231
    v_mfma_f32_16x16x32_bf16 v[62:65], v[214:217], v[102:105], v[62:65]
    v_mul_f32 v35, v35, v43
    v_exp_f32 v232, v232
    s_waitcnt lgkmcnt(2)
    v_mfma_f32_16x16x32_bf16 v[50:53], v[218:221], v[106:109], v[50:53]
    ds_read_b128 v[214:217], v252 offset:58368
    v_mul_f32 v36, v36, v44
    v_mfma_f32_16x16x32_bf16 v[54:57], v[218:221], v[110:113], v[54:57]
    v_exp_f32 v233, v233
    v_mul_f32 v37, v37, v45
    s_waitcnt lgkmcnt(2)
    v_mfma_f32_16x16x32_bf16 v[58:61], v[222:225], v[106:109], v[58:61]
    ds_read_b128 v[218:221], v252 offset:59392
    v_fma_f32 v230, v230, v250, v250
    v_mfma_f32_16x16x32_bf16 v[62:65], v[222:225], v[110:113], v[62:65]
    v_fma_f32 v231, v231, v250, v250
    v_fma_f32 v232, v232, v250, v250
    s_waitcnt lgkmcnt(2)
    v_mfma_f32_16x16x32_bf16 v[50:53], v[210:213], v[114:117], v[50:53]
    ds_read_b128 v[222:225], v252 offset:60416
    v_fma_f32 v233, v233, v250, v250
    v_mfma_f32_16x16x32_bf16 v[54:57], v[210:213], v[118:121], v[54:57]
    v_rcp_f32 v230, v230
    v_rcp_f32 v231, v231
    s_waitcnt lgkmcnt(2)
    v_mfma_f32_16x16x32_bf16 v[58:61], v[214:217], v[114:117], v[58:61]
    ds_read_b128 v[210:213], v252 offset:61440
    v_rcp_f32 v232, v232
    v_mfma_f32_16x16x32_bf16 v[62:65], v[214:217], v[118:121], v[62:65]
    v_rcp_f32 v233, v233
    v_mul_f32 v34, v34, v230
    s_waitcnt lgkmcnt(2)
    v_mfma_f32_16x16x32_bf16 v[50:53], v[218:221], v[122:125], v[50:53]
    ds_read_b128 v[214:217], v252 offset:62464
    v_mul_f32 v35, v35, v231
    v_mfma_f32_16x16x32_bf16 v[54:57], v[218:221], v[126:129], v[54:57]
    v_mul_f32 v36, v36, v232
    v_mul_f32 v37, v37, v233
    s_waitcnt lgkmcnt(2)
    v_mfma_f32_16x16x32_bf16 v[58:61], v[222:225], v[122:125], v[58:61]
    ds_read_b128 v[218:221], v252 offset:63488
    v_cvt_pk_bf16_f32 v226, v34, v35
    v_mfma_f32_16x16x32_bf16 v[62:65], v[222:225], v[126:129], v[62:65]
    v_cvt_pk_bf16_f32 v227, v36, v37
    v_mul_f32 v230, v38, v38
    s_waitcnt lgkmcnt(2)
    v_mfma_f32_16x16x32_bf16 v[50:53], v[210:213], v[130:133], v[50:53]
    ds_read_b128 v[222:225], v252 offset:64512
    buffer_load_dwordx2 v[234:235], v255, s[40:43], s27 offen offset:512
    buffer_load_dwordx2 v[236:237], v255, s[40:43], s27 offen offset:576
    v_mfma_f32_16x16x32_bf16 v[54:57], v[210:213], v[134:137], v[54:57]
    v_mul_f32 v231, v39, v39
    v_mul_f32 v232, v40, v40
    v_mul_f32 v233, v41, v41
    s_waitcnt lgkmcnt(2)
    v_mfma_f32_16x16x32_bf16 v[58:61], v[214:217], v[130:133], v[58:61]
    ds_read_b128 v[210:213], v253
    v_fma_f32 v230, v230, v249, v247
    v_mfma_f32_16x16x32_bf16 v[62:65], v[214:217], v[134:137], v[62:65]
    v_fma_f32 v231, v231, v249, v247
    v_fma_f32 v232, v232, v249, v247
    s_waitcnt lgkmcnt(2)
    v_mfma_f32_16x16x32_bf16 v[50:53], v[218:221], v[138:141], v[50:53]
    ds_read_b128 v[214:217], v253 offset:1024
    v_fma_f32 v233, v233, v249, v247
    v_mfma_f32_16x16x32_bf16 v[54:57], v[218:221], v[142:145], v[54:57]
    v_mul_f32 v230, v230, v38
    v_mul_f32 v231, v231, v39
    s_waitcnt lgkmcnt(2)
    v_mfma_f32_16x16x32_bf16 v[58:61], v[222:225], v[138:141], v[58:61]
    ds_read_b128 v[218:221], v253 offset:2048
    v_mul_f32 v232, v232, v40
    v_mfma_f32_16x16x32_bf16 v[62:65], v[222:225], v[142:145], v[62:65]
    v_mul_f32 v233, v233, v41
    v_exp_f32 v230, v230
    s_waitcnt lgkmcnt(2)
    v_mfma_f32_16x16x32_bf16 v[50:53], v[210:213], v[146:149], v[50:53]
    ds_read_b128 v[222:225], v253 offset:3072
    v_mul_f32 v38, v38, v46
    v_mfma_f32_16x16x32_bf16 v[54:57], v[210:213], v[150:153], v[54:57]
    v_exp_f32 v231, v231
    v_mul_f32 v39, v39, v47
    s_barrier
    s_waitcnt lgkmcnt(2)
    v_mfma_f32_16x16x32_bf16 v[58:61], v[214:217], v[146:149], v[58:61]
    ds_read_b128 v[210:213], v253 offset:4096
    s_add_u32 m0, s17, 0x12000
    s_add_u32 s13, s70, 0x9000
    buffer_load_dwordx4 v1, s[56:59], s13 offen lds
    v_mfma_f32_16x16x32_bf16 v[62:65], v[214:217], v[150:153], v[62:65]
    v_exp_f32 v232, v232
    v_mul_f32 v40, v40, v48
    v_exp_f32 v233, v233
    s_waitcnt lgkmcnt(2)
    v_mfma_f32_16x16x32_bf16 v[50:53], v[218:221], v[154:157], v[50:53]
    ds_read_b128 v[214:217], v253 offset:5120
    v_mul_f32 v41, v41, v49
    v_mfma_f32_16x16x32_bf16 v[54:57], v[218:221], v[158:161], v[54:57]
    v_fma_f32 v230, v230, v251, v251
    v_fma_f32 v231, v231, v251, v251
    s_waitcnt lgkmcnt(2)
    v_mfma_f32_16x16x32_bf16 v[58:61], v[222:225], v[154:157], v[58:61]
    ds_read_b128 v[218:221], v253 offset:6144
    v_fma_f32 v232, v232, v251, v251
    v_mfma_f32_16x16x32_bf16 v[62:65], v[222:225], v[158:161], v[62:65]
    v_fma_f32 v233, v233, v251, v251
    v_rcp_f32 v230, v230
    s_waitcnt lgkmcnt(2)
    v_mfma_f32_16x16x32_bf16 v[50:53], v[210:213], v[162:165], v[50:53]
    ds_read_b128 v[222:225], v253 offset:7168
    s_add_u32 m0, s17, 0x14000
    s_add_u32 s13, s70, 0xb000
    buffer_load_dwordx4 v1, s[56:59], s13 offen lds
    v_mfma_f32_16x16x32_bf16 v[54:57], v[210:213], v[166:169], v[54:57]
    v_rcp_f32 v231, v231
    v_rcp_f32 v232, v232
    v_rcp_f32 v233, v233
    s_waitcnt lgkmcnt(2)
    v_mfma_f32_16x16x32_bf16 v[58:61], v[214:217], v[162:165], v[58:61]
    ds_read_b128 v[210:213], v253 offset:8192
    v_mul_f32 v38, v38, v230
    v_mfma_f32_16x16x32_bf16 v[62:65], v[214:217], v[166:169], v[62:65]
    v_mul_f32 v39, v39, v231
    v_mul_f32 v40, v40, v232
    s_waitcnt lgkmcnt(2)
    v_mfma_f32_16x16x32_bf16 v[50:53], v[218:221], v[170:173], v[50:53]
    ds_read_b128 v[214:217], v253 offset:9216
    v_mul_f32 v41, v41, v233
    v_mfma_f32_16x16x32_bf16 v[54:57], v[218:221], v[174:177], v[54:57]
    v_cvt_pk_bf16_f32 v228, v38, v39
    v_cvt_pk_bf16_f32 v229, v40, v41
    s_waitcnt lgkmcnt(2)
    v_mfma_f32_16x16x32_bf16 v[58:61], v[222:225], v[170:173], v[58:61]
    ds_read_b128 v[218:221], v253 offset:10240
    s_add_u32 m0, s17, 0x16000
    s_add_u32 s13, s70, 0xd000
    buffer_load_dwordx4 v1, s[56:59], s13 offen lds
    v_mfma_f32_16x16x32_bf16 v[62:65], v[222:225], v[174:177], v[62:65]
    v_permlane32_swap_b32 v226, v228
    v_permlane32_swap_b32 v227, v229
    buffer_store_dwordx4 v[226:229], v254, s[48:51], s29 offen offset:1024 sc1
    s_waitcnt lgkmcnt(2)
    v_mfma_f32_16x16x32_bf16 v[50:53], v[210:213], v[178:181], v[50:53]
    ds_read_b128 v[222:225], v253 offset:11264
    v_mfma_f32_16x16x32_bf16 v[54:57], v[210:213], v[182:185], v[54:57]
    s_waitcnt lgkmcnt(2)
    v_mfma_f32_16x16x32_bf16 v[58:61], v[214:217], v[178:181], v[58:61]
    ds_read_b128 v[210:213], v253 offset:12288
    v_mfma_f32_16x16x32_bf16 v[62:65], v[214:217], v[182:185], v[62:65]
    s_waitcnt lgkmcnt(2)
    v_mfma_f32_16x16x32_bf16 v[50:53], v[218:221], v[186:189], v[50:53]
    ds_read_b128 v[214:217], v253 offset:13312
    s_add_u32 m0, s17, 0x18000
    s_add_u32 s13, s70, 0xf000
    buffer_load_dwordx4 v1, s[56:59], s13 offen lds
    v_mfma_f32_16x16x32_bf16 v[54:57], v[218:221], v[190:193], v[54:57]
    s_waitcnt lgkmcnt(2)
    v_mfma_f32_16x16x32_bf16 v[58:61], v[222:225], v[186:189], v[58:61]
    ds_read_b128 v[218:221], v253 offset:14336
    v_mfma_f32_16x16x32_bf16 v[62:65], v[222:225], v[190:193], v[62:65]
    s_waitcnt lgkmcnt(2)
    v_mfma_f32_16x16x32_bf16 v[50:53], v[210:213], v[194:197], v[50:53]
    ds_read_b128 v[222:225], v253 offset:15360
    buffer_load_dword v239, v238, s[64:67], s75 offen
    v_mfma_f32_16x16x32_bf16 v[54:57], v[210:213], v[198:201], v[54:57]
    s_waitcnt lgkmcnt(2)
    v_mfma_f32_16x16x32_bf16 v[58:61], v[214:217], v[194:197], v[58:61]
    ds_read_b128 v[210:213], v1
    s_add_u32 m0, s18, 0x12000
    s_add_u32 s13, s71, 0x9000
    s_mov_b32 exec_hi, 0
    buffer_load_dwordx4 v1, s[56:59], s13 offen lds
    s_mov_b32 exec_hi, -1
    v_mfma_f32_16x16x32_bf16 v[62:65], v[214:217], v[198:201], v[62:65]
    s_waitcnt lgkmcnt(2)
    v_mfma_f32_16x16x32_bf16 v[50:53], v[218:221], v[202:205], v[50:53]
    ds_read_b128 v[214:217], v1 offset:1024
    v_mfma_f32_16x16x32_bf16 v[54:57], v[218:221], v[206:209], v[54:57]
    s_waitcnt lgkmcnt(2)
    v_mfma_f32_16x16x32_bf16 v[58:61], v[222:225], v[202:205], v[58:61]
    ds_read_b128 v[218:221], v1 offset:2048
    v_mfma_f32_16x16x32_bf16 v[62:65], v[222:225], v[206:209], v[62:65]
    s_waitcnt vmcnt(7)
    v_mfma_f32_16x16x16_bf16 v[2:5], v[234:235], v[242:243], 0
    v_mfma_f32_16x16x16_bf16 v[6:9], v[234:235], v[244:245], 0
    v_mfma_f32_16x16x16_bf16 v[10:13], v[236:237], v[242:243], 0
    v_mfma_f32_16x16x16_bf16 v[14:17], v[236:237], v[244:245], 0
    s_waitcnt lgkmcnt(2)
    v_mfma_f32_16x16x32_bf16 v[2:5], v[210:213], v[66:69], v[2:5]
    ds_read_b128 v[222:225], v1 offset:3072
    v_mfma_f32_16x16x32_bf16 v[6:9], v[210:213], v[70:73], v[6:9]
    s_waitcnt lgkmcnt(2)
    v_mfma_f32_16x16x32_bf16 v[10:13], v[214:217], v[66:69], v[10:13]
    ds_read_b128 v[210:213], v1 offset:4096
    v_mul_f32 v230, v50, v50
    v_mfma_f32_16x16x32_bf16 v[14:17], v[214:217], v[70:73], v[14:17]
    v_mul_f32 v231, v51, v51
    v_mul_f32 v232, v52, v52
    s_waitcnt lgkmcnt(2)
    v_mfma_f32_16x16x32_bf16 v[2:5], v[218:221], v[74:77], v[2:5]
    ds_read_b128 v[214:217], v1 offset:5120
    v_mul_f32 v233, v53, v53
    v_mfma_f32_16x16x32_bf16 v[6:9], v[218:221], v[78:81], v[6:9]
    v_fma_f32 v230, v230, v248, v246
    v_fma_f32 v231, v231, v248, v246
    s_waitcnt lgkmcnt(2)
    v_mfma_f32_16x16x32_bf16 v[10:13], v[222:225], v[74:77], v[10:13]
    ds_read_b128 v[218:221], v1 offset:6144
    s_mul_i32 s13, s72, 0x24000
    v_add_u32 v252, s13, v1
    s_sub_u32 s13, 0x24000, s13
    v_add_u32 v253, s13, v1
    v_mfma_f32_16x16x32_bf16 v[14:17], v[222:225], v[78:81], v[14:17]
    v_fma_f32 v232, v232, v248, v246
    v_fma_f32 v233, v233, v248, v246
    v_mul_f32 v230, v230, v50
    s_waitcnt lgkmcnt(2)
    v_mfma_f32_16x16x32_bf16 v[2:5], v[210:213], v[82:85], v[2:5]
    ds_read_b128 v[222:225], v1 offset:7168
    v_mul_f32 v231, v231, v51
    v_mfma_f32_16x16x32_bf16 v[6:9], v[210:213], v[86:89], v[6:9]
    v_mul_f32 v232, v232, v52
    v_mul_f32 v233, v233, v53
    s_waitcnt lgkmcnt(2)
    v_mfma_f32_16x16x32_bf16 v[10:13], v[214:217], v[82:85], v[10:13]
    ds_read_b128 v[210:213], v1 offset:8192
    s_lshl_b32 s13, s73, 12
    s_add_u32 s13, s13, 0x9000
    v_add_u32 v240, s13, v1
    s_sub_u32 s13, 0x13000, s13
    v_add_u32 v241, s13, v1
    v_mfma_f32_16x16x32_bf16 v[14:17], v[214:217], v[86:89], v[14:17]
    v_exp_f32 v230, v230
    v_mul_f32 v50, v50, v58
    v_exp_f32 v231, v231
    s_waitcnt lgkmcnt(2)
    v_mfma_f32_16x16x32_bf16 v[2:5], v[218:221], v[90:93], v[2:5]
    ds_read_b128 v[214:217], v1 offset:9216
    v_mul_f32 v51, v51, v59
    v_mfma_f32_16x16x32_bf16 v[6:9], v[218:221], v[94:97], v[6:9]
    v_exp_f32 v232, v232
    v_mul_f32 v52, v52, v60
    s_waitcnt lgkmcnt(2)
    v_mfma_f32_16x16x32_bf16 v[10:13], v[222:225], v[90:93], v[10:13]
    ds_read_b128 v[218:221], v1 offset:10240
    s_lshl_b32 s13, s73, 4
    v_xor_b32 v234, s13, v1
    v_add_u32 v234, 0x9000, v234
    v_mfma_f32_16x16x32_bf16 v[14:17], v[222:225], v[94:97], v[14:17]
    v_exp_f32 v233, v233
    v_mul_f32 v53, v53, v61
    v_fma_f32 v230, v230, v250, v250
    s_waitcnt lgkmcnt(2)
    v_mfma_f32_16x16x32_bf16 v[2:5], v[210:213], v[98:101], v[2:5]
    ds_read_b128 v[222:225], v1 offset:11264
    v_fma_f32 v231, v231, v250, v250
    v_mfma_f32_16x16x32_bf16 v[6:9], v[210:213], v[102:105], v[6:9]
    v_fma_f32 v232, v232, v250, v250
    v_fma_f32 v233, v233, v250, v250
    s_waitcnt lgkmcnt(2)
    v_mfma_f32_16x16x32_bf16 v[10:13], v[214:217], v[98:101], v[10:13]
    ds_read_b128 v[210:213], v1 offset:12288
    v_rcp_f32 v230, v230
    v_mfma_f32_16x16x32_bf16 v[14:17], v[214:217], v[102:105], v[14:17]
    v_rcp_f32 v231, v231
    v_rcp_f32 v232, v232
    s_waitcnt lgkmcnt(2)
    v_mfma_f32_16x16x32_bf16 v[2:5], v[218:221], v[106:109], v[2:5]
    ds_read_b128 v[214:217], v1 offset:13312
    v_rcp_f32 v233, v233
    v_mfma_f32_16x16x32_bf16 v[6:9], v[218:221], v[110:113], v[6:9]
    v_mul_f32 v50, v50, v230
    v_mul_f32 v51, v51, v231
    s_waitcnt lgkmcnt(2)
    v_mfma_f32_16x16x32_bf16 v[10:13], v[222:225], v[106:109], v[10:13]
    ds_read_b128 v[218:221], v1 offset:14336
    v_mul_f32 v52, v52, v232
    v_mfma_f32_16x16x32_bf16 v[14:17], v[222:225], v[110:113], v[14:17]
    v_mul_f32 v53, v53, v233
    v_cvt_pk_bf16_f32 v226, v50, v51
    s_waitcnt vmcnt(1)
    v_cmp_eq_u32 vcc, -1, v239
    s_nop 1
    s_cmp_eq_u64 vcc, 0
    s_cselect_b32 s86, s76, 0
    s_cmp_eq_u32 s86, 0
    s_cbranch_scc1 L_ff_b
    s_setprio 3
    s_waitcnt lgkmcnt(2)
    v_mfma_f32_16x16x32_bf16 v[2:5], v[210:213], v[114:117], v[2:5]
    ds_read_b128 v[222:225], v1 offset:15360
    s_add_u32 s86, s74, 0
    buffer_load_dwordx4 v[66:69], v252, s[48:51], s86 offen
    v_mfma_f32_16x16x32_bf16 v[6:9], v[210:213], v[118:121], v[6:9]
    v_cvt_pk_bf16_f32 v227, v52, v53
    v_mul_f32 v230, v54, v54
    v_mul_f32 v231, v55, v55
    s_waitcnt lgkmcnt(2)
    v_mfma_f32_16x16x32_bf16 v[10:13], v[214:217], v[114:117], v[10:13]
    ds_read_b128 v[210:213], v1 offset:16384
    buffer_load_dwordx4 v[70:73], v253, s[48:51], s86 offen
    v_mfma_f32_16x16x32_bf16 v[14:17], v[214:217], v[118:121], v[14:17]
    v_mul_f32 v232, v56, v56
    v_mul_f32 v233, v57, v57
    v_fma_f32 v230, v230, v249, v247
    s_waitcnt lgkmcnt(2)
    v_mfma_f32_16x16x32_bf16 v[2:5], v[218:221], v[122:125], v[2:5]
    ds_read_b128 v[214:217], v1 offset:17408
    s_add_u32 s86, s74, 0
    buffer_load_dwordx4 v[74:77], v252, s[48:51], s86 offen offset:1024
    v_mfma_f32_16x16x32_bf16 v[6:9], v[218:221], v[126:129], v[6:9]
    v_fma_f32 v231, v231, v249, v247
    v_fma_f32 v232, v232, v249, v247
    v_fma_f32 v233, v233, v249, v247
    s_waitcnt lgkmcnt(2)
    v_mfma_f32_16x16x32_bf16 v[10:13], v[222:225], v[122:125], v[10:13]
    ds_read_b128 v[218:221], v1 offset:18432
    buffer_load_dwordx4 v[78:81], v253, s[48:51], s86 offen offset:1024
    v_mfma_f32_16x16x32_bf16 v[14:17], v[222:225], v[126:129], v[14:17]
    v_mul_f32 v230, v230, v54
    v_mul_f32 v231, v231, v55
    v_mul_f32 v232, v232, v56
    s_waitcnt lgkmcnt(2)
    v_mfma_f32_16x16x32_bf16 v[2:5], v[210:213], v[130:133], v[2:5]
    ds_read_b128 v[222:225], v1 offset:19456
    s_add_u32 s86, s74, 0
    buffer_load_dwordx4 v[82:85], v252, s[48:51], s86 offen offset:2048
    v_mfma_f32_16x16x32_bf16 v[6:9], v[210:213], v[134:137], v[6:9]
    v_mul_f32 v233, v233, v57
    v_exp_f32 v230, v230
    v_mul_f32 v54, v54, v62
    s_waitcnt lgkmcnt(2)
    v_mfma_f32_16x16x32_bf16 v[10:13], v[214:217], v[130:133], v[10:13]
    ds_read_b128 v[210:213], v1 offset:20480
    buffer_load_dwordx4 v[86:89], v253, s[48:51], s86 offen offset:2048
    v_mfma_f32_16x16x32_bf16 v[14:17], v[214:217], v[134:137], v[14:17]
    v_exp_f32 v231, v231
    v_mul_f32 v55, v55, v63
    v_exp_f32 v232, v232
    s_waitcnt lgkmcnt(2)
    v_mfma_f32_16x16x32_bf16 v[2:5], v[218:221], v[138:141], v[2:5]
    ds_read_b128 v[214:217], v1 offset:21504
    s_add_u32 s86, s74, 0
    buffer_load_dwordx4 v[90:93], v252, s[48:51], s86 offen offset:3072
    v_mfma_f32_16x16x32_bf16 v[6:9], v[218:221], v[142:145], v[6:9]
    v_mul_f32 v56, v56, v64
    v_exp_f32 v233, v233
    s_waitcnt lgkmcnt(2)
    v_mfma_f32_16x16x32_bf16 v[10:13], v[222:225], v[138:141], v[10:13]
    ds_read_b128 v[218:221], v1 offset:22528
    buffer_load_dwordx4 v[94:97], v253, s[48:51], s86 offen offset:3072
    v_mfma_f32_16x16x32_bf16 v[14:17], v[222:225], v[142:145], v[14:17]
    v_mul_f32 v57, v57, v65
    v_fma_f32 v230, v230, v251, v251
    s_waitcnt lgkmcnt(2)
    v_mfma_f32_16x16x32_bf16 v[2:5], v[210:213], v[146:149], v[2:5]
    ds_read_b128 v[222:225], v1 offset:23552
    s_add_u32 s86, s74, 0x1000
    buffer_load_dwordx4 v[98:101], v252, s[48:51], s86 offen
    v_mfma_f32_16x16x32_bf16 v[6:9], v[210:213], v[150:153], v[6:9]
    v_fma_f32 v231, v231, v251, v251
    v_fma_f32 v232, v232, v251, v251
    s_waitcnt vmcnt(9)
    s_barrier
    s_waitcnt lgkmcnt(2)
    v_mfma_f32_16x16x32_bf16 v[10:13], v[214:217], v[146:149], v[10:13]
    ds_read_b128 v[210:213], v1 offset:24576
    buffer_load_dwordx4 v[102:105], v253, s[48:51], s86 offen
    v_mfma_f32_16x16x32_bf16 v[14:17], v[214:217], v[150:153], v[14:17]
    v_fma_f32 v233, v233, v251, v251
    v_rcp_f32 v230, v230
    s_waitcnt lgkmcnt(2)
    v_mfma_f32_16x16x32_bf16 v[2:5], v[218:221], v[154:157], v[2:5]
    ds_read_b128 v[214:217], v1 offset:25600
    s_add_u32 s86, s74, 0x1000
    buffer_load_dwordx4 v[106:109], v252, s[48:51], s86 offen offset:1024
    v_mfma_f32_16x16x32_bf16 v[6:9], v[218:221], v[158:161], v[6:9]
    v_rcp_f32 v231, v231
    v_rcp_f32 v232, v232
    s_waitcnt lgkmcnt(2)
    v_mfma_f32_16x16x32_bf16 v[10:13], v[222:225], v[154:157], v[10:13]
    ds_read_b128 v[218:221], v1 offset:26624
    buffer_load_dwordx4 v[110:113], v253, s[48:51], s86 offen offset:1024
    v_mfma_f32_16x16x32_bf16 v[14:17], v[222:225], v[158:161], v[14:17]
    v_rcp_f32 v233, v233
    v_mul_f32 v54, v54, v230
    s_waitcnt lgkmcnt(2)
    v_mfma_f32_16x16x32_bf16 v[2:5], v[210:213], v[162:165], v[2:5]
    ds_read_b128 v[222:225], v1 offset:27648
    s_add_u32 s86, s74, 0x1000
    buffer_load_dwordx4 v[114:117], v252, s[48:51], s86 offen offset:2048
    v_mfma_f32_16x16x32_bf16 v[6:9], v[210:213], v[166:169], v[6:9]
    v_mul_f32 v55, v55, v231
    v_mul_f32 v56, v56, v232
    s_waitcnt lgkmcnt(2)
    v_mfma_f32_16x16x32_bf16 v[10:13], v[214:217], v[162:165], v[10:13]
    ds_read_b128 v[210:213], v1 offset:28672
    buffer_load_dwordx4 v[118:121], v253, s[48:51], s86 offen offset:2048
    v_mfma_f32_16x16x32_bf16 v[14:17], v[214:217], v[166:169], v[14:17]
    v_mul_f32 v57, v57, v233
    v_cvt_pk_bf16_f32 v228, v54, v55
    s_waitcnt lgkmcnt(2)
    v_mfma_f32_16x16x32_bf16 v[2:5], v[218:221], v[170:173], v[2:5]
    ds_read_b128 v[214:217], v1 offset:29696
    s_add_u32 s86, s74, 0x1000
    buffer_load_dwordx4 v[122:125], v252, s[48:51], s86 offen offset:3072
    v_mfma_f32_16x16x32_bf16 v[6:9], v[218:221], v[174:177], v[6:9]
    v_cvt_pk_bf16_f32 v229, v56, v57
    v_permlane32_swap_b32 v226, v228
    s_waitcnt lgkmcnt(2)
    v_mfma_f32_16x16x32_bf16 v[10:13], v[222:225], v[170:173], v[10:13]
    ds_read_b128 v[218:221], v1 offset:30720
    buffer_load_dwordx4 v[126:129], v253, s[48:51], s86 offen offset:3072
    v_mfma_f32_16x16x32_bf16 v[14:17], v[222:225], v[174:177], v[14:17]
    v_permlane32_swap_b32 v227, v229
    buffer_store_dwordx4 v[226:229], v254, s[48:51], s30 offen sc1
    s_waitcnt lgkmcnt(2)
    v_mfma_f32_16x16x32_bf16 v[2:5], v[210:213], v[178:181], v[2:5]
    ds_read_b128 v[222:225], v1 offset:31744
    v_mfma_f32_16x16x32_bf16 v[6:9], v[210:213], v[182:185], v[6:9]
    s_waitcnt lgkmcnt(2)
    v_mfma_f32_16x16x32_bf16 v[10:13], v[214:217], v[178:181], v[10:13]
    ds_read_b128 v[210:213], v1 offset:32768
    v_mfma_f32_16x16x32_bf16 v[14:17], v[214:217], v[182:185], v[14:17]
    s_waitcnt lgkmcnt(2)
    v_mfma_f32_16x16x32_bf16 v[2:5], v[218:221], v[186:189], v[2:5]
    ds_read_b128 v[214:217], v1 offset:33792
    s_lshl_b32 s13, s9, 2
    s_add_u32 s13, s13, s75
    s_mov_b64 exec, 1
    buffer_store_dword v1, v1, s[64:67], s13 offen offset:256 sc1
    s_mov_b64 exec, -1
    ds_read_b128 v[130:133], v240
    v_mfma_f32_16x16x32_bf16 v[6:9], v[218:221], v[190:193], v[6:9]
    s_waitcnt lgkmcnt(3)
    v_mfma_f32_16x16x32_bf16 v[10:13], v[222:225], v[186:189], v[10:13]
    ds_read_b128 v[218:221], v1 offset:34816
    ds_read_b128 v[134:137], v240 offset:1024
    v_mfma_f32_16x16x32_bf16 v[14:17], v[222:225], v[190:193], v[14:17]
    s_waitcnt lgkmcnt(4)
    v_mfma_f32_16x16x32_bf16 v[2:5], v[210:213], v[194:197], v[2:5]
    ds_read_b128 v[222:225], v1 offset:35840
    ds_read_b128 v[138:141], v240 offset:2048
    v_mfma_f32_16x16x32_bf16 v[6:9], v[210:213], v[198:201], v[6:9]
    s_waitcnt lgkmcnt(5)
    v_mfma_f32_16x16x32_bf16 v[10:13], v[214:217], v[194:197], v[10:13]
    ds_read_b128 v[142:145], v240 offset:3072
    v_mfma_f32_16x16x32_bf16 v[14:17], v[214:217], v[198:201], v[14:17]
    s_waitcnt lgkmcnt(4)
    v_mfma_f32_16x16x32_bf16 v[2:5], v[218:221], v[202:205], v[2:5]
    ds_read_b128 v[146:149], v241
    v_mfma_f32_16x16x32_bf16 v[6:9], v[218:221], v[206:209], v[6:9]
    s_waitcnt lgkmcnt(3)
    v_mfma_f32_16x16x32_bf16 v[10:13], v[222:225], v[202:205], v[10:13]
    v_mfma_f32_16x16x32_bf16 v[14:17], v[222:225], v[206:209], v[14:17]
    s_nop 2
    v_mul_f32 v230, v2, v2
    v_mul_f32 v231, v3, v3
    v_mul_f32 v232, v4, v4
    v_mul_f32 v233, v5, v5
    v_fma_f32 v230, v230, v248, v246
    v_fma_f32 v231, v231, v248, v246
    v_fma_f32 v232, v232, v248, v246
    v_fma_f32 v233, v233, v248, v246
    v_mul_f32 v230, v230, v2
    v_mul_f32 v231, v231, v3
    v_mul_f32 v232, v232, v4
    v_mul_f32 v233, v233, v5
    v_exp_f32 v230, v230
    v_mul_f32 v2, v2, v10
    v_exp_f32 v231, v231
    v_mul_f32 v3, v3, v11
    v_exp_f32 v232, v232
    v_mul_f32 v4, v4, v12
    v_exp_f32 v233, v233
    v_mul_f32 v5, v5, v13
    v_fma_f32 v230, v230, v250, v250
    v_fma_f32 v231, v231, v250, v250
    v_fma_f32 v232, v232, v250, v250
    v_fma_f32 v233, v233, v250, v250
    v_rcp_f32 v230, v230
    v_rcp_f32 v231, v231
    v_rcp_f32 v232, v232
    v_rcp_f32 v233, v233
    v_mul_f32 v2, v2, v230
    v_mul_f32 v3, v3, v231
    v_mul_f32 v4, v4, v232
    v_mul_f32 v5, v5, v233
    v_cvt_pk_bf16_f32 v226, v2, v3
    v_cvt_pk_bf16_f32 v227, v4, v5
    v_mul_f32 v230, v6, v6
    v_mul_f32 v231, v7, v7
    v_mul_f32 v232, v8, v8
    v_mul_f32 v233, v9, v9
    v_fma_f32 v230, v230, v249, v247
    v_fma_f32 v231, v231, v249, v247
    v_fma_f32 v232, v232, v249, v247
    v_fma_f32 v233, v233, v249, v247
    v_mul_f32 v230, v230, v6
    v_mul_f32 v231, v231, v7
    v_mul_f32 v232, v232, v8
    v_mul_f32 v233, v233, v9
    v_exp_f32 v230, v230
    v_mul_f32 v6, v6, v14
    v_exp_f32 v231, v231
    v_mul_f32 v7, v7, v15
    v_exp_f32 v232, v232
    v_mul_f32 v8, v8, v16
    v_exp_f32 v233, v233
    v_mul_f32 v9, v9, v17
    v_fma_f32 v230, v230, v251, v251
    v_fma_f32 v231, v231, v251, v251
    v_fma_f32 v232, v232, v251, v251
    v_fma_f32 v233, v233, v251, v251
    v_rcp_f32 v230, v230
    v_rcp_f32 v231, v231
    v_rcp_f32 v232, v232
    v_rcp_f32 v233, v233
    v_mul_f32 v6, v6, v230
    v_mul_f32 v7, v7, v231
    v_mul_f32 v8, v8, v232
    v_mul_f32 v9, v9, v233
    v_cvt_pk_bf16_f32 v228, v6, v7
    v_cvt_pk_bf16_f32 v229, v8, v9
    s_nop 0
    v_permlane32_swap_b32 v226, v228
    v_permlane32_swap_b32 v227, v229
    buffer_store_dwordx4 v[226:229], v254, s[48:51], s30 offen offset:512 sc1
L_ff_a:
    s_waitcnt vmcnt(17)
    v_mfma_f32_16x16x32_bf16 v[18:21], v[130:133], v[66:69], 0
    ds_read_b128 v[150:153], v241 offset:1024
    v_mfma_f32_16x16x32_bf16 v[22:25], v[130:133], v[70:73], 0
    v_mfma_f32_16x16x32_bf16 v[26:29], v[134:137], v[66:69], 0
    ds_read_b128 v[130:133], v241 offset:2048
    v_mfma_f32_16x16x32_bf16 v[30:33], v[134:137], v[70:73], 0
    s_waitcnt lgkmcnt(4)
    v_mfma_f32_16x16x32_bf16 v[34:37], v[138:141], v[66:69], 0
    ds_read_b128 v[134:137], v241 offset:3072
    v_mfma_f32_16x16x32_bf16 v[38:41], v[138:141], v[70:73], 0
    s_waitcnt lgkmcnt(4)
    v_mfma_f32_16x16x32_bf16 v[42:45], v[142:145], v[66:69], 0
    ds_read_b128 v[138:141], v234 offset:8192
    v_mfma_f32_16x16x32_bf16 v[46:49], v[142:145], v[70:73], 0
    s_waitcnt lgkmcnt(4)
    v_mfma_f32_16x16x32_bf16 v[50:53], v[146:149], v[66:69], 0
    ds_read_b128 v[142:145], v240 offset:9216
    v_mfma_f32_16x16x32_bf16 v[54:57], v[146:149], v[70:73], 0
    s_waitcnt lgkmcnt(4)
    v_mfma_f32_16x16x32_bf16 v[58:61], v[150:153], v[66:69], 0
    ds_read_b128 v[146:149], v240 offset:10240
    v_mfma_f32_16x16x32_bf16 v[62:65], v[150:153], v[70:73], 0
    s_waitcnt lgkmcnt(4)
    v_mfma_f32_16x16x32_bf16 v[154:157], v[130:133], v[66:69], 0
    ds_read_b128 v[150:153], v240 offset:11264
    v_mfma_f32_16x16x32_bf16 v[158:161], v[130:133], v[70:73], 0
    s_waitcnt lgkmcnt(4)
    v_mfma_f32_16x16x32_bf16 v[162:165], v[134:137], v[66:69], 0
    ds_read_b128 v[130:133], v240 offset:12288
    v_mfma_f32_16x16x32_bf16 v[166:169], v[134:137], v[70:73], 0
    s_waitcnt lgkmcnt(4)
    v_mfma_f32_16x16x32_bf16 v[170:173], v[138:141], v[66:69], 0
    ds_read_b128 v[134:137], v241 offset:9216
    v_mfma_f32_16x16x32_bf16 v[174:177], v[138:141], v[70:73], 0
    s_waitcnt vmcnt(15) lgkmcnt(4)
    v_mfma_f32_16x16x32_bf16 v[18:21], v[142:145], v[74:77], v[18:21]
    ds_read_b128 v[138:141], v241 offset:10240
    v_mfma_f32_16x16x32_bf16 v[22:25], v[142:145], v[78:81], v[22:25]
    s_waitcnt lgkmcnt(4)
    v_mfma_f32_16x16x32_bf16 v[26:29], v[146:149], v[74:77], v[26:29]
    ds_read_b128 v[142:145], v241 offset:11264
    s_add_u32 s86, s74, 0x2000
    v_mfma_f32_16x16x32_bf16 v[30:33], v[146:149], v[78:81], v[30:33]
    s_waitcnt lgkmcnt(4)
    v_mfma_f32_16x16x32_bf16 v[34:37], v[150:153], v[74:77], v[34:37]
    ds_read_b128 v[146:149], v241 offset:12288
    v_mfma_f32_16x16x32_bf16 v[38:41], v[150:153], v[78:81], v[38:41]
    buffer_load_dwordx4 v[66:69], v252, s[48:51], s86 offen
    s_waitcnt lgkmcnt(4)
    v_mfma_f32_16x16x32_bf16 v[42:45], v[130:133], v[74:77], v[42:45]
    ds_read_b128 v[150:153], v234 offset:17408
    v_mfma_f32_16x16x32_bf16 v[46:49], v[130:133], v[78:81], v[46:49]
    s_waitcnt lgkmcnt(4)
    v_mfma_f32_16x16x32_bf16 v[50:53], v[134:137], v[74:77], v[50:53]
    ds_read_b128 v[130:133], v240 offset:18432
    v_mfma_f32_16x16x32_bf16 v[54:57], v[134:137], v[78:81], v[54:57]
    s_waitcnt lgkmcnt(4)
    v_mfma_f32_16x16x32_bf16 v[58:61], v[138:141], v[74:77], v[58:61]
    ds_read_b128 v[134:137], v240 offset:19456
    v_mfma_f32_16x16x32_bf16 v[62:65], v[138:141], v[78:81], v[62:65]
    buffer_load_dwordx4 v[70:73], v253, s[48:51], s86 offen
    s_waitcnt lgkmcnt(4)
    v_mfma_f32_16x16x32_bf16 v[154:157], v[142:145], v[74:77], v[154:157]
    ds_read_b128 v[138:141], v240 offset:20480
    v_mfma_f32_16x16x32_bf16 v[158:161], v[142:145], v[78:81], v[158:161]
    s_waitcnt lgkmcnt(4)
    v_mfma_f32_16x16x32_bf16 v[162:165], v[146:149], v[74:77], v[162:165]
    ds_read_b128 v[142:145], v240 offset:21504
    v_mfma_f32_16x16x32_bf16 v[166:169], v[146:149], v[78:81], v[166:169]
    s_waitcnt lgkmcnt(4)
    v_mfma_f32_16x16x32_bf16 v[170:173], v[150:153], v[74:77], v[170:173]
    ds_read_b128 v[146:149], v241 offset:18432
    v_mfma_f32_16x16x32_bf16 v[174:177], v[150:153], v[78:81], v[174:177]
    s_waitcnt vmcnt(15) lgkmcnt(4)
    v_mfma_f32_16x16x32_bf16 v[18:21], v[130:133], v[82:85], v[18:21]
    ds_read_b128 v[150:153], v241 offset:19456
    v_mfma_f32_16x16x32_bf16 v[22:25], v[130:133], v[86:89], v[22:25]
    s_waitcnt lgkmcnt(4)
    v_mfma_f32_16x16x32_bf16 v[26:29], v[134:137], v[82:85], v[26:29]
    ds_read_b128 v[130:133], v241 offset:20480
    s_add_u32 s86, s74, 0x2000
    v_mfma_f32_16x16x32_bf16 v[30:33], v[134:137], v[86:89], v[30:33]
    s_waitcnt lgkmcnt(4)
    v_mfma_f32_16x16x32_bf16 v[34:37], v[138:141], v[82:85], v[34:37]
    ds_read_b128 v[134:137], v241 offset:21504
    v_mfma_f32_16x16x32_bf16 v[38:41], v[138:141], v[86:89], v[38:41]
    buffer_load_dwordx4 v[74:77], v252, s[48:51], s86 offen offset:1024
    s_waitcnt lgkmcnt(4)
    v_mfma_f32_16x16x32_bf16 v[42:45], v[142:145], v[82:85], v[42:45]
    ds_read_b128 v[138:141], v234 offset:26624
    v_mfma_f32_16x16x32_bf16 v[46:49], v[142:145], v[86:89], v[46:49]
    s_waitcnt lgkmcnt(4)
    v_mfma_f32_16x16x32_bf16 v[50:53], v[146:149], v[82:85], v[50:53]
    ds_read_b128 v[142:145], v240 offset:27648
    v_mfma_f32_16x16x32_bf16 v[54:57], v[146:149], v[86:89], v[54:57]
    s_waitcnt lgkmcnt(4)
    v_mfma_f32_16x16x32_bf16 v[58:61], v[150:153], v[82:85], v[58:61]
    ds_read_b128 v[146:149], v240 offset:28672
    v_mfma_f32_16x16x32_bf16 v[62:65], v[150:153], v[86:89], v[62:65]
    buffer_load_dwordx4 v[78:81], v253, s[48:51], s86 offen offset:1024
    s_waitcnt lgkmcnt(4)
    v_mfma_f32_16x16x32_bf16 v[154:157], v[130:133], v[82:85], v[154:157]
    ds_read_b128 v[150:153], v240 offset:29696
    v_mfma_f32_16x16x32_bf16 v[158:161], v[130:133], v[86:89], v[158:161]
    s_waitcnt lgkmcnt(4)
    v_mfma_f32_16x16x32_bf16 v[162:165], v[134:137], v[82:85], v[162:165]
    ds_read_b128 v[130:133], v240 offset:30720
    v_mfma_f32_16x16x32_bf16 v[166:169], v[134:137], v[86:89], v[166:169]
    s_waitcnt lgkmcnt(4)
    v_mfma_f32_16x16x32_bf16 v[170:173], v[138:141], v[82:85], v[170:173]
    ds_read_b128 v[134:137], v241 offset:27648
    v_mfma_f32_16x16x32_bf16 v[174:177], v[138:141], v[86:89], v[174:177]
    s_waitcnt vmcnt(15) lgkmcnt(4)
    v_mfma_f32_16x16x32_bf16 v[18:21], v[142:145], v[90:93], v[18:21]
    ds_read_b128 v[138:141], v241 offset:28672
    v_mfma_f32_16x16x32_bf16 v[22:25], v[142:145], v[94:97], v[22:25]
    s_waitcnt lgkmcnt(4)
    v_mfma_f32_16x16x32_bf16 v[26:29], v[146:149], v[90:93], v[26:29]
    ds_read_b128 v[142:145], v241 offset:29696
    s_add_u32 s86, s74, 0x2000
    v_mfma_f32_16x16x32_bf16 v[30:33], v[146:149], v[94:97], v[30:33]
    s_waitcnt lgkmcnt(4)
    v_mfma_f32_16x16x32_bf16 v[34:37], v[150:153], v[90:93], v[34:37]
    ds_read_b128 v[146:149], v241 offset:30720
    v_mfma_f32_16x16x32_bf16 v[38:41], v[150:153], v[94:97], v[38:41]
    buffer_load_dwordx4 v[82:85], v252, s[48:51], s86 offen offset:2048
    s_waitcnt lgkmcnt(4)
    v_mfma_f32_16x16x32_bf16 v[42:45], v[130:133], v[90:93], v[42:45]
    ds_read_b128 v[150:153], v234 offset:35840
    v_add_u32 v196, 0x10000, v240
    v_mfma_f32_16x16x32_bf16 v[46:49], v[130:133], v[94:97], v[46:49]
    s_waitcnt lgkmcnt(4)
    v_mfma_f32_16x16x32_bf16 v[50:53], v[134:137], v[90:93], v[50:53]
    s_barrier
    ds_read_b128 v[130:133], v240 offset:36864
    v_add_u32 v197, 0x10000, v241
    v_mfma_f32_16x16x32_bf16 v[54:57], v[134:137], v[94:97], v[54:57]
    s_waitcnt lgkmcnt(4)
    v_mfma_f32_16x16x32_bf16 v[58:61], v[138:141], v[90:93], v[58:61]
    ds_read_b128 v[134:137], v240 offset:37888
    v_add_u32 v198, 0x10000, v234
    v_mfma_f32_16x16x32_bf16 v[62:65], v[138:141], v[94:97], v[62:65]
    buffer_load_dwordx4 v[86:89], v253, s[48:51], s86 offen offset:2048
    s_waitcnt lgkmcnt(4)
    v_mfma_f32_16x16x32_bf16 v[154:157], v[142:145], v[90:93], v[154:157]
    ds_read_b128 v[138:141], v240 offset:38912
    v_mfma_f32_16x16x32_bf16 v[158:161], v[142:145], v[94:97], v[158:161]
    s_waitcnt lgkmcnt(4)
    v_mfma_f32_16x16x32_bf16 v[162:165], v[146:149], v[90:93], v[162:165]
    ds_read_b128 v[142:145], v240 offset:39936
    v_lshrrev_b32 v178, 4, v1
    v_and_b32 v235, 15, v178
    v_mfma_f32_16x16x32_bf16 v[166:169], v[146:149], v[94:97], v[166:169]
    s_waitcnt lgkmcnt(4)
    v_mfma_f32_16x16x32_bf16 v[170:173], v[150:153], v[90:93], v[170:173]
    ds_read_b128 v[146:149], v241 offset:36864
    v_bfe_u32 v236, v178, 4, 1
    v_lshlrev_b32 v199, 4, v235
    v_mfma_f32_16x16x32_bf16 v[174:177], v[150:153], v[94:97], v[174:177]
    s_waitcnt vmcnt(15) lgkmcnt(4)
    v_mfma_f32_16x16x32_bf16 v[18:21], v[130:133], v[98:101], v[18:21]
    ds_read_b128 v[150:153], v241 offset:37888
    v_lshl_add_u32 v199, v236, 10, v199
    v_mul_u32_u24 v200, 0x480, v235
    v_mfma_f32_16x16x32_bf16 v[22:25], v[130:133], v[102:105], v[22:25]
    s_waitcnt lgkmcnt(4)
    v_mfma_f32_16x16x32_bf16 v[26:29], v[134:137], v[98:101], v[26:29]
    ds_read_b128 v[130:133], v241 offset:38912
    v_lshl_add_u32 v200, v236, 6, v200
    v_lshrrev_b32 v236, 5, v178
    s_add_u32 s86, s74, 0x2000
    v_mfma_f32_16x16x32_bf16 v[30:33], v[134:137], v[102:105], v[30:33]
    s_waitcnt lgkmcnt(4)
    v_mfma_f32_16x16x32_bf16 v[34:37], v[138:141], v[98:101], v[34:37]
    ds_read_b128 v[134:137], v241 offset:39936
    v_lshl_add_u32 v200, v236, 5, v200
    v_lshlrev_b32 v236, 4, v236
    v_mfma_f32_16x16x32_bf16 v[38:41], v[138:141], v[102:105], v[38:41]
    buffer_load_dwordx4 v[90:93], v252, s[48:51], s86 offen offset:3072
    s_waitcnt lgkmcnt(4)
    v_mfma_f32_16x16x32_bf16 v[42:45], v[142:145], v[98:101], v[42:45]
    ds_read_b128 v[138:141], v234 offset:45056
    v_mov_b32 v237, 0x3f80
    v_lshlrev_b32 v237, v236, v237
    v_mfma_f32_16x16x32_bf16 v[46:49], v[142:145], v[102:105], v[46:49]
    s_waitcnt lgkmcnt(4)
    v_mfma_f32_16x16x32_bf16 v[50:53], v[146:149], v[98:101], v[50:53]
    ds_read_b128 v[142:145], v240 offset:46080
    v_mfma_f32_16x16x32_bf16 v[54:57], v[146:149], v[102:105], v[54:57]
    s_waitcnt lgkmcnt(4)
    v_mfma_f32_16x16x32_bf16 v[58:61], v[150:153], v[98:101], v[58:61]
    ds_read_b128 v[146:149], v240 offset:47104
    v_lshrrev_b32 v201, 2, v1
    v_mfma_f32_16x16x32_bf16 v[62:65], v[150:153], v[102:105], v[62:65]
    buffer_load_dwordx4 v[94:97], v253, s[48:51], s86 offen offset:3072
    s_waitcnt lgkmcnt(4)
    v_mfma_f32_16x16x32_bf16 v[154:157], v[130:133], v[98:101], v[154:157]
    ds_read_b128 v[150:153], v240 offset:48128
    v_mfma_f32_16x16x32_bf16 v[158:161], v[130:133], v[102:105], v[158:161]
    s_waitcnt lgkmcnt(4)
    v_mfma_f32_16x16x32_bf16 v[162:165], v[134:137], v[98:101], v[162:165]
    ds_read_b128 v[130:133], v240 offset:49152
    v_mfma_f32_16x16x32_bf16 v[166:169], v[134:137], v[102:105], v[166:169]
    s_waitcnt lgkmcnt(4)
    v_mfma_f32_16x16x32_bf16 v[170:173], v[138:141], v[98:101], v[170:173]
    ds_read_b128 v[134:137], v241 offset:46080
    v_mfma_f32_16x16x32_bf16 v[174:177], v[138:141], v[102:105], v[174:177]
    s_waitcnt vmcnt(15) lgkmcnt(4)
    v_mfma_f32_16x16x32_bf16 v[18:21], v[142:145], v[106:109], v[18:21]
    ds_read_b128 v[138:141], v241 offset:47104
    v_mfma_f32_16x16x32_bf16 v[22:25], v[142:145], v[110:113], v[22:25]
    s_waitcnt lgkmcnt(4)
    v_mfma_f32_16x16x32_bf16 v[26:29], v[146:149], v[106:109], v[26:29]
    ds_read_b128 v[142:145], v241 offset:48128
    s_add_u32 s86, s74, 0x3000
    v_mfma_f32_16x16x32_bf16 v[30:33], v[146:149], v[110:113], v[30:33]
    s_waitcnt lgkmcnt(4)
    v_mfma_f32_16x16x32_bf16 v[34:37], v[150:153], v[106:109], v[34:37]
    ds_read_b128 v[146:149], v241 offset:49152
    v_mfma_f32_16x16x32_bf16 v[38:41], v[150:153], v[110:113], v[38:41]
    buffer_load_dwordx4 v[98:101], v252, s[48:51], s86 offen
    s_waitcnt lgkmcnt(4)
    v_mfma_f32_16x16x32_bf16 v[42:45], v[130:133], v[106:109], v[42:45]
    ds_read_b128 v[150:153], v234 offset:54272
    v_mfma_f32_16x16x32_bf16 v[46:49], v[130:133], v[110:113], v[46:49]
    s_waitcnt lgkmcnt(4)
    v_mfma_f32_16x16x32_bf16 v[50:53], v[134:137], v[106:109], v[50:53]
    s_barrier
    ds_read_b128 v[130:133], v240 offset:55296
    v_mfma_f32_16x16x32_bf16 v[54:57], v[134:137], v[110:113], v[54:57]
    s_waitcnt lgkmcnt(4)
    v_mfma_f32_16x16x32_bf16 v[58:61], v[138:141], v[106:109], v[58:61]
    ds_read_b128 v[134:137], v240 offset:56320
    v_mfma_f32_16x16x32_bf16 v[62:65], v[138:141], v[110:113], v[62:65]
    buffer_load_dwordx4 v[102:105], v253, s[48:51], s86 offen
    s_waitcnt lgkmcnt(4)
    v_mfma_f32_16x16x32_bf16 v[154:157], v[142:145], v[106:109], v[154:157]
    ds_read_b128 v[138:141], v240 offset:57344
    v_mfma_f32_16x16x32_bf16 v[158:161], v[142:145], v[110:113], v[158:161]
    s_waitcnt lgkmcnt(4)
    v_mfma_f32_16x16x32_bf16 v[162:165], v[146:149], v[106:109], v[162:165]
    ds_read_b128 v[142:145], v240 offset:58368
    v_mfma_f32_16x16x32_bf16 v[166:169], v[146:149], v[110:113], v[166:169]
    s_waitcnt lgkmcnt(4)
    v_mfma_f32_16x16x32_bf16 v[170:173], v[150:153], v[106:109], v[170:173]
    ds_read_b128 v[146:149], v241 offset:55296
    v_mfma_f32_16x16x32_bf16 v[174:177], v[150:153], v[110:113], v[174:177]
    s_waitcnt vmcnt(15) lgkmcnt(4)
    v_mfma_f32_16x16x32_bf16 v[18:21], v[130:133], v[114:117], v[18:21]
    ds_read_b128 v[150:153], v241 offset:56320
    v_mfma_f32_16x16x32_bf16 v[22:25], v[130:133], v[118:121], v[22:25]
    s_waitcnt lgkmcnt(4)
    v_mfma_f32_16x16x32_bf16 v[26:29], v[134:137], v[114:117], v[26:29]
    ds_read_b128 v[130:133], v241 offset:57344
    s_add_u32 s86, s74, 0x3000
    v_mfma_f32_16x16x32_bf16 v[30:33], v[134:137], v[118:121], v[30:33]
    s_waitcnt lgkmcnt(4)
    v_mfma_f32_16x16x32_bf16 v[34:37], v[138:141], v[114:117], v[34:37]
    ds_read_b128 v[134:137], v241 offset:58368
    buffer_load_dword v239, v238, s[64:67], s75 offen offset:256
    v_mfma_f32_16x16x32_bf16 v[38:41], v[138:141], v[118:121], v[38:41]
    buffer_load_dwordx4 v[106:109], v252, s[48:51], s86 offen offset:1024
    s_waitcnt lgkmcnt(4)
    v_mfma_f32_16x16x32_bf16 v[42:45], v[142:145], v[114:117], v[42:45]
    ds_read_b128 v[138:141], v234 offset:63488
    v_mfma_f32_16x16x32_bf16 v[46:49], v[142:145], v[118:121], v[46:49]
    s_waitcnt lgkmcnt(4)
    v_mfma_f32_16x16x32_bf16 v[50:53], v[146:149], v[114:117], v[50:53]
    ds_read_b128 v[142:145], v240 offset:64512
    v_mfma_f32_16x16x32_bf16 v[54:57], v[146:149], v[118:121], v[54:57]
    s_waitcnt lgkmcnt(4)
    v_mfma_f32_16x16x32_bf16 v[58:61], v[150:153], v[114:117], v[58:61]
    ds_read_b128 v[146:149], v196
    v_mfma_f32_16x16x32_bf16 v[62:65], v[150:153], v[118:121], v[62:65]
    buffer_load_dwordx4 v[110:113], v253, s[48:51], s86 offen offset:1024
    s_waitcnt lgkmcnt(4)
    v_mfma_f32_16x16x32_bf16 v[154:157], v[130:133], v[114:117], v[154:157]
    ds_read_b128 v[150:153], v196 offset:1024
    v_mfma_f32_16x16x32_bf16 v[158:161], v[130:133], v[118:121], v[158:161]
    s_waitcnt lgkmcnt(4)
    v_mfma_f32_16x16x32_bf16 v[162:165], v[134:137], v[114:117], v[162:165]
    ds_read_b128 v[130:133], v196 offset:2048
    v_mfma_f32_16x16x32_bf16 v[166:169], v[134:137], v[118:121], v[166:169]
    s_waitcnt lgkmcnt(4)
    v_mfma_f32_16x16x32_bf16 v[170:173], v[138:141], v[114:117], v[170:173]
    ds_read_b128 v[134:137], v241 offset:64512
    v_mfma_f32_16x16x32_bf16 v[174:177], v[138:141], v[118:121], v[174:177]
    s_waitcnt vmcnt(16) lgkmcnt(4)
    v_mfma_f32_16x16x32_bf16 v[18:21], v[142:145], v[122:125], v[18:21]
    ds_read_b128 v[138:141], v197
    v_mfma_f32_16x16x32_bf16 v[22:25], v[142:145], v[126:129], v[22:25]
    s_waitcnt lgkmcnt(4)
    v_mfma_f32_16x16x32_bf16 v[26:29], v[146:149], v[122:125], v[26:29]
    ds_read_b128 v[142:145], v197 offset:1024
    s_add_u32 s86, s74, 0x3000
    v_mfma_f32_16x16x32_bf16 v[30:33], v[146:149], v[126:129], v[30:33]
    s_waitcnt lgkmcnt(4)
    v_mfma_f32_16x16x32_bf16 v[34:37], v[150:153], v[122:125], v[34:37]
    ds_read_b128 v[146:149], v197 offset:2048
    v_mfma_f32_16x16x32_bf16 v[38:41], v[150:153], v[126:129], v[38:41]
    buffer_load_dwordx4 v[114:117], v252, s[48:51], s86 offen offset:2048
    s_waitcnt lgkmcnt(4)
    v_mfma_f32_16x16x32_bf16 v[42:45], v[130:133], v[122:125], v[42:45]
    ds_read_b128 v[150:153], v198 offset:7168
    v_mfma_f32_16x16x32_bf16 v[46:49], v[130:133], v[126:129], v[46:49]
    s_waitcnt lgkmcnt(4)
    v_mfma_f32_16x16x32_bf16 v[50:53], v[134:137], v[122:125], v[50:53]
    s_barrier
    ds_read_b128 v[130:133], v196 offset:8192
    v_mfma_f32_16x16x32_bf16 v[54:57], v[134:137], v[126:129], v[54:57]
    s_waitcnt lgkmcnt(4)
    v_mfma_f32_16x16x32_bf16 v[58:61], v[138:141], v[122:125], v[58:61]
    ds_read_b128 v[134:137], v196 offset:9216
    v_mfma_f32_16x16x32_bf16 v[62:65], v[138:141], v[126:129], v[62:65]
    buffer_load_dwordx4 v[118:121], v253, s[48:51], s86 offen offset:2048
    s_waitcnt lgkmcnt(4)
    v_mfma_f32_16x16x32_bf16 v[154:157], v[142:145], v[122:125], v[154:157]
    ds_read_b128 v[138:141], v196 offset:10240
    v_mfma_f32_16x16x32_bf16 v[158:161], v[142:145], v[126:129], v[158:161]
    s_waitcnt lgkmcnt(4)
    v_mfma_f32_16x16x32_bf16 v[162:165], v[146:149], v[122:125], v[162:165]
    ds_read_b128 v[142:145], v196 offset:11264
    v_mfma_f32_16x16x32_bf16 v[166:169], v[146:149], v[126:129], v[166:169]
    s_waitcnt lgkmcnt(4)
    v_mfma_f32_16x16x32_bf16 v[170:173], v[150:153], v[122:125], v[170:173]
    ds_read_b128 v[146:149], v197 offset:8192
    v_mfma_f32_16x16x32_bf16 v[174:177], v[150:153], v[126:129], v[174:177]
    s_waitcnt vmcnt(13) lgkmcnt(4)
    v_mfma_f32_16x16x32_bf16 v[18:21], v[130:133], v[66:69], v[18:21]
    ds_read_b128 v[150:153], v197 offset:9216
    v_mfma_f32_16x16x32_bf16 v[22:25], v[130:133], v[70:73], v[22:25]
    s_waitcnt lgkmcnt(4)
    v_mfma_f32_16x16x32_bf16 v[26:29], v[134:137], v[66:69], v[26:29]
    ds_read_b128 v[130:133], v197 offset:10240
    s_add_u32 s86, s74, 0x3000
    v_mfma_f32_16x16x32_bf16 v[30:33], v[134:137], v[70:73], v[30:33]
    s_waitcnt lgkmcnt(4)
    v_mfma_f32_16x16x32_bf16 v[34:37], v[138:141], v[66:69], v[34:37]
    ds_read_b128 v[134:137], v197 offset:11264
    v_mfma_f32_16x16x32_bf16 v[38:41], v[138:141], v[70:73], v[38:41]
    buffer_load_dwordx4 v[122:125], v252, s[48:51], s86 offen offset:3072
    s_waitcnt lgkmcnt(4)
    v_mfma_f32_16x16x32_bf16 v[42:45], v[142:145], v[66:69], v[42:45]
    ds_read_b128 v[138:141], v198 offset:16384
    v_mfma_f32_16x16x32_bf16 v[46:49], v[142:145], v[70:73], v[46:49]
    s_waitcnt lgkmcnt(4)
    v_mfma_f32_16x16x32_bf16 v[50:53], v[146:149], v[66:69], v[50:53]
    ds_read_b128 v[142:145], v196 offset:17408
    v_mfma_f32_16x16x32_bf16 v[54:57], v[146:149], v[70:73], v[54:57]
    s_waitcnt lgkmcnt(4)
    v_mfma_f32_16x16x32_bf16 v[58:61], v[150:153], v[66:69], v[58:61]
    ds_read_b128 v[146:149], v196 offset:18432
    v_mfma_f32_16x16x32_bf16 v[62:65], v[150:153], v[70:73], v[62:65]
    buffer_load_dwordx4 v[126:129], v253, s[48:51], s86 offen offset:3072
    s_waitcnt lgkmcnt(4)
    v_mfma_f32_16x16x32_bf16 v[154:157], v[130:133], v[66:69], v[154:157]
    ds_read_b128 v[150:153], v196 offset:19456
    s_lshl_b32 s13, s9, 2
    s_add_u32 s13, s13, s75
    s_mov_b64 exec, 1
    buffer_store_dword v1, v1, s[64:67], s13 offen offset:512 sc1
    s_mov_b64 exec, -1
    v_mfma_f32_16x16x32_bf16 v[158:161], v[130:133], v[70:73], v[158:161]
    s_waitcnt lgkmcnt(4)
    v_mfma_f32_16x16x32_bf16 v[162:165], v[134:137], v[66:69], v[162:165]
    ds_read_b128 v[130:133], v196 offset:20480
    v_mfma_f32_16x16x32_bf16 v[166:169], v[134:137], v[70:73], v[166:169]
    s_waitcnt lgkmcnt(4)
    v_mfma_f32_16x16x32_bf16 v[170:173], v[138:141], v[66:69], v[170:173]
    ds_read_b128 v[134:137], v197 offset:17408
    v_mfma_f32_16x16x32_bf16 v[174:177], v[138:141], v[70:73], v[174:177]
    s_waitcnt vmcnt(14) lgkmcnt(4)
    v_mfma_f32_16x16x32_bf16 v[18:21], v[142:145], v[74:77], v[18:21]
    ds_read_b128 v[138:141], v197 offset:18432
    v_mfma_f32_16x16x32_bf16 v[22:25], v[142:145], v[78:81], v[22:25]
    s_waitcnt lgkmcnt(4)
    v_mfma_f32_16x16x32_bf16 v[26:29], v[146:149], v[74:77], v[26:29]
    ds_read_b128 v[142:145], v197 offset:19456
    s_add_u32 s86, s74, 0x4000
    v_mfma_f32_16x16x32_bf16 v[30:33], v[146:149], v[78:81], v[30:33]
    s_waitcnt lgkmcnt(4)
    v_mfma_f32_16x16x32_bf16 v[34:37], v[150:153], v[74:77], v[34:37]
    ds_read_b128 v[146:149], v197 offset:20480
    v_mfma_f32_16x16x32_bf16 v[38:41], v[150:153], v[78:81], v[38:41]
    s_waitcnt vmcnt(7)
    v_cmp_eq_u32 vcc, -1, v239
    s_nop 1
    s_cmp_eq_u64 vcc, 0
    s_mov_b32 s10, 1
    s_cbranch_scc0 L_ff_poll
L_ff_r1:
    buffer_load_dwordx4 v[66:69], v252, s[48:51], s86 offen
    s_waitcnt lgkmcnt(4)
    v_mfma_f32_16x16x32_bf16 v[42:45], v[130:133], v[74:77], v[42:45]
    ds_read_b128 v[150:153], v198 offset:25600
    v_mfma_f32_16x16x32_bf16 v[46:49], v[130:133], v[78:81], v[46:49]
    s_waitcnt lgkmcnt(4)
    v_mfma_f32_16x16x32_bf16 v[50:53], v[134:137], v[74:77], v[50:53]
    s_barrier
    ds_read_b128 v[130:133], v196 offset:26624
    v_mfma_f32_16x16x32_bf16 v[54:57], v[134:137], v[78:81], v[54:57]
    s_waitcnt lgkmcnt(4)
    v_mfma_f32_16x16x32_bf16 v[58:61], v[138:141], v[74:77], v[58:61]
    ds_read_b128 v[134:137], v196 offset:27648
    v_mfma_f32_16x16x32_bf16 v[62:65], v[138:141], v[78:81], v[62:65]
    buffer_load_dwordx4 v[70:73], v253, s[48:51], s86 offen
    s_waitcnt lgkmcnt(4)
    v_mfma_f32_16x16x32_bf16 v[154:157], v[142:145], v[74:77], v[154:157]
    ds_read_b128 v[138:141], v196 offset:28672
    v_mfma_f32_16x16x32_bf16 v[158:161], v[142:145], v[78:81], v[158:161]
    s_waitcnt lgkmcnt(4)
    v_mfma_f32_16x16x32_bf16 v[162:165], v[146:149], v[74:77], v[162:165]
    ds_read_b128 v[142:145], v196 offset:29696
    v_mfma_f32_16x16x32_bf16 v[166:169], v[146:149], v[78:81], v[166:169]
    s_waitcnt lgkmcnt(4)
    v_mfma_f32_16x16x32_bf16 v[170:173], v[150:153], v[74:77], v[170:173]
    ds_read_b128 v[146:149], v197 offset:26624
    v_mfma_f32_16x16x32_bf16 v[174:177], v[150:153], v[78:81], v[174:177]
    s_waitcnt lgkmcnt(4)
    v_mfma_f32_16x16x32_bf16 v[18:21], v[130:133], v[82:85], v[18:21]
    ds_read_b128 v[150:153], v197 offset:27648
    v_mfma_f32_16x16x32_bf16 v[22:25], v[130:133], v[86:89], v[22:25]
    s_waitcnt lgkmcnt(4)
    v_mfma_f32_16x16x32_bf16 v[26:29], v[134:137], v[82:85], v[26:29]
    ds_read_b128 v[130:133], v197 offset:28672
    s_add_u32 s86, s74, 0x4000
    v_mfma_f32_16x16x32_bf16 v[30:33], v[134:137], v[86:89], v[30:33]
    s_waitcnt lgkmcnt(4)
    v_mfma_f32_16x16x32_bf16 v[34:37], v[138:141], v[82:85], v[34:37]
    ds_read_b128 v[134:137], v197 offset:29696
    v_mfma_f32_16x16x32_bf16 v[38:41], v[138:141], v[86:89], v[38:41]
    buffer_load_dwordx4 v[74:77], v252, s[48:51], s86 offen offset:1024
    s_waitcnt lgkmcnt(4)
    v_mfma_f32_16x16x32_bf16 v[42:45], v[142:145], v[82:85], v[42:45]
    ds_read_b128 v[138:141], v198 offset:34816
    v_mfma_f32_16x16x32_bf16 v[46:49], v[142:145], v[86:89], v[46:49]
    s_waitcnt lgkmcnt(4)
    v_mfma_f32_16x16x32_bf16 v[50:53], v[146:149], v[82:85], v[50:53]
    ds_read_b128 v[142:145], v196 offset:35840
    v_mfma_f32_16x16x32_bf16 v[54:57], v[146:149], v[86:89], v[54:57]
    s_waitcnt lgkmcnt(4)
    v_mfma_f32_16x16x32_bf16 v[58:61], v[150:153], v[82:85], v[58:61]
    ds_read_b128 v[146:149], v196 offset:36864
    v_mfma_f32_16x16x32_bf16 v[62:65], v[150:153], v[86:89], v[62:65]
    buffer_load_dwordx4 v[78:81], v253, s[48:51], s86 offen offset:1024
    s_waitcnt lgkmcnt(4)
    v_mfma_f32_16x16x32_bf16 v[154:157], v[130:133], v[82:85], v[154:157]
    ds_read_b128 v[150:153], v196 offset:37888
    v_mfma_f32_16x16x32_bf16 v[158:161], v[130:133], v[86:89], v[158:161]
    s_waitcnt lgkmcnt(4)
    v_mfma_f32_16x16x32_bf16 v[162:165], v[134:137], v[82:85], v[162:165]
    ds_read_b128 v[130:133], v196 offset:38912
    v_mfma_f32_16x16x32_bf16 v[166:169], v[134:137], v[86:89], v[166:169]
    s_waitcnt lgkmcnt(4)
    v_mfma_f32_16x16x32_bf16 v[170:173], v[138:141], v[82:85], v[170:173]
    ds_read_b128 v[134:137], v197 offset:35840
    v_mfma_f32_16x16x32_bf16 v[174:177], v[138:141], v[86:89], v[174:177]
    s_waitcnt lgkmcnt(4)
    v_mfma_f32_16x16x32_bf16 v[18:21], v[142:145], v[90:93], v[18:21]
    ds_read_b128 v[138:141], v197 offset:36864
    v_mfma_f32_16x16x32_bf16 v[22:25], v[142:145], v[94:97], v[22:25]
    s_waitcnt lgkmcnt(4)
    v_mfma_f32_16x16x32_bf16 v[26:29], v[146:149], v[90:93], v[26:29]
    ds_read_b128 v[142:145], v197 offset:37888
    s_add_u32 s86, s74, 0x4000
    v_mfma_f32_16x16x32_bf16 v[30:33], v[146:149], v[94:97], v[30:33]
    s_waitcnt lgkmcnt(4)
    v_mfma_f32_16x16x32_bf16 v[34:37], v[150:153], v[90:93], v[34:37]
    ds_read_b128 v[146:149], v197 offset:38912
    v_mfma_f32_16x16x32_bf16 v[38:41], v[150:153], v[94:97], v[38:41]
    buffer_load_dwordx4 v[82:85], v252, s[48:51], s86 offen offset:2048
    s_waitcnt lgkmcnt(4)
    v_mfma_f32_16x16x32_bf16 v[42:45], v[130:133], v[90:93], v[42:45]
    ds_read_b128 v[150:153], v198 offset:44032
    v_mfma_f32_16x16x32_bf16 v[46:49], v[130:133], v[94:97], v[46:49]
    s_waitcnt lgkmcnt(4)
    v_mfma_f32_16x16x32_bf16 v[50:53], v[134:137], v[90:93], v[50:53]
    s_barrier
    ds_read_b128 v[130:133], v240
    v_mfma_f32_16x16x32_bf16 v[54:57], v[134:137], v[94:97], v[54:57]
    s_waitcnt lgkmcnt(4)
    v_mfma_f32_16x16x32_bf16 v[58:61], v[138:141], v[90:93], v[58:61]
    ds_read_b128 v[134:137], v240 offset:1024
    v_mfma_f32_16x16x32_bf16 v[62:65], v[138:141], v[94:97], v[62:65]
    buffer_load_dwordx4 v[86:89], v253, s[48:51], s86 offen offset:2048
    s_waitcnt lgkmcnt(4)
    v_mfma_f32_16x16x32_bf16 v[154:157], v[142:145], v[90:93], v[154:157]
    ds_read_b128 v[138:141], v240 offset:2048
    v_mfma_f32_16x16x32_bf16 v[158:161], v[142:145], v[94:97], v[158:161]
    s_waitcnt lgkmcnt(4)
    v_mfma_f32_16x16x32_bf16 v[162:165], v[146:149], v[90:93], v[162:165]
    ds_read_b128 v[142:145], v240 offset:3072
    v_mfma_f32_16x16x32_bf16 v[166:169], v[146:149], v[94:97], v[166:169]
    s_waitcnt lgkmcnt(4)
    v_mfma_f32_16x16x32_bf16 v[170:173], v[150:153], v[90:93], v[170:173]
    ds_read_b128 v[146:149], v241
    v_mfma_f32_16x16x32_bf16 v[174:177], v[150:153], v[94:97], v[174:177]
    s_waitcnt lgkmcnt(4)
    v_mfma_f32_16x16x32_bf16 v[18:21], v[130:133], v[98:101], v[18:21]
    ds_read_b128 v[150:153], v241 offset:1024
    v_mfma_f32_16x16x32_bf16 v[22:25], v[130:133], v[102:105], v[22:25]
    s_waitcnt lgkmcnt(4)
    v_mfma_f32_16x16x32_bf16 v[26:29], v[134:137], v[98:101], v[26:29]
    ds_read_b128 v[130:133], v241 offset:2048
    s_add_u32 s86, s74, 0x4000
    v_mfma_f32_16x16x32_bf16 v[30:33], v[134:137], v[102:105], v[30:33]
    s_waitcnt lgkmcnt(4)
    v_mfma_f32_16x16x32_bf16 v[34:37], v[138:141], v[98:101], v[34:37]
    ds_read_b128 v[134:137], v241 offset:3072
    v_mfma_f32_16x16x32_bf16 v[38:41], v[138:141], v[102:105], v[38:41]
    buffer_load_dwordx4 v[90:93], v252, s[48:51], s86 offen offset:3072
    s_waitcnt lgkmcnt(4)
    v_mfma_f32_16x16x32_bf16 v[42:45], v[142:145], v[98:101], v[42:45]
    ds_read_b128 v[138:141], v234 offset:8192
    v_mfma_f32_16x16x32_bf16 v[46:49], v[142:145], v[102:105], v[46:49]
    s_waitcnt lgkmcnt(4)
    v_mfma_f32_16x16x32_bf16 v[50:53], v[146:149], v[98:101], v[50:53]
    ds_read_b128 v[142:145], v240 offset:9216
    v_mfma_f32_16x16x32_bf16 v[54:57], v[146:149], v[102:105], v[54:57]
    s_waitcnt lgkmcnt(4)
    v_mfma_f32_16x16x32_bf16 v[58:61], v[150:153], v[98:101], v[58:61]
    ds_read_b128 v[146:149], v240 offset:10240
    v_mfma_f32_16x16x32_bf16 v[62:65], v[150:153], v[102:105], v[62:65]
    buffer_load_dwordx4 v[94:97], v253, s[48:51], s86 offen offset:3072
    s_waitcnt lgkmcnt(4)
    v_mfma_f32_16x16x32_bf16 v[154:157], v[130:133], v[98:101], v[154:157]
    ds_read_b128 v[150:153], v240 offset:11264
    v_mfma_f32_16x16x32_bf16 v[158:161], v[130:133], v[102:105], v[158:161]
    s_waitcnt lgkmcnt(4)
    v_mfma_f32_16x16x32_bf16 v[162:165], v[134:137], v[98:101], v[162:165]
    ds_read_b128 v[130:133], v240 offset:12288
    v_mfma_f32_16x16x32_bf16 v[166:169], v[134:137], v[102:105], v[166:169]
    s_waitcnt lgkmcnt(4)
    v_mfma_f32_16x16x32_bf16 v[170:173], v[138:141], v[98:101], v[170:173]
    ds_read_b128 v[134:137], v241 offset:9216
    v_mfma_f32_16x16x32_bf16 v[174:177], v[138:141], v[102:105], v[174:177]
    s_waitcnt vmcnt(13) lgkmcnt(4)
    v_mfma_f32_16x16x32_bf16 v[18:21], v[142:145], v[106:109], v[18:21]
    ds_read_b128 v[138:141], v241 offset:10240
    v_mfma_f32_16x16x32_bf16 v[22:25], v[142:145], v[110:113], v[22:25]
    s_waitcnt lgkmcnt(4)
    v_mfma_f32_16x16x32_bf16 v[26:29], v[146:149], v[106:109], v[26:29]
    ds_read_b128 v[142:145], v241 offset:11264
    s_add_u32 s86, s74, 0x5000
    v_mfma_f32_16x16x32_bf16 v[30:33], v[146:149], v[110:113], v[30:33]
    s_waitcnt lgkmcnt(4)
    v_mfma_f32_16x16x32_bf16 v[34:37], v[150:153], v[106:109], v[34:37]
    ds_read_b128 v[146:149], v241 offset:12288
    v_mfma_f32_16x16x32_bf16 v[38:41], v[150:153], v[110:113], v[38:41]
    buffer_load_dwordx4 v[98:101], v252, s[48:51], s86 offen
    s_waitcnt lgkmcnt(4)
    v_mfma_f32_16x16x32_bf16 v[42:45], v[130:133], v[106:109], v[42:45]
    ds_read_b128 v[150:153], v234 offset:17408
    v_mfma_f32_16x16x32_bf16 v[46:49], v[130:133], v[110:113], v[46:49]
    s_waitcnt lgkmcnt(4)
    v_mfma_f32_16x16x32_bf16 v[50:53], v[134:137], v[106:109], v[50:53]
    s_barrier
    ds_read_b128 v[130:133], v240 offset:18432
    v_mfma_f32_16x16x32_bf16 v[54:57], v[134:137], v[110:113], v[54:57]
    s_waitcnt lgkmcnt(4)
    v_mfma_f32_16x16x32_bf16 v[58:61], v[138:141], v[106:109], v[58:61]
    ds_read_b128 v[134:137], v240 offset:19456
    v_mfma_f32_16x16x32_bf16 v[62:65], v[138:141], v[110:113], v[62:65]
    buffer_load_dwordx4 v[102:105], v253, s[48:51], s86 offen
    s_waitcnt lgkmcnt(4)
    v_mfma_f32_16x16x32_bf16 v[154:157], v[142:145], v[106:109], v[154:157]
    ds_read_b128 v[138:141], v240 offset:20480
    v_mfma_f32_16x16x32_bf16 v[158:161], v[142:145], v[110:113], v[158:161]
    s_waitcnt lgkmcnt(4)
    v_mfma_f32_16x16x32_bf16 v[162:165], v[146:149], v[106:109], v[162:165]
    ds_read_b128 v[142:145], v240 offset:21504
    v_mfma_f32_16x16x32_bf16 v[166:169], v[146:149], v[110:113], v[166:169]
    s_waitcnt lgkmcnt(4)
    v_mfma_f32_16x16x32_bf16 v[170:173], v[150:153], v[106:109], v[170:173]
    ds_read_b128 v[146:149], v241 offset:18432
    v_mfma_f32_16x16x32_bf16 v[174:177], v[150:153], v[110:113], v[174:177]
    s_waitcnt vmcnt(13) lgkmcnt(4)
    v_mfma_f32_16x16x32_bf16 v[18:21], v[130:133], v[114:117], v[18:21]
    ds_read_b128 v[150:153], v241 offset:19456
    v_mfma_f32_16x16x32_bf16 v[22:25], v[130:133], v[118:121], v[22:25]
    s_waitcnt lgkmcnt(4)
    v_mfma_f32_16x16x32_bf16 v[26:29], v[134:137], v[114:117], v[26:29]
    ds_read_b128 v[130:133], v241 offset:20480
    s_add_u32 s86, s74, 0x5000
    v_mfma_f32_16x16x32_bf16 v[30:33], v[134:137], v[118:121], v[30:33]
    s_waitcnt lgkmcnt(4)
    v_mfma_f32_16x16x32_bf16 v[34:37], v[138:141], v[114:117], v[34:37]
    ds_read_b128 v[134:137], v241 offset:21504
    v_mfma_f32_16x16x32_bf16 v[38:41], v[138:141], v[118:121], v[38:41]
    buffer_load_dwordx4 v[106:109], v252, s[48:51], s86 offen offset:1024
    s_waitcnt lgkmcnt(4)
    v_mfma_f32_16x16x32_bf16 v[42:45], v[142:145], v[114:117], v[42:45]
    ds_read_b128 v[138:141], v234 offset:26624
    v_mfma_f32_16x16x32_bf16 v[46:49], v[142:145], v[118:121], v[46:49]
    s_waitcnt lgkmcnt(4)
    v_mfma_f32_16x16x32_bf16 v[50:53], v[146:149], v[114:117], v[50:53]
    ds_read_b128 v[142:145], v240 offset:27648
    v_mfma_f32_16x16x32_bf16 v[54:57], v[146:149], v[118:121], v[54:57]
    s_waitcnt lgkmcnt(4)
    v_mfma_f32_16x16x32_bf16 v[58:61], v[150:153], v[114:117], v[58:61]
    ds_read_b128 v[146:149], v240 offset:28672
    v_mfma_f32_16x16x32_bf16 v[62:65], v[150:153], v[118:121], v[62:65]
    buffer_load_dwordx4 v[110:113], v253, s[48:51], s86 offen offset:1024
    s_waitcnt lgkmcnt(4)
    v_mfma_f32_16x16x32_bf16 v[154:157], v[130:133], v[114:117], v[154:157]
    ds_read_b128 v[150:153], v240 offset:29696
    v_mfma_f32_16x16x32_bf16 v[158:161], v[130:133], v[118:121], v[158:161]
    s_waitcnt lgkmcnt(4)
    v_mfma_f32_16x16x32_bf16 v[162:165], v[134:137], v[114:117], v[162:165]
    ds_read_b128 v[130:133], v240 offset:30720
    v_mfma_f32_16x16x32_bf16 v[166:169], v[134:137], v[118:121], v[166:169]
    s_waitcnt lgkmcnt(4)
    v_mfma_f32_16x16x32_bf16 v[170:173], v[138:141], v[114:117], v[170:173]
    ds_read_b128 v[134:137], v241 offset:27648
    v_mfma_f32_16x16x32_bf16 v[174:177], v[138:141], v[118:121], v[174:177]
    s_waitcnt vmcnt(13) lgkmcnt(4)
    v_mfma_f32_16x16x32_bf16 v[18:21], v[142:145], v[122:125], v[18:21]
    ds_read_b128 v[138:141], v241 offset:28672
    v_mfma_f32_16x16x32_bf16 v[22:25], v[142:145], v[126:129], v[22:25]
    s_waitcnt lgkmcnt(4)
    v_mfma_f32_16x16x32_bf16 v[26:29], v[146:149], v[122:125], v[26:29]
    ds_read_b128 v[142:145], v241 offset:29696
    s_add_u32 s86, s74, 0x5000
    v_mfma_f32_16x16x32_bf16 v[30:33], v[146:149], v[126:129], v[30:33]
    s_waitcnt lgkmcnt(4)
    v_mfma_f32_16x16x32_bf16 v[34:37], v[150:153], v[122:125], v[34:37]
    ds_read_b128 v[146:149], v241 offset:30720
    v_mfma_f32_16x16x32_bf16 v[38:41], v[150:153], v[126:129], v[38:41]
    buffer_load_dwordx4 v[114:117], v252, s[48:51], s86 offen offset:2048
    s_waitcnt lgkmcnt(4)
    v_mfma_f32_16x16x32_bf16 v[42:45], v[130:133], v[122:125], v[42:45]
    ds_read_b128 v[150:153], v234 offset:35840
    v_mfma_f32_16x16x32_bf16 v[46:49], v[130:133], v[126:129], v[46:49]
    s_waitcnt lgkmcnt(4)
    v_mfma_f32_16x16x32_bf16 v[50:53], v[134:137], v[122:125], v[50:53]
    s_barrier
    ds_read_b128 v[130:133], v240 offset:36864
    v_mfma_f32_16x16x32_bf16 v[54:57], v[134:137], v[126:129], v[54:57]
    s_waitcnt lgkmcnt(4)
    v_mfma_f32_16x16x32_bf16 v[58:61], v[138:141], v[122:125], v[58:61]
    ds_read_b128 v[134:137], v240 offset:37888
    v_mfma_f32_16x16x32_bf16 v[62:65], v[138:141], v[126:129], v[62:65]
    buffer_load_dwordx4 v[118:121], v253, s[48:51], s86 offen offset:2048
    s_waitcnt lgkmcnt(4)
    v_mfma_f32_16x16x32_bf16 v[154:157], v[142:145], v[122:125], v[154:157]
    ds_read_b128 v[138:141], v240 offset:38912
    v_mfma_f32_16x16x32_bf16 v[158:161], v[142:145], v[126:129], v[158:161]
    s_waitcnt lgkmcnt(4)
    v_mfma_f32_16x16x32_bf16 v[162:165], v[146:149], v[122:125], v[162:165]
    ds_read_b128 v[142:145], v240 offset:39936
    v_mfma_f32_16x16x32_bf16 v[166:169], v[146:149], v[126:129], v[166:169]
    s_waitcnt lgkmcnt(4)
    v_mfma_f32_16x16x32_bf16 v[170:173], v[150:153], v[122:125], v[170:173]
    ds_read_b128 v[146:149], v241 offset:36864
    v_mfma_f32_16x16x32_bf16 v[174:177], v[150:153], v[126:129], v[174:177]
    s_waitcnt vmcnt(12) lgkmcnt(4)
    v_mfma_f32_16x16x32_bf16 v[18:21], v[130:133], v[66:69], v[18:21]
    ds_read_b128 v[150:153], v241 offset:37888
    v_mfma_f32_16x16x32_bf16 v[22:25], v[130:133], v[70:73], v[22:25]
    s_waitcnt lgkmcnt(4)
    v_mfma_f32_16x16x32_bf16 v[26:29], v[134:137], v[66:69], v[26:29]
    ds_read_b128 v[130:133], v241 offset:38912
    s_add_u32 s86, s74, 0x5000
    v_mfma_f32_16x16x32_bf16 v[30:33], v[134:137], v[70:73], v[30:33]
    s_waitcnt lgkmcnt(4)
    v_mfma_f32_16x16x32_bf16 v[34:37], v[138:141], v[66:69], v[34:37]
    ds_read_b128 v[134:137], v241 offset:39936
    v_mfma_f32_16x16x32_bf16 v[38:41], v[138:141], v[70:73], v[38:41]
    buffer_load_dwordx4 v[122:125], v252, s[48:51], s86 offen offset:3072
    s_waitcnt lgkmcnt(4)
    v_mfma_f32_16x16x32_bf16 v[42:45], v[142:145], v[66:69], v[42:45]
    ds_read_b128 v[138:141], v234 offset:45056
    v_mfma_f32_16x16x32_bf16 v[46:49], v[142:145], v[70:73], v[46:49]
    s_waitcnt lgkmcnt(4)
    v_mfma_f32_16x16x32_bf16 v[50:53], v[146:149], v[66:69], v[50:53]
    ds_read_b128 v[142:145], v240 offset:46080
    v_mfma_f32_16x16x32_bf16 v[54:57], v[146:149], v[70:73], v[54:57]
    s_waitcnt lgkmcnt(4)
    v_mfma_f32_16x16x32_bf16 v[58:61], v[150:153], v[66:69], v[58:61]
    ds_read_b128 v[146:149], v240 offset:47104
    v_mfma_f32_16x16x32_bf16 v[62:65], v[150:153], v[70:73], v[62:65]
    buffer_load_dwordx4 v[126:129], v253, s[48:51], s86 offen offset:3072
    s_waitcnt lgkmcnt(4)
    v_mfma_f32_16x16x32_bf16 v[154:157], v[130:133], v[66:69], v[154:157]
    ds_read_b128 v[150:153], v240 offset:48128
    v_mfma_f32_16x16x32_bf16 v[158:161], v[130:133], v[70:73], v[158:161]
    s_waitcnt lgkmcnt(4)
    v_mfma_f32_16x16x32_bf16 v[162:165], v[134:137], v[66:69], v[162:165]
    ds_read_b128 v[130:133], v240 offset:49152
    v_mfma_f32_16x16x32_bf16 v[166:169], v[134:137], v[70:73], v[166:169]
    s_waitcnt lgkmcnt(4)
    v_mfma_f32_16x16x32_bf16 v[170:173], v[138:141], v[66:69], v[170:173]
    ds_read_b128 v[134:137], v241 offset:46080
    v_mfma_f32_16x16x32_bf16 v[174:177], v[138:141], v[70:73], v[174:177]
    s_waitcnt vmcnt(12) lgkmcnt(4)
    v_mfma_f32_16x16x32_bf16 v[18:21], v[142:145], v[74:77], v[18:21]
    ds_read_b128 v[138:141], v241 offset:47104
    v_mfma_f32_16x16x32_bf16 v[22:25], v[142:145], v[78:81], v[22:25]
    s_waitcnt lgkmcnt(4)
    v_mfma_f32_16x16x32_bf16 v[26:29], v[146:149], v[74:77], v[26:29]
    ds_read_b128 v[142:145], v241 offset:48128
    s_add_u32 s86, s74, 0x6000
    v_mfma_f32_16x16x32_bf16 v[30:33], v[146:149], v[78:81], v[30:33]
    s_waitcnt lgkmcnt(4)
    v_mfma_f32_16x16x32_bf16 v[34:37], v[150:153], v[74:77], v[34:37]
    ds_read_b128 v[146:149], v241 offset:49152
    v_mfma_f32_16x16x32_bf16 v[38:41], v[150:153], v[78:81], v[38:41]
    buffer_load_dwordx4 v[66:69], v252, s[48:51], s86 offen
    s_waitcnt lgkmcnt(4)
    v_mfma_f32_16x16x32_bf16 v[42:45], v[130:133], v[74:77], v[42:45]
    ds_read_b128 v[150:153], v234 offset:54272
    v_mfma_f32_16x16x32_bf16 v[46:49], v[130:133], v[78:81], v[46:49]
    s_waitcnt lgkmcnt(4)
    v_mfma_f32_16x16x32_bf16 v[50:53], v[134:137], v[74:77], v[50:53]
    s_barrier
    ds_read_b128 v[130:133], v240 offset:55296
    v_mfma_f32_16x16x32_bf16 v[54:57], v[134:137], v[78:81], v[54:57]
    s_waitcnt lgkmcnt(4)
    v_mfma_f32_16x16x32_bf16 v[58:61], v[138:141], v[74:77], v[58:61]
    ds_read_b128 v[134:137], v240 offset:56320
    v_mfma_f32_16x16x32_bf16 v[62:65], v[138:141], v[78:81], v[62:65]
    buffer_load_dwordx4 v[70:73], v253, s[48:51], s86 offen
    s_waitcnt lgkmcnt(4)
    v_mfma_f32_16x16x32_bf16 v[154:157], v[142:145], v[74:77], v[154:157]
    ds_read_b128 v[138:141], v240 offset:57344
    v_mfma_f32_16x16x32_bf16 v[158:161], v[142:145], v[78:81], v[158:161]
    s_waitcnt lgkmcnt(4)
    v_mfma_f32_16x16x32_bf16 v[162:165], v[146:149], v[74:77], v[162:165]
    ds_read_b128 v[142:145], v240 offset:58368
    v_mfma_f32_16x16x32_bf16 v[166:169], v[146:149], v[78:81], v[166:169]
    s_waitcnt lgkmcnt(4)
    v_mfma_f32_16x16x32_bf16 v[170:173], v[150:153], v[74:77], v[170:173]
    ds_read_b128 v[146:149], v241 offset:55296
    v_mfma_f32_16x16x32_bf16 v[174:177], v[150:153], v[78:81], v[174:177]
    s_waitcnt vmcnt(12) lgkmcnt(4)
    v_mfma_f32_16x16x32_bf16 v[18:21], v[130:133], v[82:85], v[18:21]
    ds_read_b128 v[150:153], v241 offset:56320
    v_mfma_f32_16x16x32_bf16 v[22:25], v[130:133], v[86:89], v[22:25]
    s_waitcnt lgkmcnt(4)
    v_mfma_f32_16x16x32_bf16 v[26:29], v[134:137], v[82:85], v[26:29]
    ds_read_b128 v[130:133], v241 offset:57344
    s_add_u32 s86, s74, 0x6000
    v_mfma_f32_16x16x32_bf16 v[30:33], v[134:137], v[86:89], v[30:33]
    s_waitcnt lgkmcnt(4)
    v_mfma_f32_16x16x32_bf16 v[34:37], v[138:141], v[82:85], v[34:37]
    ds_read_b128 v[134:137], v241 offset:58368
    buffer_load_dword v239, v238, s[64:67], s75 offen offset:512
    v_mfma_f32_16x16x32_bf16 v[38:41], v[138:141], v[86:89], v[38:41]
    buffer_load_dwordx4 v[74:77], v252, s[48:51], s86 offen offset:1024
    s_waitcnt lgkmcnt(4)
    v_mfma_f32_16x16x32_bf16 v[42:45], v[142:145], v[82:85], v[42:45]
    ds_read_b128 v[138:141], v234 offset:63488
    v_mfma_f32_16x16x32_bf16 v[46:49], v[142:145], v[86:89], v[46:49]
    s_waitcnt lgkmcnt(4)
    v_mfma_f32_16x16x32_bf16 v[50:53], v[146:149], v[82:85], v[50:53]
    ds_read_b128 v[142:145], v240 offset:64512
    v_mfma_f32_16x16x32_bf16 v[54:57], v[146:149], v[86:89], v[54:57]
    s_waitcnt lgkmcnt(4)
    v_mfma_f32_16x16x32_bf16 v[58:61], v[150:153], v[82:85], v[58:61]
    ds_read_b128 v[146:149], v196
    v_mfma_f32_16x16x32_bf16 v[62:65], v[150:153], v[86:89], v[62:65]
    buffer_load_dwordx4 v[78:81], v253, s[48:51], s86 offen offset:1024
    s_waitcnt lgkmcnt(4)
    v_mfma_f32_16x16x32_bf16 v[154:157], v[130:133], v[82:85], v[154:157]
    ds_read_b128 v[150:153], v196 offset:1024
    v_mfma_f32_16x16x32_bf16 v[158:161], v[130:133], v[86:89], v[158:161]
    s_waitcnt lgkmcnt(4)
    v_mfma_f32_16x16x32_bf16 v[162:165], v[134:137], v[82:85], v[162:165]
    ds_read_b128 v[130:133], v196 offset:2048
    v_mfma_f32_16x16x32_bf16 v[166:169], v[134:137], v[86:89], v[166:169]
    s_waitcnt lgkmcnt(4)
    v_mfma_f32_16x16x32_bf16 v[170:173], v[138:141], v[82:85], v[170:173]
    ds_read_b128 v[134:137], v241 offset:64512
    v_mfma_f32_16x16x32_bf16 v[174:177], v[138:141], v[86:89], v[174:177]
    s_waitcnt vmcnt(13) lgkmcnt(4)
    v_mfma_f32_16x16x32_bf16 v[18:21], v[142:145], v[90:93], v[18:21]
    ds_read_b128 v[138:141], v197
    v_mfma_f32_16x16x32_bf16 v[22:25], v[142:145], v[94:97], v[22:25]
    s_waitcnt lgkmcnt(4)
    v_mfma_f32_16x16x32_bf16 v[26:29], v[146:149], v[90:93], v[26:29]
    ds_read_b128 v[142:145], v197 offset:1024
    s_add_u32 s86, s74, 0x6000
    v_mfma_f32_16x16x32_bf16 v[30:33], v[146:149], v[94:97], v[30:33]
    s_waitcnt lgkmcnt(4)
    v_mfma_f32_16x16x32_bf16 v[34:37], v[150:153], v[90:93], v[34:37]
    ds_read_b128 v[146:149], v197 offset:2048
    v_mfma_f32_16x16x32_bf16 v[38:41], v[150:153], v[94:97], v[38:41]
    buffer_load_dwordx4 v[82:85], v252, s[48:51], s86 offen offset:2048
    s_waitcnt lgkmcnt(4)
    v_mfma_f32_16x16x32_bf16 v[42:45], v[130:133], v[90:93], v[42:45]
    ds_read_b128 v[150:153], v198 offset:7168
    v_mfma_f32_16x16x32_bf16 v[46:49], v[130:133], v[94:97], v[46:49]
    s_waitcnt lgkmcnt(4)
    v_mfma_f32_16x16x32_bf16 v[50:53], v[134:137], v[90:93], v[50:53]
    s_barrier
    ds_read_b128 v[130:133], v196 offset:8192
    v_mfma_f32_16x16x32_bf16 v[54:57], v[134:137], v[94:97], v[54:57]
    s_waitcnt lgkmcnt(4)
    v_mfma_f32_16x16x32_bf16 v[58:61], v[138:141], v[90:93], v[58:61]
    ds_read_b128 v[134:137], v196 offset:9216
    v_mfma_f32_16x16x32_bf16 v[62:65], v[138:141], v[94:97], v[62:65]
    buffer_load_dwordx4 v[86:89], v253, s[48:51], s86 offen offset:2048
    s_waitcnt lgkmcnt(4)
    v_mfma_f32_16x16x32_bf16 v[154:157], v[142:145], v[90:93], v[154:157]
    ds_read_b128 v[138:141], v196 offset:10240
    v_mfma_f32_16x16x32_bf16 v[158:161], v[142:145], v[94:97], v[158:161]
    s_waitcnt lgkmcnt(4)
    v_mfma_f32_16x16x32_bf16 v[162:165], v[146:149], v[90:93], v[162:165]
    ds_read_b128 v[142:145], v196 offset:11264
    v_mfma_f32_16x16x32_bf16 v[166:169], v[146:149], v[94:97], v[166:169]
    s_waitcnt lgkmcnt(4)
    v_mfma_f32_16x16x32_bf16 v[170:173], v[150:153], v[90:93], v[170:173]
    ds_read_b128 v[146:149], v197 offset:8192
    v_mfma_f32_16x16x32_bf16 v[174:177], v[150:153], v[94:97], v[174:177]
    s_waitcnt vmcnt(13) lgkmcnt(4)
    v_mfma_f32_16x16x32_bf16 v[18:21], v[130:133], v[98:101], v[18:21]
    ds_read_b128 v[150:153], v197 offset:9216
    v_mfma_f32_16x16x32_bf16 v[22:25], v[130:133], v[102:105], v[22:25]
    s_waitcnt lgkmcnt(4)
    v_mfma_f32_16x16x32_bf16 v[26:29], v[134:137], v[98:101], v[26:29]
    ds_read_b128 v[130:133], v197 offset:10240
    s_add_u32 s86, s74, 0x6000
    v_mfma_f32_16x16x32_bf16 v[30:33], v[134:137], v[102:105], v[30:33]
    s_waitcnt lgkmcnt(4)
    v_mfma_f32_16x16x32_bf16 v[34:37], v[138:141], v[98:101], v[34:37]
    ds_read_b128 v[134:137], v197 offset:11264
    v_mfma_f32_16x16x32_bf16 v[38:41], v[138:141], v[102:105], v[38:41]
    buffer_load_dwordx4 v[90:93], v252, s[48:51], s86 offen offset:3072
    s_waitcnt lgkmcnt(4)
    v_mfma_f32_16x16x32_bf16 v[42:45], v[142:145], v[98:101], v[42:45]
    ds_read_b128 v[138:141], v198 offset:16384
    v_mfma_f32_16x16x32_bf16 v[46:49], v[142:145], v[102:105], v[46:49]
    s_waitcnt lgkmcnt(4)
    v_mfma_f32_16x16x32_bf16 v[50:53], v[146:149], v[98:101], v[50:53]
    ds_read_b128 v[142:145], v196 offset:17408
    v_mfma_f32_16x16x32_bf16 v[54:57], v[146:149], v[102:105], v[54:57]
    s_waitcnt lgkmcnt(4)
    v_mfma_f32_16x16x32_bf16 v[58:61], v[150:153], v[98:101], v[58:61]
    ds_read_b128 v[146:149], v196 offset:18432
    v_mfma_f32_16x16x32_bf16 v[62:65], v[150:153], v[102:105], v[62:65]
    buffer_load_dwordx4 v[94:97], v253, s[48:51], s86 offen offset:3072
    s_waitcnt lgkmcnt(4)
    v_mfma_f32_16x16x32_bf16 v[154:157], v[130:133], v[98:101], v[154:157]
    ds_read_b128 v[150:153], v196 offset:19456
    v_mfma_f32_16x16x32_bf16 v[158:161], v[130:133], v[102:105], v[158:161]
    s_waitcnt lgkmcnt(4)
    v_mfma_f32_16x16x32_bf16 v[162:165], v[134:137], v[98:101], v[162:165]
    ds_read_b128 v[130:133], v196 offset:20480
    v_mfma_f32_16x16x32_bf16 v[166:169], v[134:137], v[102:105], v[166:169]
    s_waitcnt lgkmcnt(4)
    v_mfma_f32_16x16x32_bf16 v[170:173], v[138:141], v[98:101], v[170:173]
    ds_read_b128 v[134:137], v197 offset:17408
    v_mfma_f32_16x16x32_bf16 v[174:177], v[138:141], v[102:105], v[174:177]
    s_waitcnt vmcnt(13) lgkmcnt(4)
    v_mfma_f32_16x16x32_bf16 v[18:21], v[142:145], v[106:109], v[18:21]
    ds_read_b128 v[138:141], v197 offset:18432
    v_mfma_f32_16x16x32_bf16 v[22:25], v[142:145], v[110:113], v[22:25]
    s_waitcnt lgkmcnt(4)
    v_mfma_f32_16x16x32_bf16 v[26:29], v[146:149], v[106:109], v[26:29]
    ds_read_b128 v[142:145], v197 offset:19456
    s_add_u32 s86, s74, 0x7000
    v_mfma_f32_16x16x32_bf16 v[30:33], v[146:149], v[110:113], v[30:33]
    s_waitcnt lgkmcnt(4)
    v_mfma_f32_16x16x32_bf16 v[34:37], v[150:153], v[106:109], v[34:37]
    ds_read_b128 v[146:149], v197 offset:20480
    v_mfma_f32_16x16x32_bf16 v[38:41], v[150:153], v[110:113], v[38:41]
    s_waitcnt vmcnt(6)
    v_cmp_eq_u32 vcc, -1, v239
    s_nop 1
    s_cmp_eq_u64 vcc, 0
    s_mov_b32 s10, 2
    s_cbranch_scc0 L_ff_poll
L_ff_r2:
    buffer_load_dwordx4 v[98:101], v252, s[48:51], s86 offen
    s_waitcnt lgkmcnt(4)
    v_mfma_f32_16x16x32_bf16 v[42:45], v[130:133], v[106:109], v[42:45]
    ds_read_b128 v[150:153], v198 offset:25600
    v_mfma_f32_16x16x32_bf16 v[46:49], v[130:133], v[110:113], v[46:49]
    s_waitcnt lgkmcnt(4)
    v_mfma_f32_16x16x32_bf16 v[50:53], v[134:137], v[106:109], v[50:53]
    s_barrier
    ds_read_b128 v[130:133], v196 offset:26624
    v_mfma_f32_16x16x32_bf16 v[54:57], v[134:137], v[110:113], v[54:57]
    s_waitcnt lgkmcnt(4)
    v_mfma_f32_16x16x32_bf16 v[58:61], v[138:141], v[106:109], v[58:61]
    ds_read_b128 v[134:137], v196 offset:27648
    v_mfma_f32_16x16x32_bf16 v[62:65], v[138:141], v[110:113], v[62:65]
    buffer_load_dwordx4 v[102:105], v253, s[48:51], s86 offen
    s_waitcnt lgkmcnt(4)
    v_mfma_f32_16x16x32_bf16 v[154:157], v[142:145], v[106:109], v[154:157]
    ds_read_b128 v[138:141], v196 offset:28672
    v_mfma_f32_16x16x32_bf16 v[158:161], v[142:145], v[110:113], v[158:161]
    s_waitcnt lgkmcnt(4)
    v_mfma_f32_16x16x32_bf16 v[162:165], v[146:149], v[106:109], v[162:165]
    ds_read_b128 v[142:145], v196 offset:29696
    v_mfma_f32_16x16x32_bf16 v[166:169], v[146:149], v[110:113], v[166:169]
    s_waitcnt lgkmcnt(4)
    v_mfma_f32_16x16x32_bf16 v[170:173], v[150:153], v[106:109], v[170:173]
    ds_read_b128 v[146:149], v197 offset:26624
    v_mfma_f32_16x16x32_bf16 v[174:177], v[150:153], v[110:113], v[174:177]
    s_waitcnt lgkmcnt(4)
    v_mfma_f32_16x16x32_bf16 v[18:21], v[130:133], v[114:117], v[18:21]
    ds_read_b128 v[150:153], v197 offset:27648
    v_mfma_f32_16x16x32_bf16 v[22:25], v[130:133], v[118:121], v[22:25]
    s_waitcnt lgkmcnt(4)
    v_mfma_f32_16x16x32_bf16 v[26:29], v[134:137], v[114:117], v[26:29]
    ds_read_b128 v[130:133], v197 offset:28672
    s_add_u32 s86, s74, 0x7000
    v_mfma_f32_16x16x32_bf16 v[30:33], v[134:137], v[118:121], v[30:33]
    s_waitcnt lgkmcnt(4)
    v_mfma_f32_16x16x32_bf16 v[34:37], v[138:141], v[114:117], v[34:37]
    ds_read_b128 v[134:137], v197 offset:29696
    v_mfma_f32_16x16x32_bf16 v[38:41], v[138:141], v[118:121], v[38:41]
    buffer_load_dwordx4 v[106:109], v252, s[48:51], s86 offen offset:1024
    s_waitcnt lgkmcnt(4)
    v_mfma_f32_16x16x32_bf16 v[42:45], v[142:145], v[114:117], v[42:45]
    ds_read_b128 v[138:141], v198 offset:34816
    v_mfma_f32_16x16x32_bf16 v[46:49], v[142:145], v[118:121], v[46:49]
    s_waitcnt lgkmcnt(4)
    v_mfma_f32_16x16x32_bf16 v[50:53], v[146:149], v[114:117], v[50:53]
    ds_read_b128 v[142:145], v196 offset:35840
    v_mfma_f32_16x16x32_bf16 v[54:57], v[146:149], v[118:121], v[54:57]
    s_waitcnt lgkmcnt(4)
    v_mfma_f32_16x16x32_bf16 v[58:61], v[150:153], v[114:117], v[58:61]
    ds_read_b128 v[146:149], v196 offset:36864
    v_mfma_f32_16x16x32_bf16 v[62:65], v[150:153], v[118:121], v[62:65]
    buffer_load_dwordx4 v[110:113], v253, s[48:51], s86 offen offset:1024
    s_waitcnt lgkmcnt(4)
    v_mfma_f32_16x16x32_bf16 v[154:157], v[130:133], v[114:117], v[154:157]
    ds_read_b128 v[150:153], v196 offset:37888
    v_mfma_f32_16x16x32_bf16 v[158:161], v[130:133], v[118:121], v[158:161]
    s_waitcnt lgkmcnt(4)
    v_mfma_f32_16x16x32_bf16 v[162:165], v[134:137], v[114:117], v[162:165]
    ds_read_b128 v[130:133], v196 offset:38912
    v_mfma_f32_16x16x32_bf16 v[166:169], v[134:137], v[118:121], v[166:169]
    s_waitcnt lgkmcnt(4)
    v_mfma_f32_16x16x32_bf16 v[170:173], v[138:141], v[114:117], v[170:173]
    ds_read_b128 v[134:137], v197 offset:35840
    v_mfma_f32_16x16x32_bf16 v[174:177], v[138:141], v[118:121], v[174:177]
    s_waitcnt lgkmcnt(4)
    v_mfma_f32_16x16x32_bf16 v[18:21], v[142:145], v[122:125], v[18:21]
    ds_read_b128 v[138:141], v197 offset:36864
    v_mfma_f32_16x16x32_bf16 v[22:25], v[142:145], v[126:129], v[22:25]
    s_waitcnt lgkmcnt(4)
    v_mfma_f32_16x16x32_bf16 v[26:29], v[146:149], v[122:125], v[26:29]
    ds_read_b128 v[142:145], v197 offset:37888
    s_add_u32 s86, s74, 0x7000
    v_mfma_f32_16x16x32_bf16 v[30:33], v[146:149], v[126:129], v[30:33]
    s_waitcnt lgkmcnt(4)
    v_mfma_f32_16x16x32_bf16 v[34:37], v[150:153], v[122:125], v[34:37]
    ds_read_b128 v[146:149], v197 offset:38912
    v_mfma_f32_16x16x32_bf16 v[38:41], v[150:153], v[126:129], v[38:41]
    buffer_load_dwordx4 v[114:117], v252, s[48:51], s86 offen offset:2048
    s_waitcnt lgkmcnt(4)
    v_mfma_f32_16x16x32_bf16 v[42:45], v[130:133], v[122:125], v[42:45]
    ds_read_b128 v[150:153], v198 offset:44032
    v_mfma_f32_16x16x32_bf16 v[46:49], v[130:133], v[126:129], v[46:49]
    s_waitcnt lgkmcnt(4)
    v_mfma_f32_16x16x32_bf16 v[50:53], v[134:137], v[122:125], v[50:53]
    s_barrier
    ds_read_b128 v[130:133], v240
    v_mfma_f32_16x16x32_bf16 v[54:57], v[134:137], v[126:129], v[54:57]
    s_waitcnt lgkmcnt(4)
    v_mfma_f32_16x16x32_bf16 v[58:61], v[138:141], v[122:125], v[58:61]
    ds_read_b128 v[134:137], v240 offset:1024
    v_mfma_f32_16x16x32_bf16 v[62:65], v[138:141], v[126:129], v[62:65]
    buffer_load_dwordx4 v[118:121], v253, s[48:51], s86 offen offset:2048
    s_waitcnt lgkmcnt(4)
    v_mfma_f32_16x16x32_bf16 v[154:157], v[142:145], v[122:125], v[154:157]
    ds_read_b128 v[138:141], v240 offset:2048
    v_mfma_f32_16x16x32_bf16 v[158:161], v[142:145], v[126:129], v[158:161]
    s_waitcnt lgkmcnt(4)
    v_mfma_f32_16x16x32_bf16 v[162:165], v[146:149], v[122:125], v[162:165]
    ds_read_b128 v[142:145], v240 offset:3072
    v_mfma_f32_16x16x32_bf16 v[166:169], v[146:149], v[126:129], v[166:169]
    s_waitcnt lgkmcnt(4)
    v_mfma_f32_16x16x32_bf16 v[170:173], v[150:153], v[122:125], v[170:173]
    ds_read_b128 v[146:149], v241
    v_mfma_f32_16x16x32_bf16 v[174:177], v[150:153], v[126:129], v[174:177]
    s_waitcnt lgkmcnt(4)
    v_mfma_f32_16x16x32_bf16 v[22:25], v[130:133], v[70:73], v[22:25]
    ds_read_b128 v[150:153], v241 offset:1024
    s_waitcnt lgkmcnt(4)
    v_mfma_f32_16x16x32_bf16 v[30:33], v[134:137], v[70:73], v[30:33]
    ds_read_b128 v[130:133], v241 offset:2048
    s_add_u32 s86, s74, 0x7000
    s_waitcnt lgkmcnt(4)
    v_mfma_f32_16x16x32_bf16 v[38:41], v[138:141], v[70:73], v[38:41]
    ds_read_b128 v[134:137], v241 offset:3072
    buffer_load_dwordx4 v[122:125], v252, s[48:51], s86 offen offset:3072
    s_waitcnt lgkmcnt(4)
    v_mfma_f32_16x16x32_bf16 v[46:49], v[142:145], v[70:73], v[46:49]
    ds_read_b128 v[138:141], v234 offset:8192
    s_waitcnt lgkmcnt(4)
    v_mfma_f32_16x16x32_bf16 v[50:53], v[146:149], v[66:69], v[50:53]
    ds_read_b128 v[142:145], v240 offset:9216
    v_mfma_f32_16x16x32_bf16 v[54:57], v[146:149], v[70:73], v[54:57]
    s_waitcnt lgkmcnt(4)
    v_mfma_f32_16x16x32_bf16 v[58:61], v[150:153], v[66:69], v[58:61]
    ds_read_b128 v[146:149], v240 offset:10240
    v_mfma_f32_16x16x32_bf16 v[62:65], v[150:153], v[70:73], v[62:65]
    buffer_load_dwordx4 v[126:129], v253, s[48:51], s86 offen offset:3072
    s_waitcnt lgkmcnt(4)
    v_mfma_f32_16x16x32_bf16 v[154:157], v[130:133], v[66:69], v[154:157]
    ds_read_b128 v[150:153], v240 offset:11264
    v_mfma_f32_16x16x32_bf16 v[158:161], v[130:133], v[70:73], v[158:161]
    s_waitcnt lgkmcnt(4)
    v_mfma_f32_16x16x32_bf16 v[162:165], v[134:137], v[66:69], v[162:165]
    ds_read_b128 v[130:133], v240 offset:12288
    v_mfma_f32_16x16x32_bf16 v[166:169], v[134:137], v[70:73], v[166:169]
    s_waitcnt lgkmcnt(4)
    v_mfma_f32_16x16x32_bf16 v[170:173], v[138:141], v[66:69], v[170:173]
    ds_read_b128 v[134:137], v241 offset:9216
    v_mfma_f32_16x16x32_bf16 v[174:177], v[138:141], v[70:73], v[174:177]
    s_waitcnt vmcnt(12) lgkmcnt(4)
    v_mfma_f32_16x16x32_bf16 v[22:25], v[142:145], v[78:81], v[22:25]
    ds_read_b128 v[138:141], v241 offset:10240
    s_waitcnt lgkmcnt(4)
    v_mfma_f32_16x16x32_bf16 v[30:33], v[146:149], v[78:81], v[30:33]
    ds_read_b128 v[142:145], v241 offset:11264
    s_add_u32 s86, s74, 0x8000
    s_waitcnt lgkmcnt(4)
    v_mfma_f32_16x16x32_bf16 v[38:41], v[150:153], v[78:81], v[38:41]
    ds_read_b128 v[146:149], v241 offset:12288
    buffer_load_dwordx4 v[2:5], v252, s[48:51], s86 offen
    s_waitcnt lgkmcnt(4)
    v_mfma_f32_16x16x32_bf16 v[46:49], v[130:133], v[78:81], v[46:49]
    ds_read_b128 v[150:153], v234 offset:17408
    s_waitcnt lgkmcnt(4)
    v_mfma_f32_16x16x32_bf16 v[50:53], v[134:137], v[74:77], v[50:53]
    s_barrier
    ds_read_b128 v[130:133], v240 offset:18432
    v_mfma_f32_16x16x32_bf16 v[54:57], v[134:137], v[78:81], v[54:57]
    s_waitcnt lgkmcnt(4)
    v_mfma_f32_16x16x32_bf16 v[58:61], v[138:141], v[74:77], v[58:61]
    ds_read_b128 v[134:137], v240 offset:19456
    v_mfma_f32_16x16x32_bf16 v[62:65], v[138:141], v[78:81], v[62:65]
    buffer_load_dwordx4 v[70:73], v253, s[48:51], s86 offen
    s_waitcnt lgkmcnt(4)
    v_mfma_f32_16x16x32_bf16 v[154:157], v[142:145], v[74:77], v[154:157]
    ds_read_b128 v[138:141], v240 offset:20480
    v_mfma_f32_16x16x32_bf16 v[158:161], v[142:145], v[78:81], v[158:161]
    s_waitcnt lgkmcnt(4)
    v_mfma_f32_16x16x32_bf16 v[162:165], v[146:149], v[74:77], v[162:165]
    ds_read_b128 v[142:145], v240 offset:21504
    v_mfma_f32_16x16x32_bf16 v[166:169], v[146:149], v[78:81], v[166:169]
    s_waitcnt lgkmcnt(4)
    v_mfma_f32_16x16x32_bf16 v[170:173], v[150:153], v[74:77], v[170:173]
    ds_read_b128 v[146:149], v241 offset:18432
    v_mfma_f32_16x16x32_bf16 v[174:177], v[150:153], v[78:81], v[174:177]
    s_waitcnt vmcnt(12) lgkmcnt(4)
    v_mfma_f32_16x16x32_bf16 v[22:25], v[130:133], v[86:89], v[22:25]
    ds_read_b128 v[150:153], v241 offset:19456
    s_waitcnt lgkmcnt(4)
    v_mfma_f32_16x16x32_bf16 v[30:33], v[134:137], v[86:89], v[30:33]
    ds_read_b128 v[130:133], v241 offset:20480
    s_add_u32 s86, s74, 0x8000
    s_waitcnt lgkmcnt(4)
    v_mfma_f32_16x16x32_bf16 v[38:41], v[138:141], v[86:89], v[38:41]
    ds_read_b128 v[134:137], v241 offset:21504
    buffer_load_dwordx4 v[6:9], v252, s[48:51], s86 offen offset:1024
    s_waitcnt lgkmcnt(4)
    v_mfma_f32_16x16x32_bf16 v[46:49], v[142:145], v[86:89], v[46:49]
    ds_read_b128 v[138:141], v234 offset:26624
    s_waitcnt lgkmcnt(4)
    v_mfma_f32_16x16x32_bf16 v[50:53], v[146:149], v[82:85], v[50:53]
    ds_read_b128 v[142:145], v240 offset:27648
    v_mfma_f32_16x16x32_bf16 v[54:57], v[146:149], v[86:89], v[54:57]
    s_waitcnt lgkmcnt(4)
    v_mfma_f32_16x16x32_bf16 v[58:61], v[150:153], v[82:85], v[58:61]
    ds_read_b128 v[146:149], v240 offset:28672
    v_mfma_f32_16x16x32_bf16 v[62:65], v[150:153], v[86:89], v[62:65]
    buffer_load_dwordx4 v[78:81], v253, s[48:51], s86 offen offset:1024
    s_waitcnt lgkmcnt(4)
    v_mfma_f32_16x16x32_bf16 v[154:157], v[130:133], v[82:85], v[154:157]
    ds_read_b128 v[150:153], v240 offset:29696
    v_mfma_f32_16x16x32_bf16 v[158:161], v[130:133], v[86:89], v[158:161]
    s_waitcnt lgkmcnt(4)
    v_mfma_f32_16x16x32_bf16 v[162:165], v[134:137], v[82:85], v[162:165]
    ds_read_b128 v[130:133], v240 offset:30720
    v_mfma_f32_16x16x32_bf16 v[166:169], v[134:137], v[86:89], v[166:169]
    s_waitcnt lgkmcnt(4)
    v_mfma_f32_16x16x32_bf16 v[170:173], v[138:141], v[82:85], v[170:173]
    ds_read_b128 v[134:137], v241 offset:27648
    v_mfma_f32_16x16x32_bf16 v[174:177], v[138:141], v[86:89], v[174:177]
    s_waitcnt vmcnt(12) lgkmcnt(4)
    v_mfma_f32_16x16x32_bf16 v[22:25], v[142:145], v[94:97], v[22:25]
    ds_read_b128 v[138:141], v241 offset:28672
    s_waitcnt lgkmcnt(4)
    v_mfma_f32_16x16x32_bf16 v[30:33], v[146:149], v[94:97], v[30:33]
    ds_read_b128 v[142:145], v241 offset:29696
    s_add_u32 s86, s74, 0x8000
    s_waitcnt lgkmcnt(4)
    v_mfma_f32_16x16x32_bf16 v[38:41], v[150:153], v[94:97], v[38:41]
    ds_read_b128 v[146:149], v241 offset:30720
    buffer_load_dwordx4 v[10:13], v252, s[48:51], s86 offen offset:2048
    s_waitcnt lgkmcnt(4)
    v_mfma_f32_16x16x32_bf16 v[46:49], v[130:133], v[94:97], v[46:49]
    ds_read_b128 v[150:153], v234 offset:35840
    s_waitcnt lgkmcnt(4)
    v_mfma_f32_16x16x32_bf16 v[50:53], v[134:137], v[90:93], v[50:53]
    s_barrier
    ds_read_b128 v[130:133], v234 offset:45056
    v_mfma_f32_16x16x32_bf16 v[54:57], v[134:137], v[94:97], v[54:57]
    s_waitcnt lgkmcnt(4)
    v_mfma_f32_16x16x32_bf16 v[58:61], v[138:141], v[90:93], v[58:61]
    ds_read_b128 v[134:137], v241 offset:36864
    v_mfma_f32_16x16x32_bf16 v[62:65], v[138:141], v[94:97], v[62:65]
    buffer_load_dwordx4 v[86:89], v253, s[48:51], s86 offen offset:2048
    s_waitcnt lgkmcnt(4)
    v_mfma_f32_16x16x32_bf16 v[154:157], v[142:145], v[90:93], v[154:157]
    ds_read_b128 v[138:141], v241 offset:37888
    v_mfma_f32_16x16x32_bf16 v[158:161], v[142:145], v[94:97], v[158:161]
    s_waitcnt lgkmcnt(4)
    v_mfma_f32_16x16x32_bf16 v[162:165], v[146:149], v[90:93], v[162:165]
    ds_read_b128 v[142:145], v241 offset:38912
    v_mfma_f32_16x16x32_bf16 v[166:169], v[146:149], v[94:97], v[166:169]
    s_waitcnt lgkmcnt(4)
    v_mfma_f32_16x16x32_bf16 v[170:173], v[150:153], v[90:93], v[170:173]
    ds_read_b128 v[146:149], v241 offset:39936
    v_mfma_f32_16x16x32_bf16 v[174:177], v[150:153], v[94:97], v[174:177]
    s_waitcnt vmcnt(12) lgkmcnt(4)
    v_mfma_f32_16x16x32_bf16 v[170:173], v[130:133], v[98:101], v[170:173]
    ds_read_b128 v[150:153], v234 offset:54272
    s_add_u32 s86, s74, 0x8000
    v_mfma_f32_16x16x32_bf16 v[174:177], v[130:133], v[102:105], v[174:177]
    buffer_load_dwordx4 v[94:97], v253, s[48:51], s86 offen offset:3072
    s_waitcnt lgkmcnt(4)
    v_mfma_f32_16x16x32_bf16 v[54:57], v[134:137], v[102:105], v[54:57]
    ds_read_b128 v[130:133], v241 offset:46080
    buffer_load_dwordx4 v[14:17], v252, s[48:51], s86 offen offset:3072
    s_waitcnt lgkmcnt(4)
    v_mfma_f32_16x16x32_bf16 v[62:65], v[138:141], v[102:105], v[62:65]
    ds_read_b128 v[134:137], v241 offset:47104
    s_waitcnt lgkmcnt(4)
    v_mfma_f32_16x16x32_bf16 v[158:161], v[142:145], v[102:105], v[158:161]
    ds_read_b128 v[138:141], v241 offset:48128
    s_waitcnt lgkmcnt(4)
    v_mfma_f32_16x16x32_bf16 v[166:169], v[146:149], v[102:105], v[166:169]
    ds_read_b128 v[142:145], v241 offset:49152
    s_waitcnt vmcnt(12) lgkmcnt(4)
    v_mfma_f32_16x16x32_bf16 v[170:173], v[150:153], v[106:109], v[170:173]
    s_barrier
    ds_read_b128 v[146:149], v234 offset:63488
    v_mfma_f32_16x16x32_bf16 v[174:177], v[150:153], v[110:113], v[174:177]
    s_waitcnt lgkmcnt(4)
    v_mfma_f32_16x16x32_bf16 v[54:57], v[130:133], v[110:113], v[54:57]
    ds_read_b128 v[150:153], v241 offset:55296
    s_waitcnt lgkmcnt(4)
    v_mfma_f32_16x16x32_bf16 v[62:65], v[134:137], v[110:113], v[62:65]
    ds_read_b128 v[130:133], v241 offset:56320
    s_waitcnt lgkmcnt(4)
    v_mfma_f32_16x16x32_bf16 v[158:161], v[138:141], v[110:113], v[158:161]
    ds_read_b128 v[134:137], v241 offset:57344
    s_waitcnt lgkmcnt(4)
    v_mfma_f32_16x16x32_bf16 v[166:169], v[142:145], v[110:113], v[166:169]
    ds_read_b128 v[138:141], v241 offset:58368
    s_waitcnt vmcnt(10) lgkmcnt(4)
    v_mfma_f32_16x16x32_bf16 v[170:173], v[146:149], v[114:117], v[170:173]
    ds_read_b128 v[142:145], v198 offset:7168
    v_mfma_f32_16x16x32_bf16 v[174:177], v[146:149], v[118:121], v[174:177]
    s_waitcnt lgkmcnt(4)
    v_mfma_f32_16x16x32_bf16 v[54:57], v[150:153], v[118:121], v[54:57]
    ds_read_b128 v[146:149], v241 offset:64512
    s_waitcnt lgkmcnt(4)
    v_mfma_f32_16x16x32_bf16 v[62:65], v[130:133], v[118:121], v[62:65]
    ds_read_b128 v[150:153], v197
    s_waitcnt lgkmcnt(4)
    v_mfma_f32_16x16x32_bf16 v[158:161], v[134:137], v[118:121], v[158:161]
    ds_read_b128 v[130:133], v197 offset:1024
    s_waitcnt lgkmcnt(4)
    v_mfma_f32_16x16x32_bf16 v[166:169], v[138:141], v[118:121], v[166:169]
    ds_read_b128 v[134:137], v197 offset:2048
    s_waitcnt vmcnt(8) lgkmcnt(4)
    v_mfma_f32_16x16x32_bf16 v[170:173], v[142:145], v[122:125], v[170:173]
    s_barrier
    ds_read_b128 v[138:141], v198 offset:16384
    v_mfma_f32_16x16x32_bf16 v[174:177], v[142:145], v[126:129], v[174:177]
    s_waitcnt lgkmcnt(4)
    v_mfma_f32_16x16x32_bf16 v[54:57], v[146:149], v[126:129], v[54:57]
    ds_read_b128 v[142:145], v197 offset:8192
    s_waitcnt lgkmcnt(4)
    v_mfma_f32_16x16x32_bf16 v[62:65], v[150:153], v[126:129], v[62:65]
    ds_read_b128 v[146:149], v197 offset:9216
    s_waitcnt lgkmcnt(4)
    v_mfma_f32_16x16x32_bf16 v[158:161], v[130:133], v[126:129], v[158:161]
    ds_read_b128 v[150:153], v197 offset:10240
    buffer_load_dwordx4 v[178:181], v199, s[36:39], s77 offen
    s_waitcnt lgkmcnt(4)
    v_mfma_f32_16x16x32_bf16 v[166:169], v[134:137], v[126:129], v[166:169]
    ds_read_b128 v[130:133], v197 offset:11264
    s_waitcnt vmcnt(7) lgkmcnt(4)
    v_mfma_f32_16x16x32_bf16 v[170:173], v[138:141], v[2:5], v[170:173]
    ds_read_b128 v[134:137], v198 offset:25600
    buffer_load_dwordx4 v[182:185], v199, s[36:39], s77 offen offset:256
    v_mfma_f32_16x16x32_bf16 v[174:177], v[138:141], v[70:73], v[174:177]
    s_waitcnt lgkmcnt(4)
    v_mfma_f32_16x16x32_bf16 v[54:57], v[142:145], v[70:73], v[54:57]
    ds_read_b128 v[138:141], v197 offset:17408
    s_waitcnt lgkmcnt(4)
    v_mfma_f32_16x16x32_bf16 v[62:65], v[146:149], v[70:73], v[62:65]
    ds_read_b128 v[142:145], v197 offset:18432
    buffer_load_dwordx4 v[186:189], v199, s[36:39], s77 offen offset:512
    s_waitcnt lgkmcnt(4)
    v_mfma_f32_16x16x32_bf16 v[158:161], v[150:153], v[70:73], v[158:161]
    ds_read_b128 v[146:149], v197 offset:19456
    s_waitcnt lgkmcnt(4)
    v_mfma_f32_16x16x32_bf16 v[166:169], v[130:133], v[70:73], v[166:169]
    ds_read_b128 v[150:153], v197 offset:20480
    buffer_load_dwordx4 v[190:193], v199, s[36:39], s77 offen offset:768
    s_waitcnt vmcnt(8) lgkmcnt(4)
    v_mfma_f32_16x16x32_bf16 v[170:173], v[134:137], v[6:9], v[170:173]
    s_barrier
    ds_read_b128 v[130:133], v198 offset:34816
    v_mfma_f32_16x16x32_bf16 v[174:177], v[134:137], v[78:81], v[174:177]
    s_waitcnt lgkmcnt(4)
    v_mfma_f32_16x16x32_bf16 v[54:57], v[138:141], v[78:81], v[54:57]
    ds_read_b128 v[134:137], v197 offset:26624
    buffer_load_dword v194, v199, s[36:39], s78 offen
    s_waitcnt lgkmcnt(4)
    v_mfma_f32_16x16x32_bf16 v[62:65], v[142:145], v[78:81], v[62:65]
    ds_read_b128 v[138:141], v197 offset:27648
    buffer_load_dword v195, v199, s[36:39], s78 offen offset:512
    s_waitcnt lgkmcnt(4)
    v_mfma_f32_16x16x32_bf16 v[158:161], v[146:149], v[78:81], v[158:161]
    ds_read_b128 v[142:145], v197 offset:28672
    s_waitcnt lgkmcnt(4)
    v_mfma_f32_16x16x32_bf16 v[166:169], v[150:153], v[78:81], v[166:169]
    ds_read_b128 v[146:149], v197 offset:29696
    s_waitcnt vmcnt(8) lgkmcnt(4)
    v_mfma_f32_16x16x32_bf16 v[170:173], v[130:133], v[10:13], v[170:173]
    ds_read_b128 v[150:153], v198 offset:44032
    v_mfma_f32_16x16x32_bf16 v[174:177], v[130:133], v[86:89], v[174:177]
    s_waitcnt lgkmcnt(4)
    v_mfma_f32_16x16x32_bf16 v[54:57], v[134:137], v[86:89], v[54:57]
    ds_read_b128 v[130:133], v197 offset:35840
    s_waitcnt lgkmcnt(4)
    v_mfma_f32_16x16x32_bf16 v[62:65], v[138:141], v[86:89], v[62:65]
    ds_read_b128 v[134:137], v197 offset:36864
    s_waitcnt lgkmcnt(4)
    v_mfma_f32_16x16x32_bf16 v[158:161], v[142:145], v[86:89], v[158:161]
    ds_read_b128 v[138:141], v197 offset:37888
    s_waitcnt lgkmcnt(4)
    v_mfma_f32_16x16x32_bf16 v[166:169], v[146:149], v[86:89], v[166:169]
    ds_read_b128 v[142:145], v197 offset:38912
    s_waitcnt vmcnt(6) lgkmcnt(4)
    v_mfma_f32_16x16x32_bf16 v[170:173], v[150:153], v[14:17], v[170:173]
    ds_read_b128 v[146:149], v241 offset:36864
    v_mfma_f32_16x16x32_bf16 v[174:177], v[150:153], v[94:97], v[174:177]
    s_waitcnt lgkmcnt(4)
    v_mfma_f32_16x16x32_bf16 v[54:57], v[130:133], v[94:97], v[54:57]
    ds_read_b128 v[150:153], v241 offset:37888
    s_waitcnt lgkmcnt(4)
    v_mfma_f32_16x16x32_bf16 v[62:65], v[134:137], v[94:97], v[62:65]
    ds_read_b128 v[130:133], v241 offset:38912
    s_waitcnt lgkmcnt(4)
    v_mfma_f32_16x16x32_bf16 v[158:161], v[138:141], v[94:97], v[158:161]
    ds_read_b128 v[134:137], v241 offset:39936
    v_cvt_pk_bf16_f32 v207, v174, v176
    s_add_u32 s13, s88, 0x1800
    buffer_store_dword v207, v201, s[64:67], s13 offen sc1
    s_waitcnt lgkmcnt(4)
    v_mfma_f32_16x16x32_bf16 v[166:169], v[142:145], v[94:97], v[166:169]
    ds_read_b128 v[138:141], v241 offset:46080
    v_cvt_pk_bf16_f32 v208, v171, v173
    s_add_u32 s13, s89, 0x1800
    buffer_store_dword v208, v201, s[64:67], s13 offen offset:256 sc1
    s_waitcnt lgkmcnt(4)
    v_mfma_f32_16x16x32_bf16 v[50:53], v[146:149], v[98:101], v[50:53]
    ds_read_b128 v[142:145], v241 offset:47104
    v_cvt_pk_bf16_f32 v209, v175, v177
    s_add_u32 s13, s90, 0x1800
    buffer_store_dword v209, v201, s[64:67], s13 offen offset:512 sc1
    s_waitcnt lgkmcnt(4)
    v_mfma_f32_16x16x32_bf16 v[58:61], v[150:153], v[98:101], v[58:61]
    ds_read_b128 v[146:149], v241 offset:48128
    v_cvt_pk_bf16_f32 v226, v54, v55
    v_cvt_pk_bf16_f32 v227, v56, v57
    s_waitcnt lgkmcnt(4)
    v_mfma_f32_16x16x32_bf16 v[154:157], v[130:133], v[98:101], v[154:157]
    ds_read_b128 v[150:153], v241 offset:49152
    v_cvt_pk_bf16_f32 v228, v62, v63
    v_cvt_pk_bf16_f32 v229, v64, v65
    s_add_u32 s13, s90, 0x1000
    buffer_store_dwordx4 v[226:229], v1, s[64:67], s13 offen sc1
    s_waitcnt lgkmcnt(4)
    v_mfma_f32_16x16x32_bf16 v[162:165], v[134:137], v[98:101], v[162:165]
    ds_read_b128 v[130:133], v241 offset:55296
    v_cvt_pk_bf16_f32 v230, v158, v159
    v_cvt_pk_bf16_f32 v231, v160, v161
    s_waitcnt lgkmcnt(4)
    v_mfma_f32_16x16x32_bf16 v[50:53], v[138:141], v[106:109], v[50:53]
    ds_read_b128 v[134:137], v241 offset:56320
    v_cvt_pk_bf16_f32 v232, v166, v167
    v_cvt_pk_bf16_f32 v233, v168, v169
    s_add_u32 s13, s90, 0x1000
    buffer_store_dwordx4 v[230:233], v1, s[64:67], s13 offen offset:1024 sc1
    s_waitcnt lgkmcnt(4)
    v_mfma_f32_16x16x32_bf16 v[58:61], v[142:145], v[106:109], v[58:61]
    ds_read_b128 v[138:141], v241 offset:57344
    s_waitcnt lgkmcnt(4)
    v_mfma_f32_16x16x32_bf16 v[154:157], v[146:149], v[106:109], v[154:157]
    ds_read_b128 v[142:145], v241 offset:58368
    s_waitcnt lgkmcnt(4)
    v_mfma_f32_16x16x32_bf16 v[162:165], v[150:153], v[106:109], v[162:165]
    ds_read_b128 v[146:149], v241 offset:64512
    s_waitcnt lgkmcnt(4)
    v_mfma_f32_16x16x32_bf16 v[50:53], v[130:133], v[114:117], v[50:53]
    ds_read_b128 v[150:153], v197
    s_waitcnt lgkmcnt(4)
    v_mfma_f32_16x16x32_bf16 v[58:61], v[134:137], v[114:117], v[58:61]
    ds_read_b128 v[130:133], v197 offset:1024
    s_waitcnt lgkmcnt(4)
    v_mfma_f32_16x16x32_bf16 v[154:157], v[138:141], v[114:117], v[154:157]
    ds_read_b128 v[134:137], v197 offset:2048
    s_waitcnt lgkmcnt(4)
    v_mfma_f32_16x16x32_bf16 v[162:165], v[142:145], v[114:117], v[162:165]
    ds_read_b128 v[138:141], v197 offset:8192
    s_waitcnt lgkmcnt(4)
    v_mfma_f32_16x16x32_bf16 v[50:53], v[146:149], v[122:125], v[50:53]
    ds_read_b128 v[142:145], v197 offset:9216
    s_waitcnt lgkmcnt(4)
    v_mfma_f32_16x16x32_bf16 v[58:61], v[150:153], v[122:125], v[58:61]
    ds_read_b128 v[146:149], v197 offset:10240
    s_waitcnt lgkmcnt(4)
    v_mfma_f32_16x16x32_bf16 v[154:157], v[130:133], v[122:125], v[154:157]
    ds_read_b128 v[150:153], v197 offset:11264
    s_waitcnt lgkmcnt(4)
    v_mfma_f32_16x16x32_bf16 v[162:165], v[134:137], v[122:125], v[162:165]
    ds_read_b128 v[130:133], v197 offset:17408
    s_waitcnt lgkmcnt(4)
    v_mfma_f32_16x16x32_bf16 v[50:53], v[138:141], v[2:5], v[50:53]
    ds_read_b128 v[134:137], v197 offset:18432
    s_waitcnt lgkmcnt(4)
    v_mfma_f32_16x16x32_bf16 v[58:61], v[142:145], v[2:5], v[58:61]
    ds_read_b128 v[138:141], v197 offset:19456
    s_waitcnt lgkmcnt(4)
    v_mfma_f32_16x16x32_bf16 v[154:157], v[146:149], v[2:5], v[154:157]
    ds_read_b128 v[142:145], v197 offset:20480
    s_waitcnt lgkmcnt(4)
    v_mfma_f32_16x16x32_bf16 v[162:165], v[150:153], v[2:5], v[162:165]
    ds_read_b128 v[146:149], v197 offset:26624
    s_waitcnt lgkmcnt(4)
    v_mfma_f32_16x16x32_bf16 v[50:53], v[130:133], v[6:9], v[50:53]
    ds_read_b128 v[150:153], v197 offset:27648
    s_waitcnt lgkmcnt(4)
    v_mfma_f32_16x16x32_bf16 v[58:61], v[134:137], v[6:9], v[58:61]
    ds_read_b128 v[130:133], v197 offset:28672
    s_waitcnt lgkmcnt(4)
    v_mfma_f32_16x16x32_bf16 v[154:157], v[138:141], v[6:9], v[154:157]
    ds_read_b128 v[134:137], v197 offset:29696
    s_waitcnt lgkmcnt(4)
    v_mfma_f32_16x16x32_bf16 v[162:165], v[142:145], v[6:9], v[162:165]
    ds_read_b128 v[138:141], v197 offset:35840
    s_waitcnt lgkmcnt(4)
    v_mfma_f32_16x16x32_bf16 v[50:53], v[146:149], v[10:13], v[50:53]
    ds_read_b128 v[142:145], v197 offset:36864
    s_waitcnt lgkmcnt(4)
    v_mfma_f32_16x16x32_bf16 v[58:61], v[150:153], v[10:13], v[58:61]
    ds_read_b128 v[146:149], v197 offset:37888
    s_waitcnt lgkmcnt(4)
    v_mfma_f32_16x16x32_bf16 v[154:157], v[130:133], v[10:13], v[154:157]
    ds_read_b128 v[150:153], v197 offset:38912
    s_waitcnt lgkmcnt(4)
    v_mfma_f32_16x16x32_bf16 v[162:165], v[134:137], v[10:13], v[162:165]
    ds_read_b128 v[130:133], v240 offset:36864
    s_waitcnt lgkmcnt(4)
    v_mfma_f32_16x16x32_bf16 v[50:53], v[138:141], v[14:17], v[50:53]
    ds_read_b128 v[134:137], v240 offset:37888
    s_waitcnt lgkmcnt(4)
    v_mfma_f32_16x16x32_bf16 v[58:61], v[142:145], v[14:17], v[58:61]
    ds_read_b128 v[138:141], v240 offset:38912
    s_waitcnt lgkmcnt(4)
    v_mfma_f32_16x16x32_bf16 v[154:157], v[146:149], v[14:17], v[154:157]
    ds_read_b128 v[142:145], v240 offset:39936
    s_nop 0
    v_cvt_pk_bf16_f32 v218, v50, v51
    v_cvt_pk_bf16_f32 v219, v52, v53
    s_waitcnt lgkmcnt(4)
    v_mfma_f32_16x16x32_bf16 v[162:165], v[150:153], v[14:17], v[162:165]
    ds_read_b128 v[146:149], v240 offset:46080
    v_cvt_pk_bf16_f32 v220, v58, v59
    v_cvt_pk_bf16_f32 v221, v60, v61
    s_add_u32 s13, s89, 0x800
    buffer_store_dwordx4 v[218:221], v1, s[64:67], s13 offen sc1
    s_waitcnt lgkmcnt(4)
    v_mfma_f32_16x16x32_bf16 v[22:25], v[130:133], v[102:105], v[22:25]
    ds_read_b128 v[150:153], v240 offset:47104
    v_cvt_pk_bf16_f32 v222, v154, v155
    v_cvt_pk_bf16_f32 v223, v156, v157
    s_waitcnt lgkmcnt(4)
    v_mfma_f32_16x16x32_bf16 v[30:33], v[134:137], v[102:105], v[30:33]
    ds_read_b128 v[130:133], v240 offset:48128
    v_cvt_pk_bf16_f32 v224, v162, v163
    v_cvt_pk_bf16_f32 v225, v164, v165
    s_add_u32 s13, s89, 0x800
    buffer_store_dwordx4 v[222:225], v1, s[64:67], s13 offen offset:1024 sc1
    s_waitcnt lgkmcnt(4)
    v_mfma_f32_16x16x32_bf16 v[38:41], v[138:141], v[102:105], v[38:41]
    ds_read_b128 v[134:137], v240 offset:49152
    s_waitcnt lgkmcnt(4)
    v_mfma_f32_16x16x32_bf16 v[46:49], v[142:145], v[102:105], v[46:49]
    ds_read_b128 v[138:141], v240 offset:55296
    s_waitcnt lgkmcnt(4)
    v_mfma_f32_16x16x32_bf16 v[22:25], v[146:149], v[110:113], v[22:25]
    ds_read_b128 v[142:145], v240 offset:56320
    s_waitcnt lgkmcnt(4)
    v_mfma_f32_16x16x32_bf16 v[30:33], v[150:153], v[110:113], v[30:33]
    ds_read_b128 v[146:149], v240 offset:57344
    s_waitcnt lgkmcnt(4)
    v_mfma_f32_16x16x32_bf16 v[38:41], v[130:133], v[110:113], v[38:41]
    ds_read_b128 v[150:153], v240 offset:58368
    s_waitcnt lgkmcnt(4)
    v_mfma_f32_16x16x32_bf16 v[46:49], v[134:137], v[110:113], v[46:49]
    ds_read_b128 v[130:133], v240 offset:64512
    s_waitcnt lgkmcnt(4)
    v_mfma_f32_16x16x32_bf16 v[22:25], v[138:141], v[118:121], v[22:25]
    ds_read_b128 v[134:137], v196
    s_waitcnt lgkmcnt(4)
    v_mfma_f32_16x16x32_bf16 v[30:33], v[142:145], v[118:121], v[30:33]
    ds_read_b128 v[138:141], v196 offset:1024
    s_waitcnt lgkmcnt(4)
    v_mfma_f32_16x16x32_bf16 v[38:41], v[146:149], v[118:121], v[38:41]
    ds_read_b128 v[142:145], v196 offset:2048
    s_waitcnt lgkmcnt(4)
    v_mfma_f32_16x16x32_bf16 v[46:49], v[150:153], v[118:121], v[46:49]
    ds_read_b128 v[146:149], v196 offset:8192
    s_waitcnt lgkmcnt(4)
    v_mfma_f32_16x16x32_bf16 v[22:25], v[130:133], v[126:129], v[22:25]
    ds_read_b128 v[150:153], v196 offset:9216
    s_waitcnt lgkmcnt(4)
    v_mfma_f32_16x16x32_bf16 v[30:33], v[134:137], v[126:129], v[30:33]
    ds_read_b128 v[130:133], v196 offset:10240
    s_waitcnt lgkmcnt(4)
    v_mfma_f32_16x16x32_bf16 v[38:41], v[138:141], v[126:129], v[38:41]
    ds_read_b128 v[134:137], v196 offset:11264
    s_waitcnt lgkmcnt(4)
    v_mfma_f32_16x16x32_bf16 v[46:49], v[142:145], v[126:129], v[46:49]
    ds_read_b128 v[138:141], v196 offset:17408
    s_waitcnt lgkmcnt(4)
    v_mfma_f32_16x16x32_bf16 v[22:25], v[146:149], v[70:73], v[22:25]
    ds_read_b128 v[142:145], v196 offset:18432
    s_waitcnt lgkmcnt(4)
    v_mfma_f32_16x16x32_bf16 v[30:33], v[150:153], v[70:73], v[30:33]
    ds_read_b128 v[146:149], v196 offset:19456
    s_waitcnt lgkmcnt(4)
    v_mfma_f32_16x16x32_bf16 v[38:41], v[130:133], v[70:73], v[38:41]
    ds_read_b128 v[150:153], v196 offset:20480
    s_waitcnt lgkmcnt(4)
    v_mfma_f32_16x16x32_bf16 v[46:49], v[134:137], v[70:73], v[46:49]
    ds_read_b128 v[130:133], v196 offset:26624
    s_waitcnt lgkmcnt(4)
    v_mfma_f32_16x16x32_bf16 v[22:25], v[138:141], v[78:81], v[22:25]
    ds_read_b128 v[134:137], v196 offset:27648
    s_waitcnt lgkmcnt(4)
    v_mfma_f32_16x16x32_bf16 v[30:33], v[142:145], v[78:81], v[30:33]
    ds_read_b128 v[138:141], v196 offset:28672
    s_waitcnt lgkmcnt(4)
    v_mfma_f32_16x16x32_bf16 v[38:41], v[146:149], v[78:81], v[38:41]
    ds_read_b128 v[142:145], v196 offset:29696
    s_waitcnt lgkmcnt(4)
    v_mfma_f32_16x16x32_bf16 v[46:49], v[150:153], v[78:81], v[46:49]
    ds_read_b128 v[146:149], v196 offset:35840
    s_waitcnt lgkmcnt(4)
    v_mfma_f32_16x16x32_bf16 v[22:25], v[130:133], v[86:89], v[22:25]
    ds_read_b128 v[150:153], v196 offset:36864
    s_waitcnt lgkmcnt(4)
    v_mfma_f32_16x16x32_bf16 v[30:33], v[134:137], v[86:89], v[30:33]
    ds_read_b128 v[130:133], v196 offset:37888
    s_waitcnt lgkmcnt(4)
    v_mfma_f32_16x16x32_bf16 v[38:41], v[138:141], v[86:89], v[38:41]
    ds_read_b128 v[134:137], v196 offset:38912
    s_waitcnt lgkmcnt(4)
    v_mfma_f32_16x16x32_bf16 v[46:49], v[142:145], v[86:89], v[46:49]
    ds_read_b128 v[138:141], v240
    s_waitcnt lgkmcnt(4)
    v_mfma_f32_16x16x32_bf16 v[22:25], v[146:149], v[94:97], v[22:25]
    ds_read_b128 v[142:145], v240 offset:1024
    s_waitcnt lgkmcnt(4)
    v_mfma_f32_16x16x32_bf16 v[30:33], v[150:153], v[94:97], v[30:33]
    ds_read_b128 v[146:149], v240 offset:2048
    s_waitcnt lgkmcnt(4)
    v_mfma_f32_16x16x32_bf16 v[38:41], v[130:133], v[94:97], v[38:41]
    ds_read_b128 v[150:153], v240 offset:3072
    s_nop 0
    v_cvt_pk_bf16_f32 v210, v22, v23
    v_cvt_pk_bf16_f32 v211, v24, v25
    s_waitcnt lgkmcnt(4)
    v_mfma_f32_16x16x32_bf16 v[46:49], v[134:137], v[94:97], v[46:49]
    ds_read_b128 v[130:133], v240 offset:9216
    v_cvt_pk_bf16_f32 v212, v30, v31
    v_cvt_pk_bf16_f32 v213, v32, v33
    s_add_u32 s13, s88, 0
    buffer_store_dwordx4 v[210:213], v1, s[64:67], s13 offen sc1
    s_waitcnt lgkmcnt(4)
    v_mfma_f32_16x16x32_bf16 v[18:21], v[138:141], v[66:69], v[18:21]
    ds_read_b128 v[134:137], v240 offset:10240
    v_cvt_pk_bf16_f32 v214, v38, v39
    v_cvt_pk_bf16_f32 v215, v40, v41
    s_waitcnt lgkmcnt(4)
    v_mfma_f32_16x16x32_bf16 v[26:29], v[142:145], v[66:69], v[26:29]
    ds_read_b128 v[138:141], v240 offset:11264
    v_cvt_pk_bf16_f32 v216, v46, v47
    v_cvt_pk_bf16_f32 v217, v48, v49
    s_add_u32 s13, s88, 0
    buffer_store_dwordx4 v[214:217], v1, s[64:67], s13 offen offset:1024 sc1
    s_waitcnt lgkmcnt(4)
    v_mfma_f32_16x16x32_bf16 v[34:37], v[146:149], v[66:69], v[34:37]
    ds_read_b128 v[142:145], v240 offset:12288
    s_waitcnt lgkmcnt(4)
    v_mfma_f32_16x16x32_bf16 v[42:45], v[150:153], v[66:69], v[42:45]
    ds_read_b128 v[146:149], v240 offset:18432
    s_waitcnt lgkmcnt(4)
    v_mfma_f32_16x16x32_bf16 v[18:21], v[130:133], v[74:77], v[18:21]
    ds_read_b128 v[150:153], v240 offset:19456
    s_waitcnt lgkmcnt(4)
    v_mfma_f32_16x16x32_bf16 v[26:29], v[134:137], v[74:77], v[26:29]
    ds_read_b128 v[130:133], v240 offset:20480
    s_waitcnt lgkmcnt(4)
    v_mfma_f32_16x16x32_bf16 v[34:37], v[138:141], v[74:77], v[34:37]
    ds_read_b128 v[134:137], v240 offset:21504
    s_waitcnt lgkmcnt(4)
    v_mfma_f32_16x16x32_bf16 v[42:45], v[142:145], v[74:77], v[42:45]
    ds_read_b128 v[138:141], v240 offset:27648
    s_waitcnt lgkmcnt(4)
    v_mfma_f32_16x16x32_bf16 v[18:21], v[146:149], v[82:85], v[18:21]
    ds_read_b128 v[142:145], v240 offset:28672
    s_waitcnt lgkmcnt(4)
    v_mfma_f32_16x16x32_bf16 v[26:29], v[150:153], v[82:85], v[26:29]
    ds_read_b128 v[146:149], v240 offset:29696
    s_waitcnt lgkmcnt(4)
    v_mfma_f32_16x16x32_bf16 v[34:37], v[130:133], v[82:85], v[34:37]
    ds_read_b128 v[150:153], v240 offset:30720
    s_waitcnt lgkmcnt(4)
    v_mfma_f32_16x16x32_bf16 v[42:45], v[134:137], v[82:85], v[42:45]
    ds_read_b128 v[130:133], v240 offset:36864
    s_waitcnt lgkmcnt(4)
    v_mfma_f32_16x16x32_bf16 v[18:21], v[138:141], v[90:93], v[18:21]
    ds_read_b128 v[134:137], v240 offset:37888
    s_waitcnt lgkmcnt(4)
    v_mfma_f32_16x16x32_bf16 v[26:29], v[142:145], v[90:93], v[26:29]
    ds_read_b128 v[138:141], v240 offset:38912
    s_waitcnt lgkmcnt(4)
    v_mfma_f32_16x16x32_bf16 v[34:37], v[146:149], v[90:93], v[34:37]
    ds_read_b128 v[142:145], v240 offset:39936
    s_waitcnt lgkmcnt(4)
    v_mfma_f32_16x16x32_bf16 v[42:45], v[150:153], v[90:93], v[42:45]
    ds_read_b128 v[146:149], v240 offset:46080
    s_waitcnt lgkmcnt(4)
    v_mfma_f32_16x16x32_bf16 v[18:21], v[130:133], v[98:101], v[18:21]
    ds_read_b128 v[150:153], v240 offset:47104
    s_waitcnt lgkmcnt(4)
    v_mfma_f32_16x16x32_bf16 v[26:29], v[134:137], v[98:101], v[26:29]
    ds_read_b128 v[130:133], v240 offset:48128
    s_waitcnt lgkmcnt(4)
    v_mfma_f32_16x16x32_bf16 v[34:37], v[138:141], v[98:101], v[34:37]
    ds_read_b128 v[134:137], v240 offset:49152
    s_waitcnt lgkmcnt(4)
    v_mfma_f32_16x16x32_bf16 v[42:45], v[142:145], v[98:101], v[42:45]
    ds_read_b128 v[138:141], v240 offset:55296
    s_waitcnt lgkmcnt(4)
    v_mfma_f32_16x16x32_bf16 v[18:21], v[146:149], v[106:109], v[18:21]
    ds_read_b128 v[142:145], v240 offset:56320
    s_waitcnt lgkmcnt(4)
    v_mfma_f32_16x16x32_bf16 v[26:29], v[150:153], v[106:109], v[26:29]
    ds_read_b128 v[146:149], v240 offset:57344
    s_waitcnt lgkmcnt(4)
    v_mfma_f32_16x16x32_bf16 v[34:37], v[130:133], v[106:109], v[34:37]
    ds_read_b128 v[150:153], v240 offset:58368
    s_waitcnt lgkmcnt(4)
    v_mfma_f32_16x16x32_bf16 v[42:45], v[134:137], v[106:109], v[42:45]
    ds_read_b128 v[130:133], v240 offset:64512
    s_waitcnt lgkmcnt(4)
    v_mfma_f32_16x16x32_bf16 v[18:21], v[138:141], v[114:117], v[18:21]
    ds_read_b128 v[134:137], v196
    s_waitcnt lgkmcnt(4)
    v_mfma_f32_16x16x32_bf16 v[26:29], v[142:145], v[114:117], v[26:29]
    ds_read_b128 v[138:141], v196 offset:1024
    s_waitcnt lgkmcnt(4)
    v_mfma_f32_16x16x32_bf16 v[34:37], v[146:149], v[114:117], v[34:37]
    ds_read_b128 v[142:145], v196 offset:2048
    s_waitcnt lgkmcnt(4)
    v_mfma_f32_16x16x32_bf16 v[42:45], v[150:153], v[114:117], v[42:45]
    ds_read_b128 v[146:149], v196 offset:8192
    s_waitcnt lgkmcnt(4)
    v_mfma_f32_16x16x32_bf16 v[18:21], v[130:133], v[122:125], v[18:21]
    ds_read_b128 v[150:153], v196 offset:9216
    s_waitcnt lgkmcnt(4)
    v_mfma_f32_16x16x32_bf16 v[26:29], v[134:137], v[122:125], v[26:29]
    ds_read_b128 v[130:133], v196 offset:10240
    s_waitcnt lgkmcnt(4)
    v_mfma_f32_16x16x32_bf16 v[34:37], v[138:141], v[122:125], v[34:37]
    ds_read_b128 v[134:137], v196 offset:11264
    s_waitcnt lgkmcnt(4)
    v_mfma_f32_16x16x32_bf16 v[42:45], v[142:145], v[122:125], v[42:45]
    ds_read_b128 v[138:141], v196 offset:17408
    s_waitcnt lgkmcnt(4)
    v_mfma_f32_16x16x32_bf16 v[18:21], v[146:149], v[2:5], v[18:21]
    ds_read_b128 v[142:145], v196 offset:18432
    s_waitcnt lgkmcnt(4)
    v_mfma_f32_16x16x32_bf16 v[26:29], v[150:153], v[2:5], v[26:29]
    ds_read_b128 v[146:149], v196 offset:19456
    s_waitcnt lgkmcnt(4)
    v_mfma_f32_16x16x32_bf16 v[34:37], v[130:133], v[2:5], v[34:37]
    ds_read_b128 v[150:153], v196 offset:20480
    s_waitcnt lgkmcnt(4)
    v_mfma_f32_16x16x32_bf16 v[42:45], v[134:137], v[2:5], v[42:45]
    ds_read_b128 v[130:133], v196 offset:26624
    s_waitcnt lgkmcnt(4)
    v_mfma_f32_16x16x32_bf16 v[18:21], v[138:141], v[6:9], v[18:21]
    ds_read_b128 v[134:137], v196 offset:27648
    s_waitcnt lgkmcnt(4)
    v_mfma_f32_16x16x32_bf16 v[26:29], v[142:145], v[6:9], v[26:29]
    ds_read_b128 v[138:141], v196 offset:28672
    s_waitcnt lgkmcnt(4)
    v_mfma_f32_16x16x32_bf16 v[34:37], v[146:149], v[6:9], v[34:37]
    ds_read_b128 v[142:145], v196 offset:29696
    s_waitcnt lgkmcnt(4)
    v_mfma_f32_16x16x32_bf16 v[42:45], v[150:153], v[6:9], v[42:45]
    ds_read_b128 v[146:149], v196 offset:35840
    s_waitcnt lgkmcnt(4)
    v_mfma_f32_16x16x32_bf16 v[18:21], v[130:133], v[10:13], v[18:21]
    ds_read_b128 v[150:153], v196 offset:36864
    s_waitcnt lgkmcnt(4)
    v_mfma_f32_16x16x32_bf16 v[26:29], v[134:137], v[10:13], v[26:29]
    ds_read_b128 v[130:133], v196 offset:37888
    s_waitcnt lgkmcnt(4)
    v_mfma_f32_16x16x32_bf16 v[34:37], v[138:141], v[10:13], v[34:37]
    ds_read_b128 v[134:137], v196 offset:38912
    s_waitcnt lgkmcnt(4)
    v_mfma_f32_16x16x32_bf16 v[42:45], v[142:145], v[10:13], v[42:45]
    s_waitcnt lgkmcnt(3)
    v_mfma_f32_16x16x32_bf16 v[18:21], v[146:149], v[14:17], v[18:21]
    s_waitcnt lgkmcnt(2)
    v_mfma_f32_16x16x32_bf16 v[26:29], v[150:153], v[14:17], v[26:29]
    s_waitcnt lgkmcnt(1)
    v_mfma_f32_16x16x32_bf16 v[34:37], v[130:133], v[14:17], v[34:37]
    s_waitcnt lgkmcnt(0)
    v_mfma_f32_16x16x32_bf16 v[42:45], v[134:137], v[14:17], v[42:45]
    s_add_u32 s13, s87, 0x1000
    s_mov_b32 s82, 0
    v_lshrrev_b32 v235, 8, v1
    v_bfe_u32 v236, v1, 6, 2
    v_cmp_eq_u32 vcc, v235, v236
    v_and_b32 v235, 16, v1
    v_mov_b32 v236, 0x3f80
    v_lshlrev_b32 v235, v235, v236
    v_cndmask_b32 v235, 0, v235, vcc
    v_and_b32 v236, 32, v1
    v_cmp_eq_u32 vcc, 0, v236
    v_mov_b32 v142, 0
    v_mov_b32 v143, 0
    v_mov_b32 v146, 0
    v_mov_b32 v147, 0
    v_cndmask_b32 v144, 0, v235, vcc
    v_cndmask_b32 v145, v235, 0, vcc
    s_waitcnt vmcnt(9)
    v_dot2_f32_bf16 v170, v194, v237, v170
    v_dot2_f32_bf16 v172, v195, v237, v172
    v_dot2_f32_bf16 v18, v178, v237, v18
    v_dot2_f32_bf16 v19, v182, v237, v19
    v_dot2_f32_bf16 v20, v186, v237, v20
    v_dot2_f32_bf16 v21, v190, v237, v21
    v_dot2_f32_bf16 v26, v179, v237, v26
    v_dot2_f32_bf16 v27, v183, v237, v27
    v_dot2_f32_bf16 v28, v187, v237, v28
    v_dot2_f32_bf16 v29, v191, v237, v29
    v_dot2_f32_bf16 v34, v180, v237, v34
    v_dot2_f32_bf16 v35, v184, v237, v35
    v_dot2_f32_bf16 v36, v188, v237, v36
    v_dot2_f32_bf16 v37, v192, v237, v37
    v_dot2_f32_bf16 v42, v181, v237, v42
    v_dot2_f32_bf16 v43, v185, v237, v43
    v_dot2_f32_bf16 v44, v189, v237, v44
    v_dot2_f32_bf16 v45, v193, v237, v45
    s_waitcnt vmcnt(0)
    s_mov_b32 s86, 14
L_ff_xpoll:
    s_bitcmp0_b32 s86, 1
    s_cbranch_scc1 L_ff_xs_41
    buffer_load_dwordx4 v[210:213], v1, s[64:67], s87 offen sc1
    buffer_load_dwordx4 v[214:217], v1, s[64:67], s87 offen offset:1024 sc1
    buffer_load_dword v203, v201, s[64:67], s13 offen offset:2048 sc1
L_ff_xs_41:
    s_bitcmp0_b32 s86, 2
    s_cbranch_scc1 L_ff_xs_42
    buffer_load_dwordx4 v[218:221], v1, s[64:67], s87 offen offset:2048 sc1
    buffer_load_dwordx4 v[222:225], v1, s[64:67], s87 offen offset:3072 sc1
    buffer_load_dword v204, v201, s[64:67], s13 offen offset:2304 sc1
L_ff_xs_42:
    s_bitcmp0_b32 s86, 3
    s_cbranch_scc1 L_ff_xs_43
    buffer_load_dwordx4 v[226:229], v1, s[64:67], s13 offen sc1
    buffer_load_dwordx4 v[230:233], v1, s[64:67], s13 offen offset:1024 sc1
    buffer_load_dword v205, v201, s[64:67], s13 offen offset:2560 sc1
L_ff_xs_43:
    s_waitcnt vmcnt(0)
    v_max3_u32 v235, v210, v211, v212
    v_max3_u32 v236, v218, v219, v220
    v_max3_u32 v202, v226, v227, v228
    v_max3_u32 v235, v235, v213, v214
    v_max3_u32 v236, v236, v221, v222
    v_max3_u32 v202, v202, v229, v230
    v_max3_u32 v235, v235, v215, v216
    v_max3_u32 v236, v236, v223, v224
    v_max3_u32 v202, v202, v231, v232
    v_max3_u32 v235, v235, v217, v203
    v_max3_u32 v236, v236, v225, v204
    v_max3_u32 v202, v202, v233, v205
    v_cmp_eq_u32 s[44:45], -1, v235
    v_cmp_eq_u32 s[46:47], -1, v236
    v_cmp_eq_u32 vcc, -1, v202
    s_mov_b32 s86, 0
    s_cmp_lg_u64 s[44:45], 0
    s_cselect_b32 s10, 2, 0
    s_or_b32 s86, s86, s10
    s_cmp_lg_u64 s[46:47], 0
    s_cselect_b32 s10, 4, 0
    s_or_b32 s86, s86, s10
    s_cmp_lg_u64 vcc, 0
    s_cselect_b32 s10, 8, 0
    s_or_b32 s86, s86, s10
    s_cbranch_scc0 L_ff_got
    s_add_u32 s82, s82, 1
    s_cmp_lt_u32 s82, 0xfa0
    s_cbranch_scc1 L_ff_xpoll
    s_mov_b32 s10, 3
    s_branch L_ff_self
L_ff_r3:
    v_subrev_u32 v240, 0x9000, v240
    v_subrev_u32 v234, 0x9000, v234
    s_mul_i32 s69, s68, 0x144000
    s_mul_i32 s77, s11, 36
    s_add_u32 s82, s77, 36
L_ff_slow:
    s_cmp_ge_u32 s82, 0x90
    s_cselect_b32 s82, 0, s82
    s_lshl_b32 s13, s82, 10
    s_add_u32 s13, s13, s52
    buffer_load_dwordx4 v[66:69], v252, s[48:51], s13 offen
    s_mul_i32 s13, s82, 0x2400
    s_add_u32 s13, s13, s69
    buffer_load_dwordx4 v[130:133], v240, s[56:59], s13 offen
    buffer_load_dwordx4 v[134:137], v240, s[56:59], s13 offen offset:1024
    buffer_load_dwordx4 v[138:141], v240, s[56:59], s13 offen offset:2048
    buffer_load_dwordx4 v[142:145], v240, s[56:59], s13 offen offset:3072
    s_add_u32 s13, s13, 0x2000
    buffer_load_dwordx4 v[146:149], v234, s[56:59], s13 offen
    s_waitcnt vmcnt(0)
    v_mfma_f32_16x16x32_bf16 v[18:21], v[130:133], v[66:69], v[18:21]
    v_mfma_f32_16x16x32_bf16 v[26:29], v[134:137], v[66:69], v[26:29]
    v_mfma_f32_16x16x32_bf16 v[34:37], v[138:141], v[66:69], v[34:37]
    v_mfma_f32_16x16x32_bf16 v[42:45], v[142:145], v[66:69], v[42:45]
    v_mfma_f32_16x16x32_bf16 v[170:173], v[146:149], v[66:69], v[170:173]
    s_add_u32 s82, s82, 1
    s_cmp_ge_u32 s82, 0x90
    s_cselect_b32 s82, 0, s82
    s_cmp_lg_u32 s82, s77
    s_cbranch_scc1 L_ff_slow
    s_branch L_ff_out
L_ff_got:
    v_mfma_f32_16x16x32_bf16 v[18:21], v[144:147], v[210:213], v[18:21]
    v_mfma_f32_16x16x32_bf16 v[26:29], v[142:145], v[210:213], v[26:29]
    v_mfma_f32_16x16x32_bf16 v[34:37], v[144:147], v[214:217], v[34:37]
    v_mfma_f32_16x16x32_bf16 v[42:45], v[142:145], v[214:217], v[42:45]
    v_mfma_f32_16x16x32_bf16 v[18:21], v[144:147], v[218:221], v[18:21]
    v_mfma_f32_16x16x32_bf16 v[26:29], v[142:145], v[218:221], v[26:29]
    v_mfma_f32_16x16x32_bf16 v[34:37], v[144:147], v[222:225], v[34:37]
    v_mfma_f32_16x16x32_bf16 v[42:45], v[142:145], v[222:225], v[42:45]
    v_mfma_f32_16x16x32_bf16 v[18:21], v[144:147], v[226:229], v[18:21]
    v_mfma_f32_16x16x32_bf16 v[26:29], v[142:145], v[226:229], v[26:29]
    v_mfma_f32_16x16x32_bf16 v[34:37], v[144:147], v[230:233], v[34:37]
    v_mfma_f32_16x16x32_bf16 v[42:45], v[142:145], v[230:233], v[42:45]
    v_dot2_f32_bf16 v170, v203, s83, v170
    v_dot2_f32_bf16 v172, v203, s84, v172
    v_dot2_f32_bf16 v170, v204, s83, v170
    v_dot2_f32_bf16 v172, v204, s84, v172
    v_dot2_f32_bf16 v170, v205, s83, v170
    v_dot2_f32_bf16 v172, v205, s84, v172
L_ff_out:
    v_permlane32_swap_b32 v18, v20
    v_permlane32_swap_b32 v19, v21
    v_permlane32_swap_b32 v26, v28
    v_permlane32_swap_b32 v27, v29
    v_permlane32_swap_b32 v34, v36
    v_permlane32_swap_b32 v35, v37
    v_permlane32_swap_b32 v42, v44
    v_permlane32_swap_b32 v43, v45
    v_permlane32_swap_b32 v170, v172
    v_cvt_pk_bf16_f32 v74, v18, v20
    v_cvt_pk_bf16_f32 v75, v26, v28
    v_cvt_pk_bf16_f32 v76, v34, v36
    v_cvt_pk_bf16_f32 v77, v42, v44
    buffer_store_dwordx4 v[74:77], v200, s[60:63], s79 offen
    v_cvt_pk_bf16_f32 v78, v19, v21
    v_cvt_pk_bf16_f32 v79, v27, v29
    v_cvt_pk_bf16_f32 v80, v35, v37
    v_cvt_pk_bf16_f32 v81, v43, v45
    buffer_store_dwordx4 v[78:81], v200, s[60:63], s79 offen offset:16
    v_cvt_pk_bf16_f32 v82, v170, v172
    buffer_store_dword v82, v200, s[60:63], s80 offen
    s_branch L_ff_fin
L_ff_b:
    s_waitcnt lgkmcnt(2)
    v_mfma_f32_16x16x32_bf16 v[2:5], v[210:213], v[114:117], v[2:5]
    ds_read_b128 v[222:225], v1 offset:15360
    v_cvt_pk_bf16_f32 v227, v52, v53
    v_mfma_f32_16x16x32_bf16 v[6:9], v[210:213], v[118:121], v[6:9]
    v_mul_f32 v230, v54, v54
    v_mul_f32 v231, v55, v55
    s_waitcnt lgkmcnt(2)
    v_mfma_f32_16x16x32_bf16 v[10:13], v[214:217], v[114:117], v[10:13]
    ds_read_b128 v[210:213], v1 offset:16384
    v_mul_f32 v232, v56, v56
    v_mfma_f32_16x16x32_bf16 v[14:17], v[214:217], v[118:121], v[14:17]
    v_mul_f32 v233, v57, v57
    v_fma_f32 v230, v230, v249, v247
    s_waitcnt lgkmcnt(2)
    v_mfma_f32_16x16x32_bf16 v[2:5], v[218:221], v[122:125], v[2:5]
    ds_read_b128 v[214:217], v1 offset:17408
    v_fma_f32 v231, v231, v249, v247
    v_mfma_f32_16x16x32_bf16 v[6:9], v[218:221], v[126:129], v[6:9]
    v_fma_f32 v232, v232, v249, v247
    v_fma_f32 v233, v233, v249, v247
    s_waitcnt lgkmcnt(2)
    v_mfma_f32_16x16x32_bf16 v[10:13], v[222:225], v[122:125], v[10:13]
    ds_read_b128 v[218:221], v1 offset:18432
    v_mul_f32 v230, v230, v54
    v_mfma_f32_16x16x32_bf16 v[14:17], v[222:225], v[126:129], v[14:17]
    v_mul_f32 v231, v231, v55
    v_mul_f32 v232, v232, v56
    s_waitcnt lgkmcnt(2)
    v_mfma_f32_16x16x32_bf16 v[2:5], v[210:213], v[130:133], v[2:5]
    ds_read_b128 v[222:225], v1 offset:19456
    v_mul_f32 v233, v233, v57
    v_mfma_f32_16x16x32_bf16 v[6:9], v[210:213], v[134:137], v[6:9]
    v_exp_f32 v230, v230
    v_mul_f32 v54, v54, v62
    s_waitcnt lgkmcnt(2)
    v_mfma_f32_16x16x32_bf16 v[10:13], v[214:217], v[130:133], v[10:13]
    ds_read_b128 v[210:213], v1 offset:20480
    v_exp_f32 v231, v231
    v_mfma_f32_16x16x32_bf16 v[14:17], v[214:217], v[134:137], v[14:17]
    v_mul_f32 v55, v55, v63
    v_exp_f32 v232, v232
    s_waitcnt lgkmcnt(2)
    v_mfma_f32_16x16x32_bf16 v[2:5], v[218:221], v[138:141], v[2:5]
    ds_read_b128 v[214:217], v1 offset:21504
    v_mul_f32 v56, v56, v64
    v_mfma_f32_16x16x32_bf16 v[6:9], v[218:221], v[142:145], v[6:9]
    v_exp_f32 v233, v233
    s_waitcnt lgkmcnt(2)
    v_mfma_f32_16x16x32_bf16 v[10:13], v[222:225], v[138:141], v[10:13]
    ds_read_b128 v[218:221], v1 offset:22528
    v_mul_f32 v57, v57, v65
    v_mfma_f32_16x16x32_bf16 v[14:17], v[222:225], v[142:145], v[14:17]
    v_fma_f32 v230, v230, v251, v251
    s_waitcnt lgkmcnt(2)
    v_mfma_f32_16x16x32_bf16 v[2:5], v[210:213], v[146:149], v[2:5]
    ds_read_b128 v[222:225], v1 offset:23552
    v_fma_f32 v231, v231, v251, v251
    v_mfma_f32_16x16x32_bf16 v[6:9], v[210:213], v[150:153], v[6:9]
    v_fma_f32 v232, v232, v251, v251
    s_waitcnt vmcnt(0)
    s_barrier
    s_waitcnt lgkmcnt(2)
    v_mfma_f32_16x16x32_bf16 v[10:13], v[214:217], v[146:149], v[10:13]
    ds_read_b128 v[210:213], v1 offset:24576
    v_fma_f32 v233, v233, v251, v251
    v_mfma_f32_16x16x32_bf16 v[14:17], v[214:217], v[150:153], v[14:17]
    v_rcp_f32 v230, v230
    s_waitcnt lgkmcnt(2)
    v_mfma_f32_16x16x32_bf16 v[2:5], v[218:221], v[154:157], v[2:5]
    ds_read_b128 v[214:217], v1 offset:25600
    v_rcp_f32 v231, v231
    v_mfma_f32_16x16x32_bf16 v[6:9], v[218:221], v[158:161], v[6:9]
    v_rcp_f32 v232, v232
    s_waitcnt lgkmcnt(2)
    v_mfma_f32_16x16x32_bf16 v[10:13], v[222:225], v[154:157], v[10:13]
    ds_read_b128 v[218:221], v1 offset:26624
    v_rcp_f32 v233, v233
    v_mfma_f32_16x16x32_bf16 v[14:17], v[222:225], v[158:161], v[14:17]
    v_mul_f32 v54, v54, v230
    s_waitcnt lgkmcnt(2)
    v_mfma_f32_16x16x32_bf16 v[2:5], v[210:213], v[162:165], v[2:5]
    ds_read_b128 v[222:225], v1 offset:27648
    v_mul_f32 v55, v55, v231
    v_mfma_f32_16x16x32_bf16 v[6:9], v[210:213], v[166:169], v[6:9]
    v_mul_f32 v56, v56, v232
    s_waitcnt lgkmcnt(2)
    v_mfma_f32_16x16x32_bf16 v[10:13], v[214:217], v[162:165], v[10:13]
    ds_read_b128 v[210:213], v1 offset:28672
    v_mul_f32 v57, v57, v233
    v_mfma_f32_16x16x32_bf16 v[14:17], v[214:217], v[166:169], v[14:17]
    v_cvt_pk_bf16_f32 v228, v54, v55
    s_waitcnt lgkmcnt(2)
    v_mfma_f32_16x16x32_bf16 v[2:5], v[218:221], v[170:173], v[2:5]
    ds_read_b128 v[214:217], v1 offset:29696
    v_cvt_pk_bf16_f32 v229, v56, v57
    v_mfma_f32_16x16x32_bf16 v[6:9], v[218:221], v[174:177], v[6:9]
    v_permlane32_swap_b32 v226, v228
    s_waitcnt lgkmcnt(2)
    v_mfma_f32_16x16x32_bf16 v[10:13], v[222:225], v[170:173], v[10:13]
    ds_read_b128 v[218:221], v1 offset:30720
    v_permlane32_swap_b32 v227, v229
    v_mfma_f32_16x16x32_bf16 v[14:17], v[222:225], v[174:177], v[14:17]
    buffer_store_dwordx4 v[226:229], v254, s[48:51], s30 offen sc1
    s_waitcnt lgkmcnt(2)
    v_mfma_f32_16x16x32_bf16 v[2:5], v[210:213], v[178:181], v[2:5]
    ds_read_b128 v[222:225], v1 offset:31744
    v_mfma_f32_16x16x32_bf16 v[6:9], v[210:213], v[182:185], v[6:9]
    s_waitcnt lgkmcnt(2)
    v_mfma_f32_16x16x32_bf16 v[10:13], v[214:217], v[178:181], v[10:13]
    ds_read_b128 v[210:213], v1 offset:32768
    v_mfma_f32_16x16x32_bf16 v[14:17], v[214:217], v[182:185], v[14:17]
    s_waitcnt lgkmcnt(2)
    v_mfma_f32_16x16x32_bf16 v[2:5], v[218:221], v[186:189], v[2:5]
    ds_read_b128 v[214:217], v1 offset:33792
    s_lshl_b32 s13, s9, 2
    s_add_u32 s13, s13, s75
    s_mov_b64 exec, 1
    buffer_store_dword v1, v1, s[64:67], s13 offen offset:256 sc1
    s_mov_b64 exec, -1
    v_mfma_f32_16x16x32_bf16 v[6:9], v[218:221], v[190:193], v[6:9]
    s_waitcnt lgkmcnt(2)
    v_mfma_f32_16x16x32_bf16 v[10:13], v[222:225], v[186:189], v[10:13]
    ds_read_b128 v[218:221], v1 offset:34816
    v_mfma_f32_16x16x32_bf16 v[14:17], v[222:225], v[190:193], v[14:17]
    s_waitcnt lgkmcnt(2)
    v_mfma_f32_16x16x32_bf16 v[2:5], v[210:213], v[194:197], v[2:5]
    ds_read_b128 v[222:225], v1 offset:35840
    v_mfma_f32_16x16x32_bf16 v[6:9], v[210:213], v[198:201], v[6:9]
    s_waitcnt lgkmcnt(2)
    v_mfma_f32_16x16x32_bf16 v[10:13], v[214:217], v[194:197], v[10:13]
    v_mfma_f32_16x16x32_bf16 v[14:17], v[214:217], v[198:201], v[14:17]
    s_waitcnt lgkmcnt(1)
    v_mfma_f32_16x16x32_bf16 v[2:5], v[218:221], v[202:205], v[2:5]
    v_mfma_f32_16x16x32_bf16 v[6:9], v[218:221], v[206:209], v[6:9]
    s_waitcnt lgkmcnt(0)
    v_mfma_f32_16x16x32_bf16 v[10:13], v[222:225], v[202:205], v[10:13]
    v_mfma_f32_16x16x32_bf16 v[14:17], v[222:225], v[206:209], v[14:17]
    s_cmp_eq_u32 s76, 1
    s_cbranch_scc1 L_ff_late
    s_lshl_b32 s77, s8, 10
    s_add_u32 s69, s69, s77
    s_add_u32 s77, s77, 0x9000
    s_add_u32 m0, s77, 0x12000
    s_add_u32 s13, s69, 0x12000
    buffer_load_dwordx4 v1, s[56:59], s13 offen lds
    s_add_u32 m0, s77, 0x13000
    s_add_u32 s13, s69, 0x13000
    buffer_load_dwordx4 v1, s[56:59], s13 offen lds
    s_add_u32 m0, s77, 0x14000
    s_add_u32 s13, s69, 0x14000
    buffer_load_dwordx4 v1, s[56:59], s13 offen lds
    s_add_u32 m0, s77, 0x15000
    s_add_u32 s13, s69, 0x15000
    buffer_load_dwordx4 v1, s[56:59], s13 offen lds
    s_add_u32 m0, s77, 0x16000
    s_add_u32 s13, s69, 0x16000
    buffer_load_dwordx4 v1, s[56:59], s13 offen lds
    s_add_u32 m0, s77, 0x17000
    s_add_u32 s13, s69, 0x17000
    buffer_load_dwordx4 v1, s[56:59], s13 offen lds
    s_add_u32 m0, s77, 0x18000
    s_add_u32 s13, s69, 0x18000
    buffer_load_dwordx4 v1, s[56:59], s13 offen lds
    s_add_u32 m0, s77, 0x19000
    s_add_u32 s13, s69, 0x19000
    buffer_load_dwordx4 v1, s[56:59], s13 offen lds
    s_add_u32 m0, s77, 0x1a000
    s_add_u32 s13, s69, 0x1a000
    buffer_load_dwordx4 v1, s[56:59], s13 offen lds
    v_mul_f32 v230, v2, v2
    v_mul_f32 v231, v3, v3
    v_mul_f32 v232, v4, v4
    v_mul_f32 v233, v5, v5
    v_fma_f32 v230, v230, v248, v246
    v_fma_f32 v231, v231, v248, v246
    v_fma_f32 v232, v232, v248, v246
    v_fma_f32 v233, v233, v248, v246
    v_mul_f32 v230, v230, v2
    v_mul_f32 v231, v231, v3
    v_mul_f32 v232, v232, v4
    v_mul_f32 v233, v233, v5
    v_exp_f32 v230, v230
    v_mul_f32 v2, v2, v10
    v_exp_f32 v231, v231
    v_mul_f32 v3, v3, v11
    v_exp_f32 v232, v232
    v_mul_f32 v4, v4, v12
    v_exp_f32 v233, v233
    v_mul_f32 v5, v5, v13
    v_fma_f32 v230, v230, v250, v250
    v_fma_f32 v231, v231, v250, v250
    v_fma_f32 v232, v232, v250, v250
    v_fma_f32 v233, v233, v250, v250
    v_rcp_f32 v230, v230
    v_rcp_f32 v231, v231
    v_rcp_f32 v232, v232
    v_rcp_f32 v233, v233
    v_mul_f32 v2, v2, v230
    v_mul_f32 v3, v3, v231
    v_mul_f32 v4, v4, v232
    v_mul_f32 v5, v5, v233
    v_cvt_pk_bf16_f32 v226, v2, v3
    v_cvt_pk_bf16_f32 v227, v4, v5
    v_mul_f32 v230, v6, v6
    v_mul_f32 v231, v7, v7
    v_mul_f32 v232, v8, v8
    v_mul_f32 v233, v9, v9
    v_fma_f32 v230, v230, v249, v247
    v_fma_f32 v231, v231, v249, v247
    v_fma_f32 v232, v232, v249, v247
    v_fma_f32 v233, v233, v249, v247
    v_mul_f32 v230, v230, v6
    v_mul_f32 v231, v231, v7
    v_mul_f32 v232, v232, v8
    v_mul_f32 v233, v233, v9
    v_exp_f32 v230, v230
    v_mul_f32 v6, v6, v14
    v_exp_f32 v231, v231
    v_mul_f32 v7, v7, v15
    v_exp_f32 v232, v232
    v_mul_f32 v8, v8, v16
    v_exp_f32 v233, v233
    v_mul_f32 v9, v9, v17
    v_fma_f32 v230, v230, v251, v251
    v_fma_f32 v231, v231, v251, v251
    v_fma_f32 v232, v232, v251, v251
    v_fma_f32 v233, v233, v251, v251
    v_rcp_f32 v230, v230
    v_rcp_f32 v231, v231
    v_rcp_f32 v232, v232
    v_rcp_f32 v233, v233
    v_mul_f32 v6, v6, v230
    v_mul_f32 v7, v7, v231
    v_mul_f32 v8, v8, v232
    v_mul_f32 v9, v9, v233
    v_cvt_pk_bf16_f32 v228, v6, v7
    v_cvt_pk_bf16_f32 v229, v8, v9
    s_nop 0
    v_permlane32_swap_b32 v226, v228
    v_permlane32_swap_b32 v227, v229
    buffer_store_dwordx4 v[226:229], v254, s[48:51], s30 offen offset:512 sc1
    s_barrier
    s_add_u32 m0, s77, 0
    s_add_u32 s13, s69, 0x1b000
    buffer_load_dwordx4 v1, s[56:59], s13 offen lds
    s_add_u32 m0, s77, 0x1000
    s_add_u32 s13, s69, 0x1c000
    buffer_load_dwordx4 v1, s[56:59], s13 offen lds
    s_add_u32 m0, s77, 0x2000
    s_add_u32 s13, s69, 0x1d000
    buffer_load_dwordx4 v1, s[56:59], s13 offen lds
    s_add_u32 m0, s77, 0x3000
    s_add_u32 s13, s69, 0x1e000
    buffer_load_dwordx4 v1, s[56:59], s13 offen lds
    s_add_u32 m0, s77, 0x4000
    s_add_u32 s13, s69, 0x1f000
    buffer_load_dwordx4 v1, s[56:59], s13 offen lds
    s_add_u32 m0, s77, 0x5000
    s_add_u32 s13, s69, 0x20000
    buffer_load_dwordx4 v1, s[56:59], s13 offen lds
    s_barrier
    s_add_u32 m0, s77, 0x6000
    s_add_u32 s13, s69, 0x21000
    buffer_load_dwordx4 v1, s[56:59], s13 offen lds
    s_add_u32 m0, s77, 0x7000
    s_add_u32 s13, s69, 0x22000
    buffer_load_dwordx4 v1, s[56:59], s13 offen lds
    s_add_u32 m0, s77, 0x8000
    s_add_u32 s13, s69, 0x23000
    buffer_load_dwordx4 v1, s[56:59], s13 offen lds
    s_add_u32 m0, s77, 0x9000
    s_add_u32 s13, s69, 0x24000
    buffer_load_dwordx4 v1, s[56:59], s13 offen lds
    s_add_u32 m0, s77, 0xa000
    s_add_u32 s13, s69, 0x25000
    buffer_load_dwordx4 v1, s[56:59], s13 offen lds
    s_waitcnt vmcnt(11)
    s_lshl_b32 s13, s9, 2
    s_add_u32 s13, s13, s75
    s_mov_b64 exec, 1
    buffer_store_dword v1, v1, s[64:67], s13 offen offset:512 sc1
    s_mov_b64 exec, -1
    s_barrier
    s_add_u32 m0, s77, 0xb000
    s_add_u32 s13, s69, 0x26000
    buffer_load_dwordx4 v1, s[56:59], s13 offen lds
    s_add_u32 m0, s77, 0xc000
    s_add_u32 s13, s69, 0x27000
    buffer_load_dwordx4 v1, s[56:59], s13 offen lds
    s_add_u32 m0, s77, 0xd000
    s_add_u32 s13, s69, 0x28000
    buffer_load_dwordx4 v1, s[56:59], s13 offen lds
    s_add_u32 m0, s77, 0xe000
    s_add_u32 s13, s69, 0x29000
    buffer_load_dwordx4 v1, s[56:59], s13 offen lds
    s_barrier
    s_add_u32 m0, s77, 0xf000
    s_add_u32 s13, s69, 0x2a000
    buffer_load_dwordx4 v1, s[56:59], s13 offen lds
    s_add_u32 m0, s77, 0x10000
    s_add_u32 s13, s69, 0x2b000
    buffer_load_dwordx4 v1, s[56:59], s13 offen lds
    s_add_u32 m0, s77, 0x11000
    s_add_u32 s13, s69, 0x2c000
    buffer_load_dwordx4 v1, s[56:59], s13 offen lds
    s_add_u32 m0, s77, 0x12000
    s_add_u32 s13, s69, 0x2d000
    buffer_load_dwordx4 v1, s[56:59], s13 offen lds
    s_add_u32 m0, s77, 0x13000
    s_add_u32 s13, s69, 0x2e000
    buffer_load_dwordx4 v1, s[56:59], s13 offen lds
    s_waitcnt vmcnt(16)
    s_barrier
    s_add_u32 m0, s77, 0x14000
    s_add_u32 s13, s69, 0x2f000
    buffer_load_dwordx4 v1, s[56:59], s13 offen lds
    s_add_u32 m0, s77, 0x15000
    s_add_u32 s13, s69, 0x30000
    buffer_load_dwordx4 v1, s[56:59], s13 offen lds
    s_add_u32 m0, s77, 0x16000
    s_add_u32 s13, s69, 0x31000
    buffer_load_dwordx4 v1, s[56:59], s13 offen lds
    s_add_u32 m0, s77, 0x17000
    s_add_u32 s13, s69, 0x32000
    buffer_load_dwordx4 v1, s[56:59], s13 offen lds
    s_waitcnt vmcnt(16)
    s_barrier
    s_add_u32 m0, s77, 0x18000
    s_add_u32 s13, s69, 0x33000
    buffer_load_dwordx4 v1, s[56:59], s13 offen lds
    s_add_u32 m0, s77, 0x19000
    s_add_u32 s13, s69, 0x34000
    buffer_load_dwordx4 v1, s[56:59], s13 offen lds
    s_add_u32 m0, s77, 0x1a000
    s_add_u32 s13, s69, 0x35000
    buffer_load_dwordx4 v1, s[56:59], s13 offen lds
    s_add_u32 m0, s77, 0
    s_add_u32 s13, s69, 0x36000
    buffer_load_dwordx4 v1, s[56:59], s13 offen lds
    s_add_u32 m0, s77, 0x1000
    s_add_u32 s13, s69, 0x37000
    buffer_load_dwordx4 v1, s[56:59], s13 offen lds
    s_waitcnt vmcnt(15)
    s_barrier
    s_add_u32 m0, s77, 0x2000
    s_add_u32 s13, s69, 0x38000
    buffer_load_dwordx4 v1, s[56:59], s13 offen lds
    s_add_u32 m0, s77, 0x3000
    s_add_u32 s13, s69, 0x39000
    buffer_load_dwordx4 v1, s[56:59], s13 offen lds
    s_add_u32 m0, s77, 0x4000
    s_add_u32 s13, s69, 0x3a000
    buffer_load_dwordx4 v1, s[56:59], s13 offen lds
    s_add_u32 m0, s77, 0x5000
    s_add_u32 s13, s69, 0x3b000
    buffer_load_dwordx4 v1, s[56:59], s13 offen lds
    s_waitcnt vmcnt(15)
    s_barrier
    s_add_u32 m0, s77, 0x6000
    s_add_u32 s13, s69, 0x3c000
    buffer_load_dwordx4 v1, s[56:59], s13 offen lds
    s_add_u32 m0, s77, 0x7000
    s_add_u32 s13, s69, 0x3d000
    buffer_load_dwordx4 v1, s[56:59], s13 offen lds
    s_add_u32 m0, s77, 0x8000
    s_add_u32 s13, s69, 0x3e000
    buffer_load_dwordx4 v1, s[56:59], s13 offen lds
    s_add_u32 m0, s77, 0x9000
    s_add_u32 s13, s69, 0x3f000
    buffer_load_dwordx4 v1, s[56:59], s13 offen lds
    s_add_u32 m0, s77, 0xa000
    s_add_u32 s13, s69, 0x40000
    buffer_load_dwordx4 v1, s[56:59], s13 offen lds
    s_waitcnt vmcnt(15)
    s_barrier
    s_add_u32 m0, s77, 0xb000
    s_add_u32 s13, s69, 0x41000
    buffer_load_dwordx4 v1, s[56:59], s13 offen lds
    s_add_u32 m0, s77, 0xc000
    s_add_u32 s13, s69, 0x42000
    buffer_load_dwordx4 v1, s[56:59], s13 offen lds
    s_add_u32 m0, s77, 0xd000
    s_add_u32 s13, s69, 0x43000
    buffer_load_dwordx4 v1, s[56:59], s13 offen lds
    s_add_u32 m0, s77, 0xe000
    s_add_u32 s13, s69, 0x44000
    buffer_load_dwordx4 v1, s[56:59], s13 offen lds
    s_waitcnt vmcnt(15)
    s_barrier
    s_add_u32 m0, s77, 0xf000
    s_add_u32 s13, s69, 0x45000
    buffer_load_dwordx4 v1, s[56:59], s13 offen lds
    s_add_u32 m0, s77, 0x10000
    s_add_u32 s13, s69, 0x46000
    buffer_load_dwordx4 v1, s[56:59], s13 offen lds
    s_add_u32 m0, s77, 0x11000
    s_add_u32 s13, s69, 0x47000
    buffer_load_dwordx4 v1, s[56:59], s13 offen lds
    s_add_u32 m0, s77, 0x12000
    s_add_u32 s13, s69, 0x48000
    buffer_load_dwordx4 v1, s[56:59], s13 offen lds
    s_add_u32 m0, s77, 0x13000
    s_add_u32 s13, s69, 0x49000
    buffer_load_dwordx4 v1, s[56:59], s13 offen lds
    s_waitcnt vmcnt(15)
    s_barrier
    s_add_u32 m0, s77, 0x14000
    s_add_u32 s13, s69, 0x4a000
    buffer_load_dwordx4 v1, s[56:59], s13 offen lds
    s_add_u32 m0, s77, 0x15000
    s_add_u32 s13, s69, 0x4b000
    buffer_load_dwordx4 v1, s[56:59], s13 offen lds
    s_add_u32 m0, s77, 0x16000
    s_add_u32 s13, s69, 0x4c000
    buffer_load_dwordx4 v1, s[56:59], s13 offen lds
    s_add_u32 m0, s77, 0x17000
    s_add_u32 s13, s69, 0x4d000
    buffer_load_dwordx4 v1, s[56:59], s13 offen lds
    s_waitcnt vmcnt(15)
    s_barrier
    s_add_u32 m0, s77, 0x18000
    s_add_u32 s13, s69, 0x4e000
    buffer_load_dwordx4 v1, s[56:59], s13 offen lds
    s_add_u32 m0, s77, 0x19000
    s_add_u32 s13, s69, 0x4f000
    buffer_load_dwordx4 v1, s[56:59], s13 offen lds
    s_add_u32 m0, s77, 0x1a000
    s_add_u32 s13, s69, 0x50000
    buffer_load_dwordx4 v1, s[56:59], s13 offen lds
    s_waitcnt vmcnt(13)
    s_barrier
    s_waitcnt vmcnt(9)
    s_barrier
    s_waitcnt vmcnt(4)
    s_barrier
    s_waitcnt vmcnt(0)
    s_barrier
    s_branch L_ff_fin
L_ff_late:
    s_nop 1
    v_mul_f32 v230, v2, v2
    v_mul_f32 v231, v3, v3
    v_mul_f32 v232, v4, v4
    v_mul_f32 v233, v5, v5
    v_fma_f32 v230, v230, v248, v246
    v_fma_f32 v231, v231, v248, v246
    v_fma_f32 v232, v232, v248, v246
    v_fma_f32 v233, v233, v248, v246
    v_mul_f32 v230, v230, v2
    v_mul_f32 v231, v231, v3
    v_mul_f32 v232, v232, v4
    v_mul_f32 v233, v233, v5
    v_exp_f32 v230, v230
    v_mul_f32 v2, v2, v10
    v_exp_f32 v231, v231
    v_mul_f32 v3, v3, v11
    v_exp_f32 v232, v232
    v_mul_f32 v4, v4, v12
    v_exp_f32 v233, v233
    v_mul_f32 v5, v5, v13
    v_fma_f32 v230, v230, v250, v250
    v_fma_f32 v231, v231, v250, v250
    v_fma_f32 v232, v232, v250, v250
    v_fma_f32 v233, v233, v250, v250
    v_rcp_f32 v230, v230
    v_rcp_f32 v231, v231
    v_rcp_f32 v232, v232
    v_rcp_f32 v233, v233
    v_mul_f32 v2, v2, v230
    v_mul_f32 v3, v3, v231
    v_mul_f32 v4, v4, v232
    v_mul_f32 v5, v5, v233
    v_cvt_pk_bf16_f32 v226, v2, v3
    v_cvt_pk_bf16_f32 v227, v4, v5
    v_mul_f32 v230, v6, v6
    v_mul_f32 v231, v7, v7
    v_mul_f32 v232, v8, v8
    v_mul_f32 v233, v9, v9
    v_fma_f32 v230, v230, v249, v247
    v_fma_f32 v231, v231, v249, v247
    v_fma_f32 v232, v232, v249, v247
    v_fma_f32 v233, v233, v249, v247
    v_mul_f32 v230, v230, v6
    v_mul_f32 v231, v231, v7
    v_mul_f32 v232, v232, v8
    v_mul_f32 v233, v233, v9
    v_exp_f32 v230, v230
    v_mul_f32 v6, v6, v14
    v_exp_f32 v231, v231
    v_mul_f32 v7, v7, v15
    v_exp_f32 v232, v232
    v_mul_f32 v8, v8, v16
    v_exp_f32 v233, v233
    v_mul_f32 v9, v9, v17
    v_fma_f32 v230, v230, v251, v251
    v_fma_f32 v231, v231, v251, v251
    v_fma_f32 v232, v232, v251, v251
    v_fma_f32 v233, v233, v251, v251
    v_rcp_f32 v230, v230
    v_rcp_f32 v231, v231
    v_rcp_f32 v232, v232
    v_rcp_f32 v233, v233
    v_mul_f32 v6, v6, v230
    v_mul_f32 v7, v7, v231
    v_mul_f32 v8, v8, v232
    v_mul_f32 v9, v9, v233
    v_cvt_pk_bf16_f32 v228, v6, v7
    v_cvt_pk_bf16_f32 v229, v8, v9
    s_nop 0
    v_permlane32_swap_b32 v226, v228
    v_permlane32_swap_b32 v227, v229
    buffer_store_dwordx4 v[226:229], v254, s[48:51], s30 offen offset:512 sc1
    s_mov_b32 s10, 0
    s_branch L_ff_poll
L_ff_r0:
    s_add_u32 s86, s74, 0
    buffer_load_dwordx4 v[66:69], v252, s[48:51], s86 offen
    buffer_load_dwordx4 v[70:73], v253, s[48:51], s86 offen
    s_add_u32 s86, s74, 0
    buffer_load_dwordx4 v[74:77], v252, s[48:51], s86 offen offset:1024
    buffer_load_dwordx4 v[78:81], v253, s[48:51], s86 offen offset:1024
    s_add_u32 s86, s74, 0
    buffer_load_dwordx4 v[82:85], v252, s[48:51], s86 offen offset:2048
    buffer_load_dwordx4 v[86:89], v253, s[48:51], s86 offen offset:2048
    s_add_u32 s86, s74, 0
    buffer_load_dwordx4 v[90:93], v252, s[48:51], s86 offen offset:3072
    buffer_load_dwordx4 v[94:97], v253, s[48:51], s86 offen offset:3072
    s_add_u32 s86, s74, 0x1000
    buffer_load_dwordx4 v[98:101], v252, s[48:51], s86 offen
    buffer_load_dwordx4 v[102:105], v253, s[48:51], s86 offen
    s_add_u32 s86, s74, 0x1000
    buffer_load_dwordx4 v[106:109], v252, s[48:51], s86 offen offset:1024
    buffer_load_dwordx4 v[110:113], v253, s[48:51], s86 offen offset:1024
    s_add_u32 s86, s74, 0x1000
    buffer_load_dwordx4 v[114:117], v252, s[48:51], s86 offen offset:2048
    buffer_load_dwordx4 v[118:121], v253, s[48:51], s86 offen offset:2048
    s_add_u32 s86, s74, 0x1000
    buffer_load_dwordx4 v[122:125], v252, s[48:51], s86 offen offset:3072
    buffer_load_dwordx4 v[126:129], v253, s[48:51], s86 offen offset:3072
    ds_read_b128 v[130:133], v240
    ds_read_b128 v[134:137], v240 offset:1024
    ds_read_b128 v[138:141], v240 offset:2048
    ds_read_b128 v[142:145], v240 offset:3072
    ds_read_b128 v[146:149], v241
    s_waitcnt vmcnt(0) lgkmcnt(0)
    s_branch L_ff_a
L_ff_poll:
    s_cmp_eq_u32 s85, 1
    s_cbranch_scc1 L_ff_ret
    s_mov_b32 s82, 0
    s_lshl_b32 s13, s10, 8
    s_add_u32 s13, s13, s75
L_ff_pl:
    buffer_load_dword v239, v238, s[64:67], s13 offen sc1
    s_waitcnt vmcnt(0)
    v_cmp_eq_u32 vcc, -1, v239
    s_nop 1
    s_cmp_eq_u64 vcc, 0
    s_cbranch_scc1 L_ff_ret
    s_add_u32 s82, s82, 1
    s_cmp_lt_u32 s82, 0xfa0
    s_cbranch_scc1 L_ff_pl
L_ff_self:
    s_cmp_eq_u32 s85, 1
    s_cbranch_scc1 L_ff_ret
    s_mov_b32 s85, 1
    s_mov_b32 s82, 0
L_ff_st:
    s_lshl_b32 s13, s82, 9
    buffer_load_dwordx2 v[202:203], v255, s[40:43], s13 offen
    buffer_load_dwordx2 v[204:205], v255, s[40:43], s13 offen offset:64
    s_waitcnt vmcnt(0)
    v_mfma_f32_16x16x16_bf16 v[178:181], v[202:203], v[242:243], 0
    v_mfma_f32_16x16x16_bf16 v[182:185], v[202:203], v[244:245], 0
    v_mfma_f32_16x16x16_bf16 v[186:189], v[204:205], v[242:243], 0
    v_mfma_f32_16x16x16_bf16 v[190:193], v[204:205], v[244:245], 0
    s_mul_i32 s25, s82, 0x9000
    s_mov_b32 s16, 0
L_ff_sk:
    s_add_u32 s13, s15, s16
    buffer_load_dwordx4 v[210:213], v1, s[36:39], s13 offen
    s_add_u32 s13, s13, 0x4800
    buffer_load_dwordx4 v[214:217], v1, s[36:39], s13 offen
    buffer_load_dwordx4 v[218:221], v1, s[32:35], s25 offen
    buffer_load_dwordx4 v[222:225], v1, s[32:35], s25 offen offset:1024
    s_waitcnt vmcnt(0)
    v_mfma_f32_16x16x32_bf16 v[178:181], v[218:221], v[210:213], v[178:181]
    v_mfma_f32_16x16x32_bf16 v[182:185], v[218:221], v[214:217], v[182:185]
    v_mfma_f32_16x16x32_bf16 v[186:189], v[222:225], v[210:213], v[186:189]
    v_mfma_f32_16x16x32_bf16 v[190:193], v[222:225], v[214:217], v[190:193]
    s_add_u32 s25, s25, 0x800
    s_add_u32 s16, s16, 0x400
    s_cmp_lt_u32 s16, 0x4800
    s_cbranch_scc1 L_ff_sk
    s_lshl_b32 s25, s82, 9
    s_add_u32 s25, s25, s52
    v_mul_f32 v230, v178, v178
    v_mul_f32 v231, v179, v179
    v_mul_f32 v232, v180, v180
    v_mul_f32 v233, v181, v181
    v_fma_f32 v230, v230, v248, v246
    v_fma_f32 v231, v231, v248, v246
    v_fma_f32 v232, v232, v248, v246
    v_fma_f32 v233, v233, v248, v246
    v_mul_f32 v230, v230, v178
    v_mul_f32 v231, v231, v179
    v_mul_f32 v232, v232, v180
    v_mul_f32 v233, v233, v181
    v_exp_f32 v230, v230
    v_mul_f32 v178, v178, v186
    v_exp_f32 v231, v231
    v_mul_f32 v179, v179, v187
    v_exp_f32 v232, v232
    v_mul_f32 v180, v180, v188
    v_exp_f32 v233, v233
    v_mul_f32 v181, v181, v189
    v_fma_f32 v230, v230, v250, v250
    v_fma_f32 v231, v231, v250, v250
    v_fma_f32 v232, v232, v250, v250
    v_fma_f32 v233, v233, v250, v250
    v_rcp_f32 v230, v230
    v_rcp_f32 v231, v231
    v_rcp_f32 v232, v232
    v_rcp_f32 v233, v233
    v_mul_f32 v178, v178, v230
    v_mul_f32 v179, v179, v231
    v_mul_f32 v180, v180, v232
    v_mul_f32 v181, v181, v233
    v_cvt_pk_bf16_f32 v226, v178, v179
    v_cvt_pk_bf16_f32 v227, v180, v181
    v_mul_f32 v230, v182, v182
    v_mul_f32 v231, v183, v183
    v_mul_f32 v232, v184, v184
    v_mul_f32 v233, v185, v185
    v_fma_f32 v230, v230, v249, v247
    v_fma_f32 v231, v231, v249, v247
    v_fma_f32 v232, v232, v249, v247
    v_fma_f32 v233, v233, v249, v247
    v_mul_f32 v230, v230, v182
    v_mul_f32 v231, v231, v183
    v_mul_f32 v232, v232, v184
    v_mul_f32 v233, v233, v185
    v_exp_f32 v230, v230
    v_mul_f32 v182, v182, v190
    v_exp_f32 v231, v231
    v_mul_f32 v183, v183, v191
    v_exp_f32 v232, v232
    v_mul_f32 v184, v184, v192
    v_exp_f32 v233, v233
    v_mul_f32 v185, v185, v193
    v_fma_f32 v230, v230, v251, v251
    v_fma_f32 v231, v231, v251, v251
    v_fma_f32 v232, v232, v251, v251
    v_fma_f32 v233, v233, v251, v251
    v_rcp_f32 v230, v230
    v_rcp_f32 v231, v231
    v_rcp_f32 v232, v232
    v_rcp_f32 v233, v233
    v_mul_f32 v182, v182, v230
    v_mul_f32 v183, v183, v231
    v_mul_f32 v184, v184, v232
    v_mul_f32 v185, v185, v233
    v_cvt_pk_bf16_f32 v228, v182, v183
    v_cvt_pk_bf16_f32 v229, v184, v185
    s_nop 0
    v_permlane32_swap_b32 v226, v228
    v_permlane32_swap_b32 v227, v229
    buffer_store_dwordx4 v[226:229], v254, s[48:51], s25 offen sc1
    s_add_u32 s82, s82, 1
    s_cmp_lt_u32 s82, 0x120
    s_cbranch_scc1 L_ff_st
    s_waitcnt vmcnt(0)
L_ff_ret:
    s_cmp_eq_u32 s10, 0
    s_cbranch_scc1 L_ff_r0
    s_cmp_eq_u32 s10, 1
    s_cbranch_scc1 L_ff_r1
    s_cmp_eq_u32 s10, 2
    s_cbranch_scc1 L_ff_r2
    s_branch L_ff_r3
L_ff_fin:
L_ff_end:
    s_endpgm
.section .rodata,"a"
.p2align 6
.amdhsa_kernel qkv_kernel
  .amdhsa_next_free_vgpr 216
  .amdhsa_next_free_sgpr 47
  .amdhsa_accum_offset 216
  .amdhsa_group_segment_fixed_size 0
  .amdhsa_kernarg_size 80
  .amdhsa_user_sgpr_count 2
  .amdhsa_user_sgpr_kernarg_segment_ptr 1
  .amdhsa_system_sgpr_workgroup_id_x 1
.end_amdhsa_kernel
.section .rodata,"a"
.p2align 6
.amdhsa_kernel attn_kernel
  .amdhsa_next_free_vgpr 176
  .amdhsa_next_free_sgpr 78
  .amdhsa_accum_offset 176
  .amdhsa_group_segment_fixed_size 0
  .amdhsa_kernarg_size 80
  .amdhsa_user_sgpr_count 2
  .amdhsa_user_sgpr_kernarg_segment_ptr 1
  .amdhsa_system_sgpr_workgroup_id_x 1
.end_amdhsa_kernel
.section .rodata,"a"
.p2align 6
.amdhsa_kernel attn_out_kernel
  .amdhsa_next_free_vgpr 200
  .amdhsa_next_free_sgpr 48
  .amdhsa_accum_offset 200
  .amdhsa_group_segment_fixed_size 0
  .amdhsa_kernarg_size 80
  .amdhsa_user_sgpr_count 2
  .amdhsa_user_sgpr_kernarg_segment_ptr 1
  .amdhsa_system_sgpr_workgroup_id_x 1
.end_amdhsa_kernel
.section .rodata,"a"
.p2align 6
.amdhsa_kernel ffn_kernel
  .amdhsa_next_free_vgpr 256
  .amdhsa_next_free_sgpr 91
  .amdhsa_accum_offset 256
  .amdhsa_group_segment_fixed_size 0
  .amdhsa_kernarg_size 80
  .amdhsa_user_sgpr_count 2
  .amdhsa_user_sgpr_kernarg_segment_ptr 1
  .amdhsa_system_sgpr_workgroup_id_x 1
.end_amdhsa_kernel
```
